```python
import torch

def _softmax(x, axis=-1):
    return torch.softmax(x, dim=axis)
def _gelu(x):
    return torch.nn.functional.gelu(x, approximate="tanh")
def _silu(x):
    return torch.nn.functional.silu(x)
def _sigmoid(x):
    return torch.sigmoid(x)
def _layernorm(x, axis=-1, eps=1e-5):
    m = x.mean(dim=axis, keepdim=True)
    v = x.var(dim=axis, keepdim=True, unbiased=False)
    return (x - m) / torch.sqrt(v + eps)
def _scatter_add(tgt, idx, src, axis=0):
    return tgt.clone().index_add_(axis, idx, src)
def _segment_sum(src, seg, n):
    out = torch.zeros((n,) + src.shape[1:], dtype=src.dtype)
    return out.index_add_(0, seg, src)
def _pad(x, pw):
    flat = tuple(v for pair in reversed(pw) for v in pair)
    return torch.nn.functional.pad(x, flat)

kernel_name = 'standalone__mha_block_cached__near_ridge'

def setup_inputs():

    _w = (lambda a: (lambda t: t.to(torch.bfloat16) if t.is_floating_point() else t)(torch.as_tensor(a)))
    B, Sq, D = 16, 112, 512
    H, Sk, Dh = 32, 512, 128
    return {
        "x": _w((lambda *s: torch.randn(*s, dtype=torch.bfloat16) * 0.8)(B, Sq, D)),
        "k_cache": _w((lambda *s: torch.randn(*s, dtype=torch.bfloat16) * 0.8)(B, H, Sk, Dh)),
        "v_cache": _w((lambda *s: torch.randn(*s, dtype=torch.bfloat16) * 0.05)(B, H, Sk, Dh)),
        "wq": _w((lambda *s: torch.randn(*s, dtype=torch.bfloat16) * 0.8)(D, H * Dh) * (D ** -0.5)),
        "wo": _w((lambda *s: torch.randn(*s, dtype=torch.bfloat16) * 0.05)(H * Dh, D) * ((H * Dh) ** -0.5)),
    }

def reference(x, k_cache, v_cache, wq, wo):
    B, Sq, D = x.shape
    H, Dh = 32, 128
    q = (lambda x, *d: x.permute(*d))((x @ wq).reshape(B, Sq, H, Dh), 0, 2, 1, 3)
    scores = torch.einsum("bhqd,bhkd->bhqk", q, k_cache) * (Dh ** -0.5)
    p = _softmax(scores, axis=-1)
    o = torch.einsum("bhqk,bhkd->bhqd", p, v_cache)
    return (lambda x, *d: x.permute(*d))(o, 0, 2, 1, 3).reshape(B, Sq, H * Dh) @ wo
```

```asm
; @launch grid=(256,1,1) block=(256,1,1) lds=163840
.amdgcn_target "amdgcn-amd-amdhsa--gfx950"
.text
.p2align 12
.globl standalone__mha_block_cached__near_ridge_kernel
.p2align 8
.type standalone__mha_block_cached__near_ridge_kernel,@function
standalone__mha_block_cached__near_ridge_kernel:
  s_cmp_ge_u32 s2, 256
  s_cbranch_scc1 L_end
  s_load_dwordx16 s[80:95], s[0:1], 0
  v_lshrrev_b32 v1, 6, v0
  v_and_b32 v2, 63, v0
  v_readfirstlane_b32 s40, v1
  s_and_b32 s42, s2, 3
  s_lshr_b32 s49, s2, 3
  s_and_b32 s43, s49, 3
  s_lshr_b32 s50, s49, 2
  s_lshl_b32 s41, s2, 1
  s_and_b32 s41, s41, 8
  s_add_u32 s41, s41, s50
  s_lshl_b32 s44, s43, 1
  s_add_u32 s44, s44, s50
  s_and_b32 s44, s44, 7
  s_lshl_b32 s45, s40, 12
  s_lshl_b32 s51, s42, 2
  s_add_u32 s51, s51, s43
  s_lshl_b32 s48, s51, 9
  s_lshl_b32 s52, s41, 4
  s_add_u32 s52, s52, s51
  s_lshl_b32 s46, s52, 18
  s_mul_i32 s47, s41, 114688
  v_lshrrev_b32 v3, 4, v2
  v_and_b32 v4, 15, v2
  v_lshlrev_b32 v5, 1, v3
  v_xor_b32 v5, v5, v4
  v_lshl_add_u32 v6, v1, 4, v3
  v_lshrrev_b32 v7, 3, v2
  v_mad_u32_u24 v7, v1, 28, v7
  v_lshlrev_b32 v7, 10, v7
  v_and_b32 v8, 7, v2
  v_xor_b32 v8, v8, v3
  v_lshl_add_u32 v222, v8, 4, v7
  v_xor_b32 v8, 4, v8
  v_lshl_add_u32 v9, v8, 4, v7
  v_mov_b32 v10, 2130706432
  v_mov_b32 v253, 2130706432
  v_cmp_gt_u32 vcc, 48, v2
  v_add_u32 v224, 12288, v222
  v_add_u32 v9, 7168, v9
  v_cndmask_b32 v223, v10, v9, vcc
  v_add_u32 v225, 12288, v223
  v_lshrrev_b32 v7, 1, v1
  v_lshl_add_u32 v7, v7, 5, v3
  v_and_b32 v8, 1, v1
  v_lshl_add_u32 v7, v8, 2, v7
  v_lshlrev_b32 v7, 13, v7
  v_lshl_add_u32 v218, v5, 4, v7
  v_xor_b32 v8, 0x80, v218
  v_add_u32 v219, 64512, v8
  v_add_u32 v220, 129024, v218
  v_add_u32 v221, 193536, v8
  s_getpc_b64 s[96:97]
L_pc0:
  s_sub_u32 s96, s96, L_pc0-standalone__mha_block_cached__near_ridge_kernel
  s_subb_u32 s97, s97, 0
  s_lshl_b32 s50, s49, 11
  v_and_b32 v7, 3, v2
  v_lshl_add_u32 v7, v1, 2, v7
  v_lshl_add_u32 v7, v7, 7, s50
  v_min_u32 v7, L_codeend-standalone__mha_block_cached__near_ridge_kernel-4, v7
  global_load_dword v254, v7, s[96:97]
  s_waitcnt lgkmcnt(0)
  s_add_u32 s8, s80, s47
  s_addc_u32 s9, s81, 0
  s_mov_b32 s10, 114688
  s_mov_b32 s11, 0x20000
  s_add_u32 s20, s86, s48
  s_addc_u32 s21, s87, 0
  s_sub_u32 s22, 4194304, s48
  s_mov_b32 s23, 0x20000
  s_add_u32 m0, s45, 131072
  s_lshl_b32 s53, s44, 7
  buffer_load_dwordx4 v222, s[8:11], s53 offen offset:0 lds
  buffer_load_dwordx4 v223, s[8:11], s53 offen offset:1024 lds
  buffer_load_dwordx4 v224, s[8:11], s53 offen offset:2048 lds
  buffer_load_dwordx4 v225, s[8:11], s53 offen offset:3072 lds
  s_add_u32 m0, s45, 16384
  s_lshl_b32 s54, s44, 19
  buffer_load_dwordx4 v218, s[20:23], s54 offen offset:0 lds
  buffer_load_dwordx4 v219, s[20:23], s54 offen offset:1024 lds
  buffer_load_dwordx4 v220, s[20:23], s54 offen offset:2048 lds
  buffer_load_dwordx4 v221, s[20:23], s54 offen offset:3072 lds
  s_add_u32 s12, s82, s46
  s_addc_u32 s13, s83, 0
  s_mov_b32 s14, 262144
  s_mov_b32 s15, 0x20000
  s_add_u32 s16, s84, s46
  s_addc_u32 s17, s85, 0
  s_mov_b32 s18, 262144
  s_mov_b32 s19, 0x20000
  s_mov_b64 s[24:25], s[88:89]
  s_mov_b32 s26, 4194304
  s_mov_b32 s27, 0x20000
  s_mov_b64 s[28:29], s[90:91]
  s_mov_b32 s30, 1835008
  s_mov_b32 s31, 0x20000
  s_mov_b64 s[32:33], s[92:93]
  s_mov_b32 s34, 256
  s_mov_b32 s35, 0x20000
  s_mov_b64 s[36:37], s[94:95]
  s_mov_b32 s38, 35651584
  s_mov_b32 s39, 0x20000
  v_and_b32 v11, 1, v3
  v_lshrrev_b32 v12, 1, v3
  v_lshl_add_u32 v11, v11, 1, v12
  v_mov_b32 v246, 0
  s_lshl_b32 s49, s41, 2
  s_add_u32 s50, s49, s42
  s_lshl_b32 s50, s50, 2
  s_add_u32 s50, s50, s40
  s_lshl_b32 s66, s50, 7
  v_min_u32 v7, 2, v2
  s_add_u32 s49, s43, 1
  v_add_u32 v7, s49, v7
  v_and_b32 v7, 3, v7
  s_lshr_b32 s66, s66, 9
  s_lshl_b32 s66, s66, 7
  s_lshl_b32 s49, s43, 2
  s_cmp_lg_u32 s40, 0
  s_cselect_b32 s49, 2130706432, s49
  v_mov_b32 v255, s49
  v_lshlrev_b32 v232, 2, v7
  s_mov_b64 exec, 1
  buffer_store_dword v246, v255, s[36:39], s66 offen sc1
  s_mov_b64 exec, -1
  v_lshrrev_b32 v7, 1, v4
  v_xor_b32 v7, v7, v3
  v_lshlrev_b32 v8, 7, v4
  v_lshl_add_u32 v8, v1, 12, v8
  v_add_u32 v8, 131072, v8
  v_lshl_add_u32 v226, v7, 4, v8
  v_xor_b32 v227, 64, v226
  v_lshrrev_b32 v7, 2, v2
  v_lshlrev_b32 v8, 8, v7
  v_and_b32 v7, 7, v7
  v_lshl_add_u32 v8, v7, 5, v8
  v_and_b32 v9, 3, v2
  v_lshl_add_u32 v184, v9, 3, v8
  v_add_u32 v192, 0x10000, v184
  v_add_u32 v200, 0x20000, v184
  v_xor_b32 v185, 32, v184
  v_add_u32 v193, 0x10000, v185
  v_add_u32 v201, 0x20000, v185
  v_xor_b32 v186, 64, v184
  v_add_u32 v194, 0x10000, v186
  v_add_u32 v202, 0x20000, v186
  v_xor_b32 v187, 96, v184
  v_add_u32 v195, 0x10000, v187
  v_add_u32 v203, 0x20000, v187
  v_xor_b32 v188, 128, v184
  v_add_u32 v196, 0x10000, v188
  v_add_u32 v204, 0x20000, v188
  v_xor_b32 v189, 160, v184
  v_add_u32 v197, 0x10000, v189
  v_add_u32 v205, 0x20000, v189
  v_xor_b32 v190, 192, v184
  v_add_u32 v198, 0x10000, v190
  v_add_u32 v206, 0x20000, v190
  v_xor_b32 v191, 224, v184
  v_add_u32 v199, 0x10000, v191
  v_add_u32 v207, 0x20000, v191
  v_lshlrev_b32 v7, 8, v6
  v_lshl_add_u32 v216, v5, 4, v7
  v_xor_b32 v217, 0x80, v216
  v_xor_b32 v8, v4, v3
  v_lshl_add_u32 v212, v8, 4, v7
  v_xor_b32 v213, 64, v212
  v_xor_b32 v214, 128, v212
  v_xor_b32 v215, 192, v212
  v_xor_b32 v8, v11, v4
  v_lshlrev_b32 v7, 8, v4
  v_add_u32 v7, 65536, v7
  v_lshl_add_u32 v208, v8, 4, v7
  v_xor_b32 v209, 64, v208
  v_xor_b32 v210, 128, v208
  v_xor_b32 v211, 192, v208
  v_mad_u32_u24 v7, v3, 14, v4
  v_lshlrev_b32 v7, 4, v7
  v_mad_u32_u24 v8, v1, 28, v4
  v_lshlrev_b32 v8, 10, v8
  v_lshl_add_u32 v8, v11, 4, v8
  v_cmp_gt_u32 vcc, 14, v4
  v_mov_b32 v9, 0xff800000
  v_mov_b32 v247, 1182793728
  v_cndmask_b32 v230, v10, v7, vcc
  v_cndmask_b32 v231, v10, v8, vcc
  v_cndmask_b32 v247, v247, v9, vcc
  v_mov_b32 v248, v6
  v_mov_b32 v249, v5
  v_lshrrev_b32 v7, 1, v0
  v_lshlrev_b32 v7, 10, v7
  v_and_b32 v8, 1, v0
  v_lshl_add_u32 v7, v8, 7, v7
  s_and_b32 s49, s41, 7
  s_lshl_b32 s50, s42, 3
  s_add_u32 s49, s49, s50
  s_lshl_b32 s49, s49, 17
  s_lshl_b32 s50, s43, 8
  s_add_u32 s49, s49, s50
  v_add_u32 v250, s49, v7
  s_mov_b32 s64, 1040356334
  s_mov_b32 s65, 1040356334
  s_mov_b32 s63, 1149239296
  s_lshl_b32 s49, s52, 2
  s_add_u32 s49, s49, s40
  s_mul_i32 s49, s49, 7168
  s_add_u32 s68, s49, 524288
  s_lshl_b32 s49, s42, 6
  s_lshl_b32 s50, s43, 8
  s_add_u32 s49, s49, s50
  s_add_u32 s78, s49, s47
  s_add_u32 s49, s43, 0
  s_and_b32 s49, s49, 3
  s_lshl_b32 s50, s42, 2
  s_add_u32 s50, s50, s49
  s_lshl_b32 s51, s50, 18
  s_lshl_b32 s56, s43, 8
  s_add_u32 s56, s56, s51
  s_add_u32 s49, s43, 1
  s_and_b32 s49, s49, 3
  s_lshl_b32 s50, s42, 2
  s_add_u32 s50, s50, s49
  s_lshl_b32 s51, s50, 18
  s_lshl_b32 s57, s43, 8
  s_add_u32 s57, s57, s51
  s_sub_i32 s49, s49, s43
  s_mul_i32 s49, s49, 28672
  s_add_i32 s69, s68, s49
  s_add_u32 s49, s43, 2
  s_and_b32 s49, s49, 3
  s_lshl_b32 s50, s42, 2
  s_add_u32 s50, s50, s49
  s_lshl_b32 s51, s50, 18
  s_lshl_b32 s58, s43, 8
  s_add_u32 s58, s58, s51
  s_sub_i32 s49, s49, s43
  s_mul_i32 s49, s49, 28672
  s_add_i32 s70, s68, s49
  s_add_u32 s49, s43, 3
  s_and_b32 s49, s49, 3
  s_lshl_b32 s50, s42, 2
  s_add_u32 s50, s50, s49
  s_lshl_b32 s51, s50, 18
  s_lshl_b32 s59, s43, 8
  s_add_u32 s59, s59, s51
  s_sub_i32 s49, s49, s43
  s_mul_i32 s49, s49, 28672
  s_add_i32 s71, s68, s49
  s_lshl_b32 s52, s41, 2
  s_add_u32 s52, s52, s43
  s_lshl_b32 s52, s52, 6
  s_add_u32 s52, s52, s40
  s_add_u32 s49, s42, 1
  s_and_b32 s49, s49, 3
  s_lshl_b32 s50, s49, 2
  s_add_u32 s50, s50, s42
  s_lshl_b32 s50, s50, 2
  s_add_u32 s50, s50, s52
  s_mul_i32 s50, s50, 1792
  s_add_u32 s72, s50, 17301504
  s_lshl_b32 s50, s42, 2
  s_add_u32 s50, s50, s49
  s_lshl_b32 s50, s50, 2
  s_add_u32 s50, s50, s52
  s_mul_i32 s50, s50, 1792
  s_add_u32 s75, s50, 17301504
  s_add_u32 s49, s42, 2
  s_and_b32 s49, s49, 3
  s_lshl_b32 s50, s49, 2
  s_add_u32 s50, s50, s42
  s_lshl_b32 s50, s50, 2
  s_add_u32 s50, s50, s52
  s_mul_i32 s50, s50, 1792
  s_add_u32 s73, s50, 17301504
  s_lshl_b32 s50, s42, 2
  s_add_u32 s50, s50, s49
  s_lshl_b32 s50, s50, 2
  s_add_u32 s50, s50, s52
  s_mul_i32 s50, s50, 1792
  s_add_u32 s76, s50, 17301504
  s_add_u32 s49, s42, 3
  s_and_b32 s49, s49, 3
  s_lshl_b32 s50, s49, 2
  s_add_u32 s50, s50, s42
  s_lshl_b32 s50, s50, 2
  s_add_u32 s50, s50, s52
  s_mul_i32 s50, s50, 1792
  s_add_u32 s74, s50, 17301504
  s_lshl_b32 s50, s42, 2
  s_add_u32 s50, s50, s49
  s_lshl_b32 s50, s50, 2
  s_add_u32 s50, s50, s52
  s_mul_i32 s50, s50, 1792
  s_add_u32 s77, s50, 17301504
  s_waitcnt vmcnt(9)
  s_mov_b64 exec, 0
  s_cmp_eq_u32 s40, 0
  s_cbranch_scc1 L_pg0
  s_cmp_eq_u32 s40, 1
  s_cbranch_scc1 L_pg1
  s_cmp_eq_u32 s40, 2
  s_cbranch_scc1 L_pg2
  s_branch L_pg3
L_pgback:
  s_mov_b64 exec, -1
  s_add_u32 m0, s45, 147456
  s_add_u32 s53, s53, 128
  s_and_b32 s53, s53, 0x3ff
  buffer_load_dwordx4 v222, s[8:11], s53 offen offset:0 lds
  buffer_load_dwordx4 v223, s[8:11], s53 offen offset:1024 lds
  buffer_load_dwordx4 v224, s[8:11], s53 offen offset:2048 lds
  buffer_load_dwordx4 v225, s[8:11], s53 offen offset:3072 lds
  s_add_u32 m0, s45, 32768
  s_add_u32 s54, s54, 524288
  s_and_b32 s54, s54, 0x3fffff
  buffer_load_dwordx4 v218, s[20:23], s54 offen offset:0 lds
  buffer_load_dwordx4 v219, s[20:23], s54 offen offset:1024 lds
  buffer_load_dwordx4 v220, s[20:23], s54 offen offset:2048 lds
  buffer_load_dwordx4 v221, s[20:23], s54 offen offset:3072 lds
  s_waitcnt vmcnt(9)
  s_barrier
  ds_read_b128 a[128:131], v226 offset:0
  ds_read_b128 a[132:135], v226 offset:2048
  ds_read_b64_tr_b16 a[64:65], v184 offset:16384
  ds_read_b64_tr_b16 a[66:67], v184 offset:20480
  ds_read_b64_tr_b16 a[68:69], v185 offset:16384
  ds_read_b64_tr_b16 a[70:71], v185 offset:20480
  ds_read_b128 a[136:139], v227 offset:0
  ds_read_b128 a[140:143], v227 offset:2048
  ds_read_b64_tr_b16 a[72:73], v186 offset:16384
  ds_read_b64_tr_b16 a[74:75], v186 offset:20480
  ds_read_b64_tr_b16 a[76:77], v187 offset:16384
  ds_read_b64_tr_b16 a[78:79], v187 offset:20480
  ds_read_b64_tr_b16 a[80:81], v188 offset:16384
  ds_read_b64_tr_b16 a[82:83], v188 offset:20480
  ds_read_b64_tr_b16 a[84:85], v189 offset:16384
  s_waitcnt lgkmcnt(14)
  ds_read_b64_tr_b16 a[86:87], v189 offset:20480
  s_waitcnt lgkmcnt(12)
  v_mfma_f32_16x16x32_bf16 v[0:3], a[64:67], a[128:131], 0
  s_add_u32 m0, s45, 98304
  ds_read_b64_tr_b16 a[88:89], v190 offset:16384
  v_mfma_f32_16x16x32_bf16 v[8:11], a[64:67], a[132:135], 0
  ds_read_b64_tr_b16 a[90:91], v190 offset:20480
  ds_read_b64_tr_b16 a[92:93], v191 offset:16384
  s_waitcnt lgkmcnt(13)
  v_mfma_f32_16x16x32_bf16 v[4:7], a[68:71], a[128:131], 0
  s_add_u32 s54, s54, 524288
  ds_read_b64_tr_b16 a[94:95], v191 offset:20480
  v_mfma_f32_16x16x32_bf16 v[12:15], a[68:71], a[132:135], 0
  s_and_b32 s54, s54, 0x3fffff
  ds_read_b64_tr_b16 a[96:97], v184 offset:24576
  s_waitcnt lgkmcnt(11)
  v_mfma_f32_16x16x32_bf16 v[16:19], a[72:75], a[128:131], 0
  buffer_load_dwordx4 v218, s[20:23], s54 offen offset:0 lds
  v_mfma_f32_16x16x32_bf16 v[24:27], a[72:75], a[132:135], 0
  ds_read_b64_tr_b16 a[98:99], v184 offset:28672
  ds_read_b64_tr_b16 a[100:101], v185 offset:24576
  s_waitcnt lgkmcnt(7)
  v_mfma_f32_16x16x32_bf16 v[20:23], a[76:79], a[128:131], 0
  buffer_load_dwordx4 v219, s[20:23], s54 offen offset:1024 lds
  v_mfma_f32_16x16x32_bf16 v[28:31], a[76:79], a[132:135], 0
  ds_read_b64_tr_b16 a[102:103], v185 offset:28672
  ds_read_b64_tr_b16 a[104:105], v186 offset:24576
  v_mfma_f32_16x16x32_bf16 v[32:35], a[80:83], a[128:131], 0
  buffer_load_dwordx4 v220, s[20:23], s54 offen offset:2048 lds
  v_mfma_f32_16x16x32_bf16 v[40:43], a[80:83], a[132:135], 0
  ds_read_b64_tr_b16 a[106:107], v186 offset:28672
  ds_read_b64_tr_b16 a[108:109], v187 offset:24576
  v_mfma_f32_16x16x32_bf16 v[36:39], a[84:87], a[128:131], 0
  buffer_load_dwordx4 v221, s[20:23], s54 offen offset:3072 lds
  v_mfma_f32_16x16x32_bf16 v[44:47], a[84:87], a[132:135], 0
  v_accvgpr_read_b32 v251, a143
  s_add_u32 m0, s45, 131072
  s_add_u32 s53, s53, 128
  s_and_b32 s53, s53, 0x3ff
  ds_read_b64_tr_b16 a[110:111], v187 offset:28672
  s_waitcnt lgkmcnt(5)
  v_mfma_f32_16x16x32_bf16 v[48:51], a[88:91], a[128:131], 0
  ds_read_b64_tr_b16 a[112:113], v188 offset:24576
  ds_read_b64_tr_b16 a[114:115], v188 offset:28672
  v_mfma_f32_16x16x32_bf16 v[56:59], a[88:91], a[132:135], 0
  buffer_load_dwordx4 v222, s[8:11], s53 offen offset:0 lds
  v_mfma_f32_16x16x32_bf16 v[52:55], a[92:95], a[128:131], 0
  ds_read_b64_tr_b16 a[116:117], v189 offset:24576
  ds_read_b64_tr_b16 a[118:119], v189 offset:28672
  v_mfma_f32_16x16x32_bf16 v[60:63], a[92:95], a[132:135], 0
  buffer_load_dwordx4 v223, s[8:11], s53 offen offset:1024 lds
  v_mfma_f32_16x16x32_bf16 v[0:3], a[96:99], a[136:139], v[0:3]
  ds_read_b64_tr_b16 a[120:121], v190 offset:24576
  ds_read_b64_tr_b16 a[122:123], v190 offset:28672
  v_mfma_f32_16x16x32_bf16 v[8:11], a[96:99], a[140:143], v[8:11]
  buffer_load_dwordx4 v224, s[8:11], s53 offen offset:2048 lds
  buffer_load_dwordx4 v225, s[8:11], s53 offen offset:3072 lds
  s_waitcnt lgkmcnt(6)
  v_mfma_f32_16x16x32_bf16 v[4:7], a[100:103], a[136:139], v[4:7]
  ds_read_b64_tr_b16 a[124:125], v191 offset:24576
  ds_read_b64_tr_b16 a[126:127], v191 offset:28672
  v_mfma_f32_16x16x32_bf16 v[12:15], a[100:103], a[140:143], v[12:15]
  s_waitcnt vmcnt(8)
  s_barrier
  v_mfma_f32_16x16x32_bf16 v[16:19], a[104:107], a[136:139], v[16:19]
  s_add_u32 m0, s45, 114688
  s_add_u32 s54, s54, 524288
  v_mfma_f32_16x16x32_bf16 v[24:27], a[104:107], a[140:143], v[24:27]
  ds_read_b128 a[144:147], v226 offset:16384
  ds_read_b128 a[148:151], v226 offset:18432
  ds_read_b64_tr_b16 a[64:65], v184 offset:32768
  ds_read_b64_tr_b16 a[66:67], v184 offset:36864
  v_mfma_f32_16x16x32_bf16 v[20:23], a[108:111], a[136:139], v[20:23]
  s_and_b32 s54, s54, 0x3fffff
  ds_read_b64_tr_b16 a[68:69], v185 offset:32768
  v_mfma_f32_16x16x32_bf16 v[28:31], a[108:111], a[140:143], v[28:31]
  ds_read_b64_tr_b16 a[70:71], v185 offset:36864
  ds_read_b128 a[152:155], v227 offset:16384
  s_waitcnt lgkmcnt(9)
  v_mfma_f32_16x16x32_bf16 v[32:35], a[112:115], a[136:139], v[32:35]
  ds_read_b128 a[156:159], v227 offset:18432
  ds_read_b64_tr_b16 a[72:73], v186 offset:32768
  v_mfma_f32_16x16x32_bf16 v[40:43], a[112:115], a[140:143], v[40:43]
  buffer_load_dwordx4 v218, s[20:23], s54 offen offset:0 lds
  ds_read_b64_tr_b16 a[74:75], v186 offset:36864
  v_mfma_f32_16x16x32_bf16 v[36:39], a[116:119], a[136:139], v[36:39]
  ds_read_b64_tr_b16 a[76:77], v187 offset:32768
  ds_read_b64_tr_b16 a[78:79], v187 offset:36864
  v_mfma_f32_16x16x32_bf16 v[44:47], a[116:119], a[140:143], v[44:47]
  buffer_load_dwordx4 v219, s[20:23], s54 offen offset:1024 lds
  v_mfma_f32_16x16x32_bf16 v[48:51], a[120:123], a[136:139], v[48:51]
  ds_read_b64_tr_b16 a[80:81], v188 offset:32768
  s_waitcnt lgkmcnt(8)
  ds_read_b64_tr_b16 a[82:83], v188 offset:36864
  v_mfma_f32_16x16x32_bf16 v[56:59], a[120:123], a[140:143], v[56:59]
  ds_read_b64_tr_b16 a[84:85], v189 offset:32768
  ds_read_b64_tr_b16 a[86:87], v189 offset:36864
  v_mfma_f32_16x16x32_bf16 v[52:55], a[124:127], a[136:139], v[52:55]
  buffer_load_dwordx4 v220, s[20:23], s54 offen offset:2048 lds
  v_mfma_f32_16x16x32_bf16 v[60:63], a[124:127], a[140:143], v[60:63]
  ds_read_b64_tr_b16 a[88:89], v190 offset:32768
  ds_read_b64_tr_b16 a[90:91], v190 offset:36864
  v_mfma_f32_16x16x32_bf16 v[0:3], a[64:67], a[144:147], v[0:3]
  buffer_load_dwordx4 v221, s[20:23], s54 offen offset:3072 lds
  v_mfma_f32_16x16x32_bf16 v[8:11], a[64:67], a[148:151], v[8:11]
  s_waitcnt lgkmcnt(6)
  v_accvgpr_read_b32 v251, a159
  ds_read_b64_tr_b16 a[92:93], v191 offset:32768
  v_mfma_f32_16x16x32_bf16 v[4:7], a[68:71], a[144:147], v[4:7]
  s_add_u32 m0, s45, 147456
  ds_read_b64_tr_b16 a[94:95], v191 offset:36864
  v_mfma_f32_16x16x32_bf16 v[12:15], a[68:71], a[148:151], v[12:15]
  s_add_u32 s53, s53, 128
  s_and_b32 s53, s53, 0x3ff
  v_mfma_f32_16x16x32_bf16 v[16:19], a[72:75], a[144:147], v[16:19]
  ds_read_b64_tr_b16 a[96:97], v184 offset:40960
  ds_read_b64_tr_b16 a[98:99], v184 offset:45056
  v_mfma_f32_16x16x32_bf16 v[24:27], a[72:75], a[148:151], v[24:27]
  buffer_load_dwordx4 v222, s[8:11], s53 offen offset:0 lds
  v_mfma_f32_16x16x32_bf16 v[20:23], a[76:79], a[144:147], v[20:23]
  ds_read_b64_tr_b16 a[100:101], v185 offset:40960
  ds_read_b64_tr_b16 a[102:103], v185 offset:45056
  v_mfma_f32_16x16x32_bf16 v[28:31], a[76:79], a[148:151], v[28:31]
  buffer_load_dwordx4 v223, s[8:11], s53 offen offset:1024 lds
  s_waitcnt lgkmcnt(5)
  v_mfma_f32_16x16x32_bf16 v[32:35], a[80:83], a[144:147], v[32:35]
  ds_read_b64_tr_b16 a[104:105], v186 offset:40960
  ds_read_b64_tr_b16 a[106:107], v186 offset:45056
  v_mfma_f32_16x16x32_bf16 v[40:43], a[80:83], a[148:151], v[40:43]
  ds_read_b64_tr_b16 a[108:109], v187 offset:40960
  ds_read_b64_tr_b16 a[110:111], v187 offset:45056
  v_mfma_f32_16x16x32_bf16 v[36:39], a[84:87], a[144:147], v[36:39]
  buffer_load_dwordx4 v224, s[8:11], s53 offen offset:2048 lds
  v_mfma_f32_16x16x32_bf16 v[44:47], a[84:87], a[148:151], v[44:47]
  ds_read_b64_tr_b16 a[112:113], v188 offset:40960
  ds_read_b64_tr_b16 a[114:115], v188 offset:45056
  v_mfma_f32_16x16x32_bf16 v[48:51], a[88:91], a[144:147], v[48:51]
  buffer_load_dwordx4 v225, s[8:11], s53 offen offset:3072 lds
  v_mfma_f32_16x16x32_bf16 v[56:59], a[88:91], a[148:151], v[56:59]
  ds_read_b64_tr_b16 a[116:117], v189 offset:40960
  ds_read_b64_tr_b16 a[118:119], v189 offset:45056
  s_waitcnt lgkmcnt(8)
  v_mfma_f32_16x16x32_bf16 v[52:55], a[92:95], a[144:147], v[52:55]
  ds_read_b64_tr_b16 a[120:121], v190 offset:40960
  ds_read_b64_tr_b16 a[122:123], v190 offset:45056
  v_mfma_f32_16x16x32_bf16 v[60:63], a[92:95], a[148:151], v[60:63]
  v_mov_b32 v160, -1
  v_mov_b32 v161, -1
  v_mov_b32 v162, -1
  v_mov_b32 v163, -1
  v_mfma_f32_16x16x32_bf16 v[0:3], a[96:99], a[152:155], v[0:3]
  s_add_u32 s51, s72, 0
  ds_read_b64_tr_b16 a[124:125], v191 offset:40960
  v_mfma_f32_16x16x32_bf16 v[8:11], a[96:99], a[156:159], v[8:11]
  buffer_store_dwordx4 v[160:163], v230, s[36:39], s51 offen offset:0 sc1
  s_add_u32 s51, s72, 896
  buffer_store_dwordx4 v[160:163], v230, s[36:39], s51 offen offset:0 sc1
  v_mfma_f32_16x16x32_bf16 v[4:7], a[100:103], a[152:155], v[4:7]
  ds_read_b64_tr_b16 a[126:127], v191 offset:45056
  v_mfma_f32_16x16x32_bf16 v[12:15], a[100:103], a[156:159], v[12:15]
  s_waitcnt vmcnt(10)
  s_barrier
  s_waitcnt lgkmcnt(4)
  v_mfma_f32_16x16x32_bf16 v[16:19], a[104:107], a[152:155], v[16:19]
  s_add_u32 m0, s45, 16384
  s_add_u32 s54, s54, 524288
  v_mfma_f32_16x16x32_bf16 v[24:27], a[104:107], a[156:159], v[24:27]
  ds_read_b128 a[160:163], v226 offset:0
  ds_read_b128 a[164:167], v226 offset:2048
  ds_read_b64_tr_b16 a[64:65], v192 offset:32768
  ds_read_b64_tr_b16 a[66:67], v192 offset:36864
  v_mfma_f32_16x16x32_bf16 v[20:23], a[108:111], a[152:155], v[20:23]
  s_and_b32 s54, s54, 0x3fffff
  ds_read_b64_tr_b16 a[68:69], v193 offset:32768
  v_mfma_f32_16x16x32_bf16 v[28:31], a[108:111], a[156:159], v[28:31]
  ds_read_b64_tr_b16 a[70:71], v193 offset:36864
  ds_read_b128 a[168:171], v227 offset:0
  v_mfma_f32_16x16x32_bf16 v[32:35], a[112:115], a[152:155], v[32:35]
  ds_read_b128 a[172:175], v227 offset:2048
  ds_read_b64_tr_b16 a[72:73], v194 offset:32768
  v_mfma_f32_16x16x32_bf16 v[40:43], a[112:115], a[156:159], v[40:43]
  buffer_load_dwordx4 v218, s[20:23], s54 offen offset:0 lds
  ds_read_b64_tr_b16 a[74:75], v194 offset:36864
  v_mfma_f32_16x16x32_bf16 v[36:39], a[116:119], a[152:155], v[36:39]
  ds_read_b64_tr_b16 a[76:77], v195 offset:32768
  s_waitcnt lgkmcnt(11)
  ds_read_b64_tr_b16 a[78:79], v195 offset:36864
L_pg0:
  s_cbranch_execz L_pg4
  v_mfma_f32_16x16x32_bf16 v[44:47], a[116:119], a[156:159], v[44:47]
  buffer_load_dwordx4 v219, s[20:23], s54 offen offset:1024 lds
  v_mfma_f32_16x16x32_bf16 v[48:51], a[120:123], a[152:155], v[48:51]
  ds_read_b64_tr_b16 a[80:81], v196 offset:32768
  ds_read_b64_tr_b16 a[82:83], v196 offset:36864
  v_mfma_f32_16x16x32_bf16 v[56:59], a[120:123], a[156:159], v[56:59]
  ds_read_b64_tr_b16 a[84:85], v197 offset:32768
  s_waitcnt lgkmcnt(8)
  ds_read_b64_tr_b16 a[86:87], v197 offset:36864
  v_mfma_f32_16x16x32_bf16 v[52:55], a[124:127], a[152:155], v[52:55]
  buffer_load_dwordx4 v220, s[20:23], s54 offen offset:2048 lds
  v_mfma_f32_16x16x32_bf16 v[60:63], a[124:127], a[156:159], v[60:63]
  ds_read_b64_tr_b16 a[88:89], v198 offset:32768
  ds_read_b64_tr_b16 a[90:91], v198 offset:36864
  v_mfma_f32_16x16x32_bf16 v[0:3], a[64:67], a[160:163], v[0:3]
  buffer_load_dwordx4 v221, s[20:23], s54 offen offset:3072 lds
  v_mfma_f32_16x16x32_bf16 v[8:11], a[64:67], a[164:167], v[8:11]
  s_waitcnt lgkmcnt(6)
  v_accvgpr_read_b32 v251, a175
  ds_read_b64_tr_b16 a[92:93], v199 offset:32768
  v_mfma_f32_16x16x32_bf16 v[4:7], a[68:71], a[160:163], v[4:7]
  s_add_u32 m0, s45, 131072
  ds_read_b64_tr_b16 a[94:95], v199 offset:36864
  v_mfma_f32_16x16x32_bf16 v[12:15], a[68:71], a[164:167], v[12:15]
  s_add_u32 s53, s53, 128
  s_and_b32 s53, s53, 0x3ff
  v_mfma_f32_16x16x32_bf16 v[16:19], a[72:75], a[160:163], v[16:19]
  ds_read_b64_tr_b16 a[96:97], v192 offset:40960
  ds_read_b64_tr_b16 a[98:99], v192 offset:45056
  v_mfma_f32_16x16x32_bf16 v[24:27], a[72:75], a[164:167], v[24:27]
  buffer_load_dwordx4 v222, s[8:11], s53 offen offset:0 lds
  v_mfma_f32_16x16x32_bf16 v[20:23], a[76:79], a[160:163], v[20:23]
  ds_read_b64_tr_b16 a[100:101], v193 offset:40960
  ds_read_b64_tr_b16 a[102:103], v193 offset:45056
  v_mfma_f32_16x16x32_bf16 v[28:31], a[76:79], a[164:167], v[28:31]
  buffer_load_dwordx4 v223, s[8:11], s53 offen offset:1024 lds
  s_waitcnt lgkmcnt(5)
  v_mfma_f32_16x16x32_bf16 v[32:35], a[80:83], a[160:163], v[32:35]
  ds_read_b64_tr_b16 a[104:105], v194 offset:40960
  ds_read_b64_tr_b16 a[106:107], v194 offset:45056
  v_mfma_f32_16x16x32_bf16 v[40:43], a[80:83], a[164:167], v[40:43]
  ds_read_b64_tr_b16 a[108:109], v195 offset:40960
  ds_read_b64_tr_b16 a[110:111], v195 offset:45056
  v_mfma_f32_16x16x32_bf16 v[36:39], a[84:87], a[160:163], v[36:39]
  buffer_load_dwordx4 v224, s[8:11], s53 offen offset:2048 lds
  v_mfma_f32_16x16x32_bf16 v[44:47], a[84:87], a[164:167], v[44:47]
  ds_read_b64_tr_b16 a[112:113], v196 offset:40960
  ds_read_b64_tr_b16 a[114:115], v196 offset:45056
  v_mfma_f32_16x16x32_bf16 v[48:51], a[88:91], a[160:163], v[48:51]
  buffer_load_dwordx4 v225, s[8:11], s53 offen offset:3072 lds
  v_mfma_f32_16x16x32_bf16 v[56:59], a[88:91], a[164:167], v[56:59]
  s_add_u32 s51, s73, 0
  ds_read_b64_tr_b16 a[116:117], v197 offset:40960
  s_waitcnt lgkmcnt(7)
  v_mfma_f32_16x16x32_bf16 v[52:55], a[92:95], a[160:163], v[52:55]
  ds_read_b64_tr_b16 a[118:119], v197 offset:45056
  ds_read_b64_tr_b16 a[120:121], v198 offset:40960
  v_mfma_f32_16x16x32_bf16 v[60:63], a[92:95], a[164:167], v[60:63]
  buffer_store_dwordx4 v[160:163], v230, s[36:39], s51 offen offset:0 sc1
  v_mfma_f32_16x16x32_bf16 v[0:3], a[96:99], a[168:171], v[0:3]
  s_add_u32 s51, s73, 896
  ds_read_b64_tr_b16 a[122:123], v198 offset:45056
  v_mfma_f32_16x16x32_bf16 v[8:11], a[96:99], a[172:175], v[8:11]
  buffer_store_dwordx4 v[160:163], v230, s[36:39], s51 offen offset:0 sc1
  v_mfma_f32_16x16x32_bf16 v[4:7], a[100:103], a[168:171], v[4:7]
  ds_read_b64_tr_b16 a[124:125], v199 offset:40960
  ds_read_b64_tr_b16 a[126:127], v199 offset:45056
  v_mfma_f32_16x16x32_bf16 v[12:15], a[100:103], a[172:175], v[12:15]
  s_waitcnt vmcnt(12)
  s_barrier
  s_waitcnt lgkmcnt(5)
  v_mfma_f32_16x16x32_bf16 v[16:19], a[104:107], a[168:171], v[16:19]
  s_add_u32 m0, s45, 32768
  s_add_u32 s54, s54, 524288
  v_mfma_f32_16x16x32_bf16 v[24:27], a[104:107], a[172:175], v[24:27]
  ds_read_b128 a[176:179], v226 offset:16384
  ds_read_b128 a[180:183], v226 offset:18432
  ds_read_b64_tr_b16 a[64:65], v192 offset:49152
  ds_read_b64_tr_b16 a[66:67], v192 offset:53248
  v_mfma_f32_16x16x32_bf16 v[20:23], a[108:111], a[168:171], v[20:23]
  s_and_b32 s54, s54, 0x3fffff
  ds_read_b64_tr_b16 a[68:69], v193 offset:49152
  v_mfma_f32_16x16x32_bf16 v[28:31], a[108:111], a[172:175], v[28:31]
  ds_read_b64_tr_b16 a[70:71], v193 offset:53248
  ds_read_b128 a[184:187], v227 offset:16384
  v_mfma_f32_16x16x32_bf16 v[32:35], a[112:115], a[168:171], v[32:35]
  ds_read_b128 a[188:191], v227 offset:18432
  ds_read_b64_tr_b16 a[72:73], v194 offset:49152
  v_mfma_f32_16x16x32_bf16 v[40:43], a[112:115], a[172:175], v[40:43]
  buffer_load_dwordx4 v218, s[20:23], s54 offen offset:0 lds
  ds_read_b64_tr_b16 a[74:75], v194 offset:53248
  s_waitcnt lgkmcnt(10)
  v_mfma_f32_16x16x32_bf16 v[36:39], a[116:119], a[168:171], v[36:39]
  ds_read_b64_tr_b16 a[76:77], v195 offset:49152
  ds_read_b64_tr_b16 a[78:79], v195 offset:53248
  v_mfma_f32_16x16x32_bf16 v[44:47], a[116:119], a[172:175], v[44:47]
  buffer_load_dwordx4 v219, s[20:23], s54 offen offset:1024 lds
  v_mfma_f32_16x16x32_bf16 v[48:51], a[120:123], a[168:171], v[48:51]
  ds_read_b64_tr_b16 a[80:81], v196 offset:49152
  ds_read_b64_tr_b16 a[82:83], v196 offset:53248
  v_mfma_f32_16x16x32_bf16 v[56:59], a[120:123], a[172:175], v[56:59]
  ds_read_b64_tr_b16 a[84:85], v197 offset:49152
  s_waitcnt lgkmcnt(8)
  ds_read_b64_tr_b16 a[86:87], v197 offset:53248
  v_mfma_f32_16x16x32_bf16 v[52:55], a[124:127], a[168:171], v[52:55]
  buffer_load_dwordx4 v220, s[20:23], s54 offen offset:2048 lds
  v_mfma_f32_16x16x32_bf16 v[60:63], a[124:127], a[172:175], v[60:63]
  ds_read_b64_tr_b16 a[88:89], v198 offset:49152
  ds_read_b64_tr_b16 a[90:91], v198 offset:53248
  v_mfma_f32_16x16x32_bf16 v[0:3], a[64:67], a[176:179], v[0:3]
  buffer_load_dwordx4 v221, s[20:23], s54 offen offset:3072 lds
  v_mfma_f32_16x16x32_bf16 v[8:11], a[64:67], a[180:183], v[8:11]
  s_waitcnt lgkmcnt(6)
  v_accvgpr_read_b32 v251, a191
  ds_read_b64_tr_b16 a[92:93], v199 offset:49152
  v_mfma_f32_16x16x32_bf16 v[4:7], a[68:71], a[176:179], v[4:7]
  s_add_u32 m0, s45, 147456
  ds_read_b64_tr_b16 a[94:95], v199 offset:53248
  v_mfma_f32_16x16x32_bf16 v[12:15], a[68:71], a[180:183], v[12:15]
  s_add_u32 s53, s53, 128
  s_and_b32 s53, s53, 0x3ff
  v_mfma_f32_16x16x32_bf16 v[16:19], a[72:75], a[176:179], v[16:19]
  ds_read_b64_tr_b16 a[96:97], v192 offset:57344
  ds_read_b64_tr_b16 a[98:99], v192 offset:61440
  v_mfma_f32_16x16x32_bf16 v[24:27], a[72:75], a[180:183], v[24:27]
  buffer_load_dwordx4 v222, s[8:11], s53 offen offset:0 lds
  v_mfma_f32_16x16x32_bf16 v[20:23], a[76:79], a[176:179], v[20:23]
  ds_read_b64_tr_b16 a[100:101], v193 offset:57344
  ds_read_b64_tr_b16 a[102:103], v193 offset:61440
  v_mfma_f32_16x16x32_bf16 v[28:31], a[76:79], a[180:183], v[28:31]
  buffer_load_dwordx4 v223, s[8:11], s53 offen offset:1024 lds
  s_waitcnt lgkmcnt(5)
  v_mfma_f32_16x16x32_bf16 v[32:35], a[80:83], a[176:179], v[32:35]
  ds_read_b64_tr_b16 a[104:105], v194 offset:57344
  ds_read_b64_tr_b16 a[106:107], v194 offset:61440
  v_mfma_f32_16x16x32_bf16 v[40:43], a[80:83], a[180:183], v[40:43]
  ds_read_b64_tr_b16 a[108:109], v195 offset:57344
  ds_read_b64_tr_b16 a[110:111], v195 offset:61440
  v_mfma_f32_16x16x32_bf16 v[36:39], a[84:87], a[176:179], v[36:39]
  buffer_load_dwordx4 v224, s[8:11], s53 offen offset:2048 lds
  v_mfma_f32_16x16x32_bf16 v[44:47], a[84:87], a[180:183], v[44:47]
  ds_read_b64_tr_b16 a[112:113], v196 offset:57344
  ds_read_b64_tr_b16 a[114:115], v196 offset:61440
  v_mfma_f32_16x16x32_bf16 v[48:51], a[88:91], a[176:179], v[48:51]
  buffer_load_dwordx4 v225, s[8:11], s53 offen offset:3072 lds
  v_mfma_f32_16x16x32_bf16 v[56:59], a[88:91], a[180:183], v[56:59]
  s_add_u32 s51, s74, 0
  ds_read_b64_tr_b16 a[116:117], v197 offset:57344
  s_waitcnt lgkmcnt(7)
  v_mfma_f32_16x16x32_bf16 v[52:55], a[92:95], a[176:179], v[52:55]
  ds_read_b64_tr_b16 a[118:119], v197 offset:61440
  ds_read_b64_tr_b16 a[120:121], v198 offset:57344
  v_mfma_f32_16x16x32_bf16 v[60:63], a[92:95], a[180:183], v[60:63]
  buffer_store_dwordx4 v[160:163], v230, s[36:39], s51 offen offset:0 sc1
  v_mfma_f32_16x16x32_bf16 v[0:3], a[96:99], a[184:187], v[0:3]
  s_add_u32 s51, s74, 896
  ds_read_b64_tr_b16 a[122:123], v198 offset:61440
  v_mfma_f32_16x16x32_bf16 v[8:11], a[96:99], a[188:191], v[8:11]
  buffer_store_dwordx4 v[160:163], v230, s[36:39], s51 offen offset:0 sc1
  v_mfma_f32_16x16x32_bf16 v[4:7], a[100:103], a[184:187], v[4:7]
  ds_read_b64_tr_b16 a[124:125], v199 offset:57344
  ds_read_b64_tr_b16 a[126:127], v199 offset:61440
  v_mfma_f32_16x16x32_bf16 v[12:15], a[100:103], a[188:191], v[12:15]
  s_waitcnt vmcnt(12)
  s_barrier
  s_waitcnt lgkmcnt(5)
  v_mfma_f32_16x16x32_bf16 v[16:19], a[104:107], a[184:187], v[16:19]
  s_add_u32 m0, s45, 98304
  s_add_u32 s54, s54, 524288
  v_mfma_f32_16x16x32_bf16 v[24:27], a[104:107], a[188:191], v[24:27]
  ds_read_b128 a[192:195], v226 offset:0
  ds_read_b128 a[196:199], v226 offset:2048
  ds_read_b64_tr_b16 a[64:65], v184 offset:16384
  ds_read_b64_tr_b16 a[66:67], v184 offset:20480
  v_mfma_f32_16x16x32_bf16 v[20:23], a[108:111], a[184:187], v[20:23]
  s_and_b32 s54, s54, 0x3fffff
  ds_read_b64_tr_b16 a[68:69], v185 offset:16384
  v_mfma_f32_16x16x32_bf16 v[28:31], a[108:111], a[188:191], v[28:31]
  ds_read_b64_tr_b16 a[70:71], v185 offset:20480
  ds_read_b128 a[200:203], v227 offset:0
  v_mfma_f32_16x16x32_bf16 v[32:35], a[112:115], a[184:187], v[32:35]
  ds_read_b128 a[204:207], v227 offset:2048
  ds_read_b64_tr_b16 a[72:73], v186 offset:16384
  v_mfma_f32_16x16x32_bf16 v[40:43], a[112:115], a[188:191], v[40:43]
  buffer_load_dwordx4 v218, s[20:23], s54 offen offset:0 lds
  ds_read_b64_tr_b16 a[74:75], v186 offset:20480
  s_waitcnt lgkmcnt(10)
  v_mfma_f32_16x16x32_bf16 v[36:39], a[116:119], a[184:187], v[36:39]
  ds_read_b64_tr_b16 a[76:77], v187 offset:16384
  ds_read_b64_tr_b16 a[78:79], v187 offset:20480
  v_mfma_f32_16x16x32_bf16 v[44:47], a[116:119], a[188:191], v[44:47]
  buffer_load_dwordx4 v219, s[20:23], s54 offen offset:1024 lds
  v_mfma_f32_16x16x32_bf16 v[48:51], a[120:123], a[184:187], v[48:51]
  ds_read_b64_tr_b16 a[80:81], v188 offset:16384
  ds_read_b64_tr_b16 a[82:83], v188 offset:20480
  v_mfma_f32_16x16x32_bf16 v[56:59], a[120:123], a[188:191], v[56:59]
  ds_read_b64_tr_b16 a[84:85], v189 offset:16384
  s_waitcnt lgkmcnt(8)
  ds_read_b64_tr_b16 a[86:87], v189 offset:20480
  v_mfma_f32_16x16x32_bf16 v[52:55], a[124:127], a[184:187], v[52:55]
  buffer_load_dwordx4 v220, s[20:23], s54 offen offset:2048 lds
  v_mfma_f32_16x16x32_bf16 v[60:63], a[124:127], a[188:191], v[60:63]
  ds_read_b64_tr_b16 a[88:89], v190 offset:16384
  ds_read_b64_tr_b16 a[90:91], v190 offset:20480
  v_mfma_f32_16x16x32_bf16 v[0:3], a[64:67], a[192:195], v[0:3]
  ds_read_b64_tr_b16 a[92:93], v191 offset:16384
  ds_read_b64_tr_b16 a[94:95], v191 offset:20480
  v_mfma_f32_16x16x32_bf16 v[8:11], a[64:67], a[196:199], v[8:11]
  buffer_load_dwordx4 v221, s[20:23], s54 offen offset:3072 lds
  v_mfma_f32_16x16x32_bf16 v[4:7], a[68:71], a[192:195], v[4:7]
  s_waitcnt lgkmcnt(6)
  v_accvgpr_read_b32 v251, a207
  ds_read_b64_tr_b16 a[96:97], v184 offset:24576
  v_mfma_f32_16x16x32_bf16 v[12:15], a[68:71], a[196:199], v[12:15]
  s_add_u32 m0, s45, 131072
  ds_read_b64_tr_b16 a[98:99], v184 offset:28672
  v_mfma_f32_16x16x32_bf16 v[16:19], a[72:75], a[192:195], v[16:19]
  s_add_u32 s53, s53, 128
  ds_read_b64_tr_b16 a[100:101], v185 offset:24576
  v_mfma_f32_16x16x32_bf16 v[24:27], a[72:75], a[196:199], v[24:27]
  s_and_b32 s53, s53, 0x3ff
  ds_read_b64_tr_b16 a[102:103], v185 offset:28672
  v_mfma_f32_16x16x32_bf16 v[20:23], a[76:79], a[192:195], v[20:23]
  buffer_load_dwordx4 v222, s[8:11], s53 offen offset:0 lds
  v_mfma_f32_16x16x32_bf16 v[28:31], a[76:79], a[196:199], v[28:31]
  ds_read_b64_tr_b16 a[104:105], v186 offset:24576
  ds_read_b64_tr_b16 a[106:107], v186 offset:28672
  v_mfma_f32_16x16x32_bf16 v[32:35], a[80:83], a[192:195], v[32:35]
  ds_read_b64_tr_b16 a[108:109], v187 offset:24576
  ds_read_b64_tr_b16 a[110:111], v187 offset:28672
  v_mfma_f32_16x16x32_bf16 v[40:43], a[80:83], a[196:199], v[40:43]
  buffer_load_dwordx4 v223, s[8:11], s53 offen offset:1024 lds
  s_waitcnt lgkmcnt(6)
  v_mfma_f32_16x16x32_bf16 v[36:39], a[84:87], a[192:195], v[36:39]
  ds_read_b64_tr_b16 a[112:113], v188 offset:24576
  ds_read_b64_tr_b16 a[114:115], v188 offset:28672
  v_mfma_f32_16x16x32_bf16 v[44:47], a[84:87], a[196:199], v[44:47]
  ds_read_b64_tr_b16 a[116:117], v189 offset:24576
  ds_read_b64_tr_b16 a[118:119], v189 offset:28672
  v_mfma_f32_16x16x32_bf16 v[48:51], a[88:91], a[192:195], v[48:51]
  buffer_load_dwordx4 v224, s[8:11], s53 offen offset:2048 lds
  v_mfma_f32_16x16x32_bf16 v[56:59], a[88:91], a[196:199], v[56:59]
  ds_read_b64_tr_b16 a[120:121], v190 offset:24576
  ds_read_b64_tr_b16 a[122:123], v190 offset:28672
  v_mfma_f32_16x16x32_bf16 v[52:55], a[92:95], a[192:195], v[52:55]
  v_mfma_f32_16x16x32_bf16 v[60:63], a[92:95], a[196:199], v[60:63]
  ds_read_b64_tr_b16 a[124:125], v191 offset:24576
  ds_read_b64_tr_b16 a[126:127], v191 offset:28672
  v_mfma_f32_16x16x32_bf16 v[0:3], a[96:99], a[200:203], v[0:3]
  buffer_load_dwordx4 v225, s[8:11], s53 offen offset:3072 lds
  v_mfma_f32_16x16x32_bf16 v[8:11], a[96:99], a[204:207], v[8:11]
  s_waitcnt lgkmcnt(4)
  v_mfma_f32_16x16x32_bf16 v[4:7], a[100:103], a[200:203], v[4:7]
  v_mfma_f32_16x16x32_bf16 v[12:15], a[100:103], a[204:207], v[12:15]
  s_waitcnt vmcnt(10)
  s_barrier
  v_mfma_f32_16x16x32_bf16 v[16:19], a[104:107], a[200:203], v[16:19]
  s_add_u32 m0, s45, 114688
  s_add_u32 s54, s54, 524288
  v_mfma_f32_16x16x32_bf16 v[24:27], a[104:107], a[204:207], v[24:27]
  ds_read_b128 a[208:211], v226 offset:16384
  ds_read_b128 a[212:215], v226 offset:18432
  ds_read_b64_tr_b16 a[64:65], v184 offset:32768
  ds_read_b64_tr_b16 a[66:67], v184 offset:36864
  v_mfma_f32_16x16x32_bf16 v[20:23], a[108:111], a[200:203], v[20:23]
  s_and_b32 s54, s54, 0x3fffff
  ds_read_b64_tr_b16 a[68:69], v185 offset:32768
  v_mfma_f32_16x16x32_bf16 v[28:31], a[108:111], a[204:207], v[28:31]
  ds_read_b64_tr_b16 a[70:71], v185 offset:36864
  ds_read_b128 a[216:219], v227 offset:16384
  v_mfma_f32_16x16x32_bf16 v[32:35], a[112:115], a[200:203], v[32:35]
  ds_read_b128 a[220:223], v227 offset:18432
  ds_read_b64_tr_b16 a[72:73], v186 offset:32768
  v_mfma_f32_16x16x32_bf16 v[40:43], a[112:115], a[204:207], v[40:43]
  buffer_load_dwordx4 v218, s[20:23], s54 offen offset:0 lds
  ds_read_b64_tr_b16 a[74:75], v186 offset:36864
  v_mfma_f32_16x16x32_bf16 v[36:39], a[116:119], a[200:203], v[36:39]
  ds_read_b64_tr_b16 a[76:77], v187 offset:32768
  s_waitcnt lgkmcnt(11)
  ds_read_b64_tr_b16 a[78:79], v187 offset:36864
  v_mfma_f32_16x16x32_bf16 v[44:47], a[116:119], a[204:207], v[44:47]
  buffer_load_dwordx4 v219, s[20:23], s54 offen offset:1024 lds
  v_mfma_f32_16x16x32_bf16 v[48:51], a[120:123], a[200:203], v[48:51]
  ds_read_b64_tr_b16 a[80:81], v188 offset:32768
  ds_read_b64_tr_b16 a[82:83], v188 offset:36864
  v_mfma_f32_16x16x32_bf16 v[56:59], a[120:123], a[204:207], v[56:59]
  buffer_load_dwordx4 v220, s[20:23], s54 offen offset:2048 lds
  v_mfma_f32_16x16x32_bf16 v[52:55], a[124:127], a[200:203], v[52:55]
  ds_read_b64_tr_b16 a[84:85], v189 offset:32768
  s_waitcnt lgkmcnt(6)
  ds_read_b64_tr_b16 a[86:87], v189 offset:36864
  v_mfma_f32_16x16x32_bf16 v[60:63], a[124:127], a[204:207], v[60:63]
  buffer_load_dwordx4 v221, s[20:23], s54 offen offset:3072 lds
  v_mfma_f32_16x16x32_bf16 v[0:3], a[64:67], a[208:211], v[0:3]
  v_accvgpr_read_b32 v251, a223
  ds_read_b64_tr_b16 a[88:89], v190 offset:32768
  v_mfma_f32_16x16x32_bf16 v[8:11], a[64:67], a[212:215], v[8:11]
  s_add_u32 m0, s45, 147456
  s_add_u32 s53, s53, 128
  s_and_b32 s53, s53, 0x3ff
  ds_read_b64_tr_b16 a[90:91], v190 offset:36864
  v_mfma_f32_16x16x32_bf16 v[4:7], a[68:71], a[208:211], v[4:7]
  ds_read_b64_tr_b16 a[92:93], v191 offset:32768
  ds_read_b64_tr_b16 a[94:95], v191 offset:36864
  v_mfma_f32_16x16x32_bf16 v[12:15], a[68:71], a[212:215], v[12:15]
  buffer_load_dwordx4 v222, s[8:11], s53 offen offset:0 lds
  s_waitcnt lgkmcnt(6)
  v_mfma_f32_16x16x32_bf16 v[16:19], a[72:75], a[208:211], v[16:19]
  ds_read_b64_tr_b16 a[96:97], v184 offset:40960
  ds_read_b64_tr_b16 a[98:99], v184 offset:45056
  v_mfma_f32_16x16x32_bf16 v[24:27], a[72:75], a[212:215], v[24:27]
  buffer_load_dwordx4 v223, s[8:11], s53 offen offset:1024 lds
  v_mfma_f32_16x16x32_bf16 v[20:23], a[76:79], a[208:211], v[20:23]
  ds_read_b64_tr_b16 a[100:101], v185 offset:40960
  ds_read_b64_tr_b16 a[102:103], v185 offset:45056
  v_mfma_f32_16x16x32_bf16 v[28:31], a[76:79], a[212:215], v[28:31]
  buffer_load_dwordx4 v224, s[8:11], s53 offen offset:2048 lds
  v_mfma_f32_16x16x32_bf16 v[32:35], a[80:83], a[208:211], v[32:35]
  ds_read_b64_tr_b16 a[104:105], v186 offset:40960
  ds_read_b64_tr_b16 a[106:107], v186 offset:45056
  v_mfma_f32_16x16x32_bf16 v[40:43], a[80:83], a[212:215], v[40:43]
  buffer_load_dwordx4 v225, s[8:11], s53 offen offset:3072 lds
  s_waitcnt lgkmcnt(6)
  v_mfma_f32_16x16x32_bf16 v[36:39], a[84:87], a[208:211], v[36:39]
  s_add_u32 m0, s45, 49152
  ds_read_b64_tr_b16 a[108:109], v187 offset:40960
  v_mfma_f32_16x16x32_bf16 v[44:47], a[84:87], a[212:215], v[44:47]
  s_add_u32 s54, s54, 524544
  s_and_b32 s54, s54, 0x3fffff
  ds_read_b64_tr_b16 a[110:111], v187 offset:45056
  v_mfma_f32_16x16x32_bf16 v[48:51], a[88:91], a[208:211], v[48:51]
  ds_read_b64_tr_b16 a[112:113], v188 offset:40960
  ds_read_b64_tr_b16 a[114:115], v188 offset:45056
  v_mfma_f32_16x16x32_bf16 v[56:59], a[88:91], a[212:215], v[56:59]
  buffer_load_dwordx4 v218, s[20:23], s54 offen offset:0 lds
  v_mfma_f32_16x16x32_bf16 v[52:55], a[92:95], a[208:211], v[52:55]
  ds_read_b64_tr_b16 a[116:117], v189 offset:40960
  ds_read_b64_tr_b16 a[118:119], v189 offset:45056
  v_mfma_f32_16x16x32_bf16 v[60:63], a[92:95], a[212:215], v[60:63]
  buffer_load_dwordx4 v219, s[20:23], s54 offen offset:1024 lds
  s_waitcnt lgkmcnt(6)
  v_mfma_f32_16x16x32_bf16 v[0:3], a[96:99], a[216:219], v[0:3]
  ds_read_b64_tr_b16 a[120:121], v190 offset:40960
  ds_read_b64_tr_b16 a[122:123], v190 offset:45056
  v_mfma_f32_16x16x32_bf16 v[8:11], a[96:99], a[220:223], v[8:11]
  buffer_load_dwordx4 v220, s[20:23], s54 offen offset:2048 lds
  buffer_load_dwordx4 v221, s[20:23], s54 offen offset:3072 lds
  v_mfma_f32_16x16x32_bf16 v[4:7], a[100:103], a[216:219], v[4:7]
  ds_read_b64_tr_b16 a[124:125], v191 offset:40960
  ds_read_b64_tr_b16 a[126:127], v191 offset:45056
  v_mfma_f32_16x16x32_bf16 v[12:15], a[100:103], a[220:223], v[12:15]
  s_waitcnt vmcnt(12)
  s_barrier
  v_mfma_f32_16x16x32_bf16 v[16:19], a[104:107], a[216:219], v[16:19]
  v_mfma_f32_16x16x32_bf16 v[24:27], a[104:107], a[220:223], v[24:27]
  ds_read_b128 a[224:227], v226 offset:0
  ds_read_b128 a[228:231], v226 offset:2048
  ds_read_b64_tr_b16 a[64:65], v192 offset:32768
  ds_read_b64_tr_b16 a[66:67], v192 offset:36864
  s_waitcnt lgkmcnt(8)
  v_mfma_f32_16x16x32_bf16 v[20:23], a[108:111], a[216:219], v[20:23]
  ds_read_b64_tr_b16 a[68:69], v193 offset:32768
  ds_read_b64_tr_b16 a[70:71], v193 offset:36864
  v_mfma_f32_16x16x32_bf16 v[28:31], a[108:111], a[220:223], v[28:31]
  ds_read_b128 a[232:235], v227 offset:0
  ds_read_b128 a[236:239], v227 offset:2048
  v_mfma_f32_16x16x32_bf16 v[32:35], a[112:115], a[216:219], v[32:35]
  ds_read_b64_tr_b16 a[72:73], v194 offset:32768
  ds_read_b64_tr_b16 a[74:75], v194 offset:36864
  v_mfma_f32_16x16x32_bf16 v[40:43], a[112:115], a[220:223], v[40:43]
  s_lshl_b32 s50, s41, 4
  s_mov_b32 s62, 1
  s_cmp_lg_u32 s40, 0
  s_cbranch_scc1 L_noadd_24
  s_atomic_add s62, s[32:33], s50
L_noadd_24:
  v_mfma_f32_16x16x32_bf16 v[36:39], a[116:119], a[216:219], v[36:39]
  ds_read_b64_tr_b16 a[76:77], v195 offset:32768
  s_waitcnt lgkmcnt(11)
  ds_read_b64_tr_b16 a[78:79], v195 offset:36864
  v_mfma_f32_16x16x32_bf16 v[44:47], a[116:119], a[220:223], v[44:47]
  ds_read_b64_tr_b16 a[80:81], v196 offset:32768
  ds_read_b64_tr_b16 a[82:83], v196 offset:36864
  v_mfma_f32_16x16x32_bf16 v[48:51], a[120:123], a[216:219], v[48:51]
  ds_read_b64_tr_b16 a[84:85], v197 offset:32768
  s_waitcnt lgkmcnt(9)
  ds_read_b64_tr_b16 a[86:87], v197 offset:36864
  v_mfma_f32_16x16x32_bf16 v[56:59], a[120:123], a[220:223], v[56:59]
  ds_read_b64_tr_b16 a[88:89], v198 offset:32768
  ds_read_b64_tr_b16 a[90:91], v198 offset:36864
  v_mfma_f32_16x16x32_bf16 v[52:55], a[124:127], a[216:219], v[52:55]
  v_mfma_f32_16x16x32_bf16 v[60:63], a[124:127], a[220:223], v[60:63]
  ds_read_b64_tr_b16 a[92:93], v199 offset:32768
  ds_read_b64_tr_b16 a[94:95], v199 offset:36864
  v_mfma_f32_16x16x32_bf16 v[0:3], a[64:67], a[224:227], v[0:3]
  v_mfma_f32_16x16x32_bf16 v[8:11], a[64:67], a[228:231], v[8:11]
  s_waitcnt lgkmcnt(6)
  v_accvgpr_read_b32 v251, a239
  ds_read_b64_tr_b16 a[96:97], v192 offset:40960
  v_mfma_f32_16x16x32_bf16 v[4:7], a[68:71], a[224:227], v[4:7]
  s_add_u32 m0, s45, 131072
  ds_read_b64_tr_b16 a[98:99], v192 offset:45056
  v_mfma_f32_16x16x32_bf16 v[12:15], a[68:71], a[228:231], v[12:15]
  s_add_u32 s54, s54, 524288
  s_and_b32 s54, s54, 0x3fffff
  v_mfma_f32_16x16x32_bf16 v[16:19], a[72:75], a[224:227], v[16:19]
  buffer_load_dwordx4 v218, s[20:23], s54 offen offset:0 lds
  v_mfma_f32_16x16x32_bf16 v[24:27], a[72:75], a[228:231], v[24:27]
  ds_read_b64_tr_b16 a[100:101], v193 offset:40960
  ds_read_b64_tr_b16 a[102:103], v193 offset:45056
  v_mfma_f32_16x16x32_bf16 v[20:23], a[76:79], a[224:227], v[20:23]
  ds_read_b64_tr_b16 a[104:105], v194 offset:40960
  ds_read_b64_tr_b16 a[106:107], v194 offset:45056
  v_mfma_f32_16x16x32_bf16 v[28:31], a[76:79], a[228:231], v[28:31]
  buffer_load_dwordx4 v219, s[20:23], s54 offen offset:1024 lds
  v_mfma_f32_16x16x32_bf16 v[32:35], a[80:83], a[224:227], v[32:35]
  ds_read_b64_tr_b16 a[108:109], v195 offset:40960
  ds_read_b64_tr_b16 a[110:111], v195 offset:45056
  v_mfma_f32_16x16x32_bf16 v[40:43], a[80:83], a[228:231], v[40:43]
  ds_read_b64_tr_b16 a[112:113], v196 offset:40960
  s_waitcnt lgkmcnt(7)
  ds_read_b64_tr_b16 a[114:115], v196 offset:45056
  v_mfma_f32_16x16x32_bf16 v[36:39], a[84:87], a[224:227], v[36:39]
  buffer_load_dwordx4 v220, s[20:23], s54 offen offset:2048 lds
  v_mfma_f32_16x16x32_bf16 v[44:47], a[84:87], a[228:231], v[44:47]
  ds_read_b64_tr_b16 a[116:117], v197 offset:40960
  ds_read_b64_tr_b16 a[118:119], v197 offset:45056
  v_mfma_f32_16x16x32_bf16 v[48:51], a[88:91], a[224:227], v[48:51]
  v_mfma_f32_16x16x32_bf16 v[56:59], a[88:91], a[228:231], v[56:59]
  ds_read_b64_tr_b16 a[120:121], v198 offset:40960
  ds_read_b64_tr_b16 a[122:123], v198 offset:45056
  v_mfma_f32_16x16x32_bf16 v[52:55], a[92:95], a[224:227], v[52:55]
  buffer_load_dwordx4 v221, s[20:23], s54 offen offset:3072 lds
  v_mfma_f32_16x16x32_bf16 v[60:63], a[92:95], a[228:231], v[60:63]
  ds_read_b64_tr_b16 a[124:125], v199 offset:40960
  ds_read_b64_tr_b16 a[126:127], v199 offset:45056
  v_mfma_f32_16x16x32_bf16 v[0:3], a[96:99], a[232:235], v[0:3]
  v_mfma_f32_16x16x32_bf16 v[8:11], a[96:99], a[236:239], v[8:11]
  s_waitcnt lgkmcnt(4)
  v_mfma_f32_16x16x32_bf16 v[4:7], a[100:103], a[232:235], v[4:7]
  v_mfma_f32_16x16x32_bf16 v[12:15], a[100:103], a[236:239], v[12:15]
  s_waitcnt vmcnt(8)
  s_barrier
  v_mfma_f32_16x16x32_bf16 v[16:19], a[104:107], a[232:235], v[16:19]
  v_mfma_f32_16x16x32_bf16 v[24:27], a[104:107], a[236:239], v[24:27]
  ds_read_b128 a[240:243], v226 offset:16384
  ds_read_b128 a[244:247], v226 offset:18432
  ds_read_b64_tr_b16 a[64:65], v192 offset:49152
  ds_read_b64_tr_b16 a[66:67], v192 offset:53248
  v_mfma_f32_16x16x32_bf16 v[20:23], a[108:111], a[232:235], v[20:23]
  ds_read_b64_tr_b16 a[68:69], v193 offset:49152
  ds_read_b64_tr_b16 a[70:71], v193 offset:53248
  v_mfma_f32_16x16x32_bf16 v[28:31], a[108:111], a[236:239], v[28:31]
  ds_read_b128 a[248:251], v227 offset:16384
  ds_read_b128 a[252:255], v227 offset:18432
  v_mfma_f32_16x16x32_bf16 v[32:35], a[112:115], a[232:235], v[32:35]
  ds_read_b64_tr_b16 a[72:73], v192 offset:57344
  ds_read_b64_tr_b16 a[74:75], v192 offset:61440
  v_mfma_f32_16x16x32_bf16 v[40:43], a[112:115], a[236:239], v[40:43]
  ds_read_b64_tr_b16 a[76:77], v193 offset:57344
  s_waitcnt lgkmcnt(11)
  ds_read_b64_tr_b16 a[78:79], v193 offset:61440
  v_mfma_f32_16x16x32_bf16 v[36:39], a[116:119], a[232:235], v[36:39]
  ds_read_b64_tr_b16 a[80:81], v194 offset:49152
  ds_read_b64_tr_b16 a[82:83], v194 offset:53248
  v_mfma_f32_16x16x32_bf16 v[44:47], a[116:119], a[236:239], v[44:47]
  ds_read_b64_tr_b16 a[84:85], v195 offset:49152
  s_waitcnt lgkmcnt(11)
  ds_read_b64_tr_b16 a[86:87], v195 offset:53248
  v_mfma_f32_16x16x32_bf16 v[48:51], a[120:123], a[232:235], v[48:51]
  v_mfma_f32_16x16x32_bf16 v[56:59], a[120:123], a[236:239], v[56:59]
  ds_read_b64_tr_b16 a[88:89], v194 offset:57344
  ds_read_b64_tr_b16 a[90:91], v194 offset:61440
  v_mfma_f32_16x16x32_bf16 v[52:55], a[124:127], a[232:235], v[52:55]
  v_mfma_f32_16x16x32_bf16 v[60:63], a[124:127], a[236:239], v[60:63]
  ds_read_b64_tr_b16 a[92:93], v195 offset:57344
  s_waitcnt lgkmcnt(7)
  ds_read_b64_tr_b16 a[94:95], v195 offset:61440
  v_mfma_f32_16x16x32_bf16 v[0:3], a[64:67], a[240:243], v[0:3]
  v_mfma_f32_16x16x32_bf16 v[8:11], a[64:67], a[244:247], v[8:11]
  v_accvgpr_read_b32 v251, a255
  ds_read_b64_tr_b16 a[96:97], v196 offset:49152
  v_mfma_f32_16x16x32_bf16 v[4:7], a[68:71], a[240:243], v[4:7]
  s_add_u32 m0, s45, 147456
  ds_read_b64_tr_b16 a[98:99], v196 offset:53248
  v_mfma_f32_16x16x32_bf16 v[12:15], a[68:71], a[244:247], v[12:15]
  s_add_u32 s54, s54, 524288
  s_and_b32 s54, s54, 0x3fffff
  v_mfma_f32_16x16x32_bf16 v[0:3], a[72:75], a[248:251], v[0:3]
  buffer_load_dwordx4 v218, s[20:23], s54 offen offset:0 lds
  v_mfma_f32_16x16x32_bf16 v[8:11], a[72:75], a[252:255], v[8:11]
  ds_read_b64_tr_b16 a[100:101], v197 offset:49152
  ds_read_b64_tr_b16 a[102:103], v197 offset:53248
  v_mfma_f32_16x16x32_bf16 v[4:7], a[76:79], a[248:251], v[4:7]
  ds_read_b64_tr_b16 a[104:105], v196 offset:57344
  ds_read_b64_tr_b16 a[106:107], v196 offset:61440
  v_mfma_f32_16x16x32_bf16 v[12:15], a[76:79], a[252:255], v[12:15]
  buffer_load_dwordx4 v219, s[20:23], s54 offen offset:1024 lds
  s_waitcnt lgkmcnt(5)
  v_mfma_f32_16x16x32_bf16 v[16:19], a[80:83], a[240:243], v[16:19]
  ds_read_b64_tr_b16 a[108:109], v197 offset:57344
  ds_read_b64_tr_b16 a[110:111], v197 offset:61440
  v_mfma_f32_16x16x32_bf16 v[24:27], a[80:83], a[244:247], v[24:27]
  ds_read_b64_tr_b16 a[112:113], v198 offset:49152
  ds_read_b64_tr_b16 a[114:115], v198 offset:53248
  v_mfma_f32_16x16x32_bf16 v[20:23], a[84:87], a[240:243], v[20:23]
  buffer_load_dwordx4 v220, s[20:23], s54 offen offset:2048 lds
  v_mfma_f32_16x16x32_bf16 v[28:31], a[84:87], a[244:247], v[28:31]
  ds_read_b64_tr_b16 a[116:117], v199 offset:49152
  v_mul_f32 v0, s64, v0
  v_mfma_f32_16x16x32_bf16 v[16:19], a[88:91], a[248:251], v[16:19]
  ds_read_b64_tr_b16 a[118:119], v199 offset:53248
  v_mul_f32 v1, s64, v1
  v_mfma_f32_16x16x32_bf16 v[24:27], a[88:91], a[252:255], v[24:27]
  ds_read_b64_tr_b16 a[120:121], v198 offset:57344
  v_mul_f32 v2, s64, v2
  v_mfma_f32_16x16x32_bf16 v[20:23], a[92:95], a[248:251], v[20:23]
  ds_read_b64_tr_b16 a[122:123], v198 offset:61440
  v_mul_f32 v3, s64, v3
  v_mfma_f32_16x16x32_bf16 v[28:31], a[92:95], a[252:255], v[28:31]
  buffer_load_dwordx4 v221, s[20:23], s54 offen offset:3072 lds
  s_waitcnt lgkmcnt(4)
  v_mfma_f32_16x16x32_bf16 v[32:35], a[96:99], a[240:243], v[32:35]
  ds_read_b64_tr_b16 a[124:125], v199 offset:57344
  v_mul_f32 v4, s64, v4
  v_mfma_f32_16x16x32_bf16 v[40:43], a[96:99], a[244:247], v[40:43]
  ds_read_b64_tr_b16 a[126:127], v199 offset:61440
  v_mul_f32 v5, s64, v5
  v_mfma_f32_16x16x32_bf16 v[36:39], a[100:103], a[240:243], v[36:39]
  v_mul_f32 v6, s64, v6
  v_mul_f32 v7, s64, v7
  v_mfma_f32_16x16x32_bf16 v[44:47], a[100:103], a[244:247], v[44:47]
  s_waitcnt vmcnt(8)
  s_barrier
  v_mfma_f32_16x16x32_bf16 v[32:35], a[104:107], a[248:251], v[32:35]
  s_add_u32 m0, s45, 65536
  v_cvt_pk_bf16_f32 v0, v0, v1
  v_mfma_f32_16x16x32_bf16 v[40:43], a[104:107], a[252:255], v[40:43]
  ds_read_b64_tr_b16 a[64:65], v184 offset:49152
  ds_read_b64_tr_b16 a[66:67], v184 offset:53248
  v_mfma_f32_16x16x32_bf16 v[36:39], a[108:111], a[248:251], v[36:39]
L_pg1:
  s_cbranch_execz L_pg5
  ds_read_b64_tr_b16 a[68:69], v185 offset:49152
  v_cvt_pk_bf16_f32 v4, v4, v5
  v_mfma_f32_16x16x32_bf16 v[44:47], a[108:111], a[252:255], v[44:47]
  s_mov_b32 s55, 0
  ds_read_b64_tr_b16 a[70:71], v185 offset:53248
  v_mfma_f32_16x16x32_bf16 v[48:51], a[112:115], a[240:243], v[48:51]
  ds_read_b64_tr_b16 a[72:73], v186 offset:49152
  v_cvt_pk_bf16_f32 v2, v2, v3
  v_mfma_f32_16x16x32_bf16 v[56:59], a[112:115], a[244:247], v[56:59]
  buffer_load_dwordx4 v212, s[12:15], s55 offen offset:0 nt lds
  ds_read_b64_tr_b16 a[74:75], v186 offset:53248
  s_waitcnt lgkmcnt(6)
  v_mfma_f32_16x16x32_bf16 v[52:55], a[116:119], a[240:243], v[52:55]
  ds_read_b64_tr_b16 a[76:77], v187 offset:49152
  v_cvt_pk_bf16_f32 v6, v6, v7
  v_mfma_f32_16x16x32_bf16 v[60:63], a[116:119], a[244:247], v[60:63]
  ds_read_b64_tr_b16 a[78:79], v187 offset:53248
  ds_read_b64_tr_b16 a[80:81], v188 offset:49152
  v_mfma_f32_16x16x32_bf16 v[48:51], a[120:123], a[248:251], v[48:51]
  ds_read_b64_tr_b16 a[82:83], v188 offset:53248
  ds_read_b64_tr_b16 a[84:85], v189 offset:49152
  v_mfma_f32_16x16x32_bf16 v[56:59], a[120:123], a[252:255], v[56:59]
  buffer_load_dwordx4 v213, s[12:15], s55 offen offset:1024 nt lds
  v_mfma_f32_16x16x32_bf16 v[52:55], a[124:127], a[248:251], v[52:55]
  ds_read_b64_tr_b16 a[86:87], v189 offset:53248
  ds_read_b64_tr_b16 a[88:89], v190 offset:49152
  v_mfma_f32_16x16x32_bf16 v[60:63], a[124:127], a[252:255], v[60:63]
  ds_read_b64_tr_b16 a[90:91], v190 offset:53248
  ds_read_b64_tr_b16 a[92:93], v191 offset:49152
  s_waitcnt lgkmcnt(9)
  v_mfma_f32_16x16x32_bf16 v[64:67], a[64:67], a[128:131], 0
  ds_read_b64_tr_b16 a[94:95], v191 offset:53248
  v_mfma_f32_16x16x32_bf16 v[72:75], a[64:67], a[132:135], 0
  ds_read_b64_tr_b16 a[96:97], v184 offset:57344
  ds_read_b64_tr_b16 a[98:99], v184 offset:61440
  v_mfma_f32_16x16x32_bf16 v[68:71], a[68:71], a[128:131], 0
  v_permlane16_swap_b32 v0, v4
  v_mfma_f32_16x16x32_bf16 v[76:79], a[68:71], a[132:135], 0
  ds_read_b64_tr_b16 a[100:101], v185 offset:57344
  ds_read_b64_tr_b16 a[102:103], v185 offset:61440
  v_mfma_f32_16x16x32_bf16 v[80:83], a[72:75], a[128:131], 0
  buffer_load_dwordx4 v214, s[12:15], s55 offen offset:2048 nt lds
  v_mfma_f32_16x16x32_bf16 v[88:91], a[72:75], a[132:135], 0
  ds_read_b64_tr_b16 a[104:105], v186 offset:57344
  s_waitcnt lgkmcnt(6)
  ds_read_b64_tr_b16 a[106:107], v186 offset:61440
  v_mfma_f32_16x16x32_bf16 v[84:87], a[76:79], a[128:131], 0
  v_permlane16_swap_b32 v2, v6
  v_mfma_f32_16x16x32_bf16 v[92:95], a[76:79], a[132:135], 0
  ds_read_b64_tr_b16 a[108:109], v187 offset:57344
  v_accvgpr_write_b32 a0, v0
  v_mfma_f32_16x16x32_bf16 v[96:99], a[80:83], a[128:131], 0
  ds_read_b64_tr_b16 a[110:111], v187 offset:61440
  v_accvgpr_write_b32 a2, v4
  v_mfma_f32_16x16x32_bf16 v[104:107], a[80:83], a[132:135], 0
  ds_read_b64_tr_b16 a[112:113], v188 offset:57344
  v_accvgpr_write_b32 a1, v2
  v_mfma_f32_16x16x32_bf16 v[100:103], a[84:87], a[128:131], 0
  ds_read_b64_tr_b16 a[114:115], v188 offset:61440
  v_accvgpr_write_b32 a3, v6
  v_mfma_f32_16x16x32_bf16 v[108:111], a[84:87], a[132:135], 0
  ds_read_b64_tr_b16 a[116:117], v189 offset:57344
  v_mul_f32 v8, s64, v8
  v_mfma_f32_16x16x32_bf16 v[112:115], a[88:91], a[128:131], 0
  ds_read_b64_tr_b16 a[118:119], v189 offset:61440
  v_mul_f32 v9, s64, v9
  v_mfma_f32_16x16x32_bf16 v[120:123], a[88:91], a[132:135], 0
  buffer_load_dwordx4 v215, s[12:15], s55 offen offset:3072 nt lds
  s_waitcnt lgkmcnt(5)
  v_mfma_f32_16x16x32_bf16 v[116:119], a[92:95], a[128:131], 0
  ds_read_b64_tr_b16 a[120:121], v190 offset:57344
  v_mul_f32 v10, s64, v10
  v_mfma_f32_16x16x32_bf16 v[124:127], a[92:95], a[132:135], 0
  ds_read_b64_tr_b16 a[122:123], v190 offset:61440
  v_mul_f32 v11, s64, v11
  v_mfma_f32_16x16x32_bf16 v[64:67], a[96:99], a[136:139], v[64:67]
  ds_read_b64_tr_b16 a[124:125], v191 offset:57344
  v_mul_f32 v12, s64, v12
  v_mfma_f32_16x16x32_bf16 v[72:75], a[96:99], a[140:143], v[72:75]
  ds_read_b64_tr_b16 a[126:127], v191 offset:61440
  v_mul_f32 v13, s64, v13
  v_mfma_f32_16x16x32_bf16 v[68:71], a[100:103], a[136:139], v[68:71]
  v_mul_f32 v14, s64, v14
  v_mul_f32 v15, s64, v15
  v_mfma_f32_16x16x32_bf16 v[76:79], a[100:103], a[140:143], v[76:79]
  s_waitcnt vmcnt(8)
  s_barrier
  v_mfma_f32_16x16x32_bf16 v[80:83], a[104:107], a[136:139], v[80:83]
  s_add_u32 m0, s45, 114688
  v_cvt_pk_bf16_f32 v8, v8, v9
  v_mfma_f32_16x16x32_bf16 v[88:91], a[104:107], a[140:143], v[88:91]
  ds_read_b64_tr_b16 a[64:65], v200 offset:0
  ds_read_b64_tr_b16 a[66:67], v200 offset:4096
  s_waitcnt lgkmcnt(4)
  v_mfma_f32_16x16x32_bf16 v[84:87], a[108:111], a[136:139], v[84:87]
  ds_read_b64_tr_b16 a[68:69], v201 offset:0
  v_cvt_pk_bf16_f32 v12, v12, v13
  v_mfma_f32_16x16x32_bf16 v[92:95], a[108:111], a[140:143], v[92:95]
  s_add_u32 s54, s54, 524288
  s_and_b32 s54, s54, 0x3fffff
  ds_read_b64_tr_b16 a[70:71], v201 offset:4096
  v_mfma_f32_16x16x32_bf16 v[96:99], a[112:115], a[136:139], v[96:99]
  ds_read_b64_tr_b16 a[72:73], v202 offset:0
  v_cvt_pk_bf16_f32 v10, v10, v11
  v_mfma_f32_16x16x32_bf16 v[104:107], a[112:115], a[140:143], v[104:107]
  buffer_load_dwordx4 v218, s[20:23], s54 offen offset:0 lds
  ds_read_b64_tr_b16 a[74:75], v202 offset:4096
  v_mfma_f32_16x16x32_bf16 v[100:103], a[116:119], a[136:139], v[100:103]
  ds_read_b64_tr_b16 a[76:77], v203 offset:0
  v_cvt_pk_bf16_f32 v14, v14, v15
  v_mfma_f32_16x16x32_bf16 v[108:111], a[116:119], a[140:143], v[108:111]
  buffer_load_dwordx4 v219, s[20:23], s54 offen offset:1024 lds
  ds_read_b64_tr_b16 a[78:79], v203 offset:4096
  v_mfma_f32_16x16x32_bf16 v[112:115], a[120:123], a[136:139], v[112:115]
  ds_read_b64_tr_b16 a[80:81], v204 offset:0
  ds_read_b64_tr_b16 a[82:83], v204 offset:4096
  v_mfma_f32_16x16x32_bf16 v[120:123], a[120:123], a[140:143], v[120:123]
  ds_read_b64_tr_b16 a[84:85], v205 offset:0
  ds_read_b64_tr_b16 a[86:87], v205 offset:4096
  s_waitcnt lgkmcnt(8)
  v_mfma_f32_16x16x32_bf16 v[116:119], a[124:127], a[136:139], v[116:119]
  buffer_load_dwordx4 v220, s[20:23], s54 offen offset:2048 lds
  v_mfma_f32_16x16x32_bf16 v[124:127], a[124:127], a[140:143], v[124:127]
  ds_read_b64_tr_b16 a[88:89], v206 offset:0
  ds_read_b64_tr_b16 a[90:91], v206 offset:4096
  v_mfma_f32_16x16x32_bf16 v[64:67], a[64:67], a[144:147], v[64:67]
  ds_read_b64_tr_b16 a[92:93], v207 offset:0
  ds_read_b64_tr_b16 a[94:95], v207 offset:4096
  v_mfma_f32_16x16x32_bf16 v[72:75], a[64:67], a[148:151], v[72:75]
  buffer_load_dwordx4 v221, s[20:23], s54 offen offset:3072 lds
  v_mfma_f32_16x16x32_bf16 v[68:71], a[68:71], a[144:147], v[68:71]
  s_add_u32 m0, s45, 0
  ds_read_b64_tr_b16 a[96:97], v200 offset:8192
  v_mfma_f32_16x16x32_bf16 v[76:79], a[68:71], a[148:151], v[76:79]
  s_mov_b32 s55, 0
  ds_read_b64_tr_b16 a[98:99], v200 offset:12288
  s_waitcnt lgkmcnt(6)
  v_mfma_f32_16x16x32_bf16 v[80:83], a[72:75], a[144:147], v[80:83]
  ds_read_b64_tr_b16 a[100:101], v201 offset:8192
  ds_read_b64_tr_b16 a[102:103], v201 offset:12288
  v_mfma_f32_16x16x32_bf16 v[88:91], a[72:75], a[148:151], v[88:91]
  buffer_load_dwordx4 v216, s[16:19], s55 offen offset:0 nt lds
  v_mfma_f32_16x16x32_bf16 v[84:87], a[76:79], a[144:147], v[84:87]
  ds_read_b64_tr_b16 a[104:105], v202 offset:8192
  ds_read_b64_tr_b16 a[106:107], v202 offset:12288
  v_mfma_f32_16x16x32_bf16 v[92:95], a[76:79], a[148:151], v[92:95]
  ds_read_b64_tr_b16 a[108:109], v203 offset:8192
  ds_read_b64_tr_b16 a[110:111], v203 offset:12288
  v_mfma_f32_16x16x32_bf16 v[96:99], a[80:83], a[144:147], v[96:99]
  buffer_load_dwordx4 v217, s[16:19], s55 offen offset:1024 nt lds
  v_mfma_f32_16x16x32_bf16 v[104:107], a[80:83], a[148:151], v[104:107]
  ds_read_b64_tr_b16 a[112:113], v204 offset:8192
  ds_read_b64_tr_b16 a[114:115], v204 offset:12288
  v_mfma_f32_16x16x32_bf16 v[100:103], a[84:87], a[144:147], v[100:103]
  v_permlane16_swap_b32 v8, v12
  v_mfma_f32_16x16x32_bf16 v[108:111], a[84:87], a[148:151], v[108:111]
  ds_read_b64_tr_b16 a[116:117], v205 offset:8192
  s_waitcnt lgkmcnt(7)
  ds_read_b64_tr_b16 a[118:119], v205 offset:12288
  v_mfma_f32_16x16x32_bf16 v[112:115], a[88:91], a[144:147], v[112:115]
  s_waitcnt vmcnt(9)
  buffer_load_dwordx4 v216, s[16:19], s55 offen offset:2048 nt lds
  v_mfma_f32_16x16x32_bf16 v[120:123], a[88:91], a[148:151], v[120:123]
  ds_read_b64_tr_b16 a[120:121], v206 offset:8192
  ds_read_b64_tr_b16 a[122:123], v206 offset:12288
  v_mfma_f32_16x16x32_bf16 v[116:119], a[92:95], a[144:147], v[116:119]
  v_permlane16_swap_b32 v10, v14
  v_mfma_f32_16x16x32_bf16 v[124:127], a[92:95], a[148:151], v[124:127]
  s_waitcnt vmcnt(9)
  buffer_load_dwordx4 v217, s[16:19], s55 offen offset:3072 nt lds
  v_mfma_f32_16x16x32_bf16 v[64:67], a[96:99], a[152:155], v[64:67]
  ds_read_b64_tr_b16 a[124:125], v207 offset:8192
  v_accvgpr_write_b32 a4, v8
  v_mfma_f32_16x16x32_bf16 v[72:75], a[96:99], a[156:159], v[72:75]
  ds_read_b64_tr_b16 a[126:127], v207 offset:12288
  v_accvgpr_write_b32 a6, v12
  v_mfma_f32_16x16x32_bf16 v[68:71], a[100:103], a[152:155], v[68:71]
  v_accvgpr_write_b32 a5, v10
  v_accvgpr_write_b32 a7, v14
  v_mul_f32 v16, s64, v16
  v_mul_f32 v17, s64, v17
  v_mul_f32 v18, s64, v18
  v_mul_f32 v19, s64, v19
  v_mul_f32 v20, s64, v20
  v_mul_f32 v21, s64, v21
  v_mul_f32 v22, s64, v22
  v_mul_f32 v23, s64, v23
  v_cvt_pk_bf16_f32 v16, v16, v17
  v_cvt_pk_bf16_f32 v20, v20, v21
  v_cvt_pk_bf16_f32 v18, v18, v19
  v_cvt_pk_bf16_f32 v22, v22, v23
  v_permlane16_swap_b32 v16, v20
  s_nop 0
  v_permlane16_swap_b32 v18, v22
  v_accvgpr_write_b32 a8, v16
  v_accvgpr_write_b32 a10, v20
  v_accvgpr_write_b32 a9, v18
  v_accvgpr_write_b32 a11, v22
  v_mul_f32 v24, s64, v24
  v_mul_f32 v25, s64, v25
  v_mul_f32 v26, s64, v26
  v_mul_f32 v27, s64, v27
  v_mul_f32 v28, s64, v28
  v_mul_f32 v29, s64, v29
  v_mul_f32 v30, s64, v30
  v_mul_f32 v31, s64, v31
  v_cvt_pk_bf16_f32 v24, v24, v25
  v_cvt_pk_bf16_f32 v28, v28, v29
  v_cvt_pk_bf16_f32 v26, v26, v27
  v_cvt_pk_bf16_f32 v30, v30, v31
  v_mfma_f32_16x16x32_bf16 v[76:79], a[100:103], a[156:159], v[76:79]
  s_barrier
  s_waitcnt lgkmcnt(2)
  v_mfma_f32_16x16x32_bf16 v[80:83], a[104:107], a[152:155], v[80:83]
  v_permlane16_swap_b32 v24, v28
  v_mfma_f32_16x16x32_bf16 v[88:91], a[104:107], a[156:159], v[88:91]
  ds_read_b64_tr_b16 a[64:65], v200 offset:16384
  ds_read_b64_tr_b16 a[66:67], v200 offset:20480
  v_mfma_f32_16x16x32_bf16 v[84:87], a[108:111], a[152:155], v[84:87]
  v_permlane16_swap_b32 v26, v30
  v_mfma_f32_16x16x32_bf16 v[92:95], a[108:111], a[156:159], v[92:95]
  s_add_u32 m0, s45, 49152
  s_add_u32 s54, s54, 524288
  s_and_b32 s54, s54, 0x3fffff
  ds_read_b64_tr_b16 a[68:69], v201 offset:16384
  ds_read_b64_tr_b16 a[70:71], v201 offset:20480
  v_accvgpr_write_b32 a12, v24
  v_mfma_f32_16x16x32_bf16 v[96:99], a[112:115], a[152:155], v[96:99]
  ds_read_b64_tr_b16 a[72:73], v202 offset:16384
  v_accvgpr_write_b32 a14, v28
  v_mfma_f32_16x16x32_bf16 v[104:107], a[112:115], a[156:159], v[104:107]
  buffer_load_dwordx4 v218, s[20:23], s54 offen offset:0 lds
  ds_read_b64_tr_b16 a[74:75], v202 offset:20480
  v_accvgpr_write_b32 a13, v26
  v_mfma_f32_16x16x32_bf16 v[100:103], a[116:119], a[152:155], v[100:103]
  ds_read_b64_tr_b16 a[76:77], v203 offset:16384
  v_accvgpr_write_b32 a15, v30
  v_mfma_f32_16x16x32_bf16 v[108:111], a[116:119], a[156:159], v[108:111]
  buffer_load_dwordx4 v219, s[20:23], s54 offen offset:1024 lds
  ds_read_b64_tr_b16 a[78:79], v203 offset:20480
  v_mul_f32 v32, s64, v32
  v_mfma_f32_16x16x32_bf16 v[112:115], a[120:123], a[152:155], v[112:115]
  ds_read_b64_tr_b16 a[80:81], v204 offset:16384
  v_mul_f32 v33, s64, v33
  v_mfma_f32_16x16x32_bf16 v[120:123], a[120:123], a[156:159], v[120:123]
  ds_read_b64_tr_b16 a[82:83], v204 offset:20480
  v_mul_f32 v34, s64, v34
  s_waitcnt lgkmcnt(6)
  v_mfma_f32_16x16x32_bf16 v[116:119], a[124:127], a[152:155], v[116:119]
  ds_read_b64_tr_b16 a[84:85], v205 offset:16384
  v_mul_f32 v35, s64, v35
  v_mfma_f32_16x16x32_bf16 v[124:127], a[124:127], a[156:159], v[124:127]
  buffer_load_dwordx4 v220, s[20:23], s54 offen offset:2048 lds
  ds_read_b64_tr_b16 a[86:87], v205 offset:20480
  v_mul_f32 v36, s64, v36
  v_mfma_f32_16x16x32_bf16 v[64:67], a[64:67], a[160:163], v[64:67]
  ds_read_b64_tr_b16 a[88:89], v206 offset:16384
  v_mul_f32 v37, s64, v37
  v_mfma_f32_16x16x32_bf16 v[72:75], a[64:67], a[164:167], v[72:75]
  ds_read_b64_tr_b16 a[90:91], v206 offset:20480
  v_mul_f32 v38, s64, v38
  v_mfma_f32_16x16x32_bf16 v[68:71], a[68:71], a[160:163], v[68:71]
  ds_read_b64_tr_b16 a[92:93], v207 offset:16384
  v_mul_f32 v39, s64, v39
  v_mfma_f32_16x16x32_bf16 v[76:79], a[68:71], a[164:167], v[76:79]
  buffer_load_dwordx4 v221, s[20:23], s54 offen offset:3072 lds
  ds_read_b64_tr_b16 a[94:95], v207 offset:20480
  v_cvt_pk_bf16_f32 v32, v32, v33
  s_waitcnt lgkmcnt(6)
  v_mfma_f32_16x16x32_bf16 v[80:83], a[72:75], a[160:163], v[80:83]
  ds_read_b64_tr_b16 a[96:97], v200 offset:24576
  v_cvt_pk_bf16_f32 v36, v36, v37
  v_mfma_f32_16x16x32_bf16 v[88:91], a[72:75], a[164:167], v[88:91]
  s_add_u32 m0, s45, 81920
  s_mov_b32 s55, 16384
  ds_read_b64_tr_b16 a[98:99], v200 offset:28672
  v_cvt_pk_bf16_f32 v34, v34, v35
  v_mfma_f32_16x16x32_bf16 v[84:87], a[76:79], a[160:163], v[84:87]
  ds_read_b64_tr_b16 a[100:101], v201 offset:24576
  v_cvt_pk_bf16_f32 v38, v38, v39
  v_mfma_f32_16x16x32_bf16 v[92:95], a[76:79], a[164:167], v[92:95]
  s_waitcnt vmcnt(13)
  buffer_load_dwordx4 v212, s[12:15], s55 offen offset:0 nt lds
  ds_read_b64_tr_b16 a[102:103], v201 offset:28672
  v_mfma_f32_16x16x32_bf16 v[96:99], a[80:83], a[160:163], v[96:99]
  v_permlane16_swap_b32 v32, v36
  v_mfma_f32_16x16x32_bf16 v[104:107], a[80:83], a[164:167], v[104:107]
  ds_read_b64_tr_b16 a[104:105], v202 offset:24576
  ds_read_b64_tr_b16 a[106:107], v202 offset:28672
  s_waitcnt lgkmcnt(6)
  v_mfma_f32_16x16x32_bf16 v[100:103], a[84:87], a[160:163], v[100:103]
  v_permlane16_swap_b32 v34, v38
  v_mfma_f32_16x16x32_bf16 v[108:111], a[84:87], a[164:167], v[108:111]
  s_waitcnt vmcnt(13)
  buffer_load_dwordx4 v213, s[12:15], s55 offen offset:1024 nt lds
  ds_read_b64_tr_b16 a[108:109], v203 offset:24576
  ds_read_b64_tr_b16 a[110:111], v203 offset:28672
  v_accvgpr_write_b32 a16, v32
  v_mfma_f32_16x16x32_bf16 v[112:115], a[88:91], a[160:163], v[112:115]
  ds_read_b64_tr_b16 a[112:113], v204 offset:24576
  v_accvgpr_write_b32 a18, v36
  v_mfma_f32_16x16x32_bf16 v[120:123], a[88:91], a[164:167], v[120:123]
  ds_read_b64_tr_b16 a[114:115], v204 offset:28672
  v_accvgpr_write_b32 a17, v34
  v_mfma_f32_16x16x32_bf16 v[116:119], a[92:95], a[160:163], v[116:119]
  ds_read_b64_tr_b16 a[116:117], v205 offset:24576
  v_accvgpr_write_b32 a19, v38
  v_mfma_f32_16x16x32_bf16 v[124:127], a[92:95], a[164:167], v[124:127]
  s_waitcnt vmcnt(9)
  buffer_load_dwordx4 v214, s[12:15], s55 offen offset:2048 nt lds
  ds_read_b64_tr_b16 a[118:119], v205 offset:28672
  v_mul_f32 v40, s64, v40
  s_waitcnt lgkmcnt(6)
  v_mfma_f32_16x16x32_bf16 v[64:67], a[96:99], a[168:171], v[64:67]
  ds_read_b64_tr_b16 a[120:121], v206 offset:24576
  v_mul_f32 v41, s64, v41
  v_mfma_f32_16x16x32_bf16 v[72:75], a[96:99], a[172:175], v[72:75]
  s_waitcnt vmcnt(9)
  buffer_load_dwordx4 v215, s[12:15], s55 offen offset:3072 nt lds
  ds_read_b64_tr_b16 a[122:123], v206 offset:28672
  v_mul_f32 v42, s64, v42
  v_mfma_f32_16x16x32_bf16 v[68:71], a[100:103], a[168:171], v[68:71]
  ds_read_b64_tr_b16 a[124:125], v207 offset:24576
  v_mul_f32 v43, s64, v43
  v_mfma_f32_16x16x32_bf16 v[76:79], a[100:103], a[172:175], v[76:79]
  ds_read_b64_tr_b16 a[126:127], v207 offset:28672
  v_mul_f32 v44, s64, v44
  s_barrier
  v_mfma_f32_16x16x32_bf16 v[80:83], a[104:107], a[168:171], v[80:83]
  s_add_u32 m0, s45, 16384
  v_mul_f32 v45, s64, v45
  v_mfma_f32_16x16x32_bf16 v[88:91], a[104:107], a[172:175], v[88:91]
  ds_read_b64_tr_b16 a[64:65], v192 offset:49152
  ds_read_b64_tr_b16 a[66:67], v192 offset:53248
  v_mul_f32 v46, s64, v46
  s_waitcnt lgkmcnt(6)
  v_mfma_f32_16x16x32_bf16 v[84:87], a[108:111], a[168:171], v[84:87]
  ds_read_b64_tr_b16 a[68:69], v193 offset:49152
  v_mul_f32 v47, s64, v47
  v_mfma_f32_16x16x32_bf16 v[92:95], a[108:111], a[172:175], v[92:95]
  s_mov_b32 s55, 16384
  ds_read_b64_tr_b16 a[70:71], v193 offset:53248
  v_cvt_pk_bf16_f32 v40, v40, v41
  v_mfma_f32_16x16x32_bf16 v[96:99], a[112:115], a[168:171], v[96:99]
  ds_read_b64_tr_b16 a[72:73], v194 offset:49152
  v_cvt_pk_bf16_f32 v44, v44, v45
  v_mfma_f32_16x16x32_bf16 v[104:107], a[112:115], a[172:175], v[104:107]
  s_waitcnt vmcnt(9)
  buffer_load_dwordx4 v216, s[16:19], s55 offen offset:0 nt lds
  ds_read_b64_tr_b16 a[74:75], v194 offset:53248
  v_cvt_pk_bf16_f32 v42, v42, v43
  v_mfma_f32_16x16x32_bf16 v[100:103], a[116:119], a[168:171], v[100:103]
  ds_read_b64_tr_b16 a[76:77], v195 offset:49152
  v_cvt_pk_bf16_f32 v46, v46, v47
  v_mfma_f32_16x16x32_bf16 v[108:111], a[116:119], a[172:175], v[108:111]
  ds_read_b64_tr_b16 a[78:79], v195 offset:53248
  ds_read_b64_tr_b16 a[80:81], v196 offset:49152
  s_waitcnt lgkmcnt(7)
  v_mfma_f32_16x16x32_bf16 v[112:115], a[120:123], a[168:171], v[112:115]
  v_permlane16_swap_b32 v40, v44
  v_mfma_f32_16x16x32_bf16 v[120:123], a[120:123], a[172:175], v[120:123]
  ds_read_b64_tr_b16 a[82:83], v196 offset:53248
  ds_read_b64_tr_b16 a[84:85], v197 offset:49152
  v_mfma_f32_16x16x32_bf16 v[116:119], a[124:127], a[168:171], v[116:119]
  v_permlane16_swap_b32 v42, v46
  v_mfma_f32_16x16x32_bf16 v[124:127], a[124:127], a[172:175], v[124:127]
  s_waitcnt vmcnt(9)
  buffer_load_dwordx4 v217, s[16:19], s55 offen offset:1024 nt lds
  ds_read_b64_tr_b16 a[86:87], v197 offset:53248
  v_accvgpr_write_b32 a20, v40
  v_mfma_f32_16x16x32_bf16 v[64:67], a[64:67], a[176:179], v[64:67]
  ds_read_b64_tr_b16 a[88:89], v198 offset:49152
  v_accvgpr_write_b32 a22, v44
  v_mfma_f32_16x16x32_bf16 v[72:75], a[64:67], a[180:183], v[72:75]
  ds_read_b64_tr_b16 a[90:91], v198 offset:53248
  v_accvgpr_write_b32 a21, v42
  s_waitcnt lgkmcnt(5)
  v_mfma_f32_16x16x32_bf16 v[68:71], a[68:71], a[176:179], v[68:71]
  ds_read_b64_tr_b16 a[92:93], v199 offset:49152
  v_accvgpr_write_b32 a23, v46
  v_mfma_f32_16x16x32_bf16 v[76:79], a[68:71], a[180:183], v[76:79]
  ds_read_b64_tr_b16 a[94:95], v199 offset:53248
  v_mul_f32 v48, s64, v48
  v_mfma_f32_16x16x32_bf16 v[80:83], a[72:75], a[176:179], v[80:83]
  ds_read_b64_tr_b16 a[96:97], v192 offset:57344
  v_mul_f32 v49, s64, v49
  v_mfma_f32_16x16x32_bf16 v[88:91], a[72:75], a[180:183], v[88:91]
  ds_read_b64_tr_b16 a[98:99], v192 offset:61440
  v_mul_f32 v50, s64, v50
  v_mfma_f32_16x16x32_bf16 v[84:87], a[76:79], a[176:179], v[84:87]
  ds_read_b64_tr_b16 a[100:101], v193 offset:57344
  v_mul_f32 v51, s64, v51
  v_mfma_f32_16x16x32_bf16 v[92:95], a[76:79], a[180:183], v[92:95]
  s_waitcnt vmcnt(5)
  buffer_load_dwordx4 v216, s[16:19], s55 offen offset:2048 nt lds
  ds_read_b64_tr_b16 a[102:103], v193 offset:61440
  v_mul_f32 v52, s64, v52
  s_waitcnt lgkmcnt(6)
  v_mfma_f32_16x16x32_bf16 v[96:99], a[80:83], a[176:179], v[96:99]
  ds_read_b64_tr_b16 a[104:105], v194 offset:57344
  ds_read_b64_tr_b16 a[106:107], v194 offset:61440
  v_mul_f32 v53, s64, v53
  v_mfma_f32_16x16x32_bf16 v[104:107], a[80:83], a[180:183], v[104:107]
  ds_read_b64_tr_b16 a[108:109], v195 offset:57344
  v_mul_f32 v54, s64, v54
  v_mfma_f32_16x16x32_bf16 v[100:103], a[84:87], a[176:179], v[100:103]
  ds_read_b64_tr_b16 a[110:111], v195 offset:61440
  v_mul_f32 v55, s64, v55
  v_mfma_f32_16x16x32_bf16 v[108:111], a[84:87], a[180:183], v[108:111]
  ds_read_b64_tr_b16 a[112:113], v196 offset:57344
  v_cvt_pk_bf16_f32 v48, v48, v49
  v_mfma_f32_16x16x32_bf16 v[112:115], a[88:91], a[176:179], v[112:115]
  ds_read_b64_tr_b16 a[114:115], v196 offset:61440
  ds_read_b64_tr_b16 a[116:117], v197 offset:57344
  v_cvt_pk_bf16_f32 v52, v52, v53
  v_mfma_f32_16x16x32_bf16 v[120:123], a[88:91], a[180:183], v[120:123]
  ds_read_b64_tr_b16 a[118:119], v197 offset:61440
  v_cvt_pk_bf16_f32 v50, v50, v51
  s_waitcnt lgkmcnt(8)
  v_mfma_f32_16x16x32_bf16 v[116:119], a[92:95], a[176:179], v[116:119]
  ds_read_b64_tr_b16 a[120:121], v198 offset:57344
  v_cvt_pk_bf16_f32 v54, v54, v55
  v_mfma_f32_16x16x32_bf16 v[124:127], a[92:95], a[180:183], v[124:127]
  s_waitcnt vmcnt(5)
  buffer_load_dwordx4 v217, s[16:19], s55 offen offset:3072 nt lds
  ds_read_b64_tr_b16 a[122:123], v198 offset:61440
  ds_read_b64_tr_b16 a[124:125], v199 offset:57344
  ds_read_b64_tr_b16 a[126:127], v199 offset:61440
  v_mfma_f32_16x16x32_bf16 v[64:67], a[96:99], a[184:187], v[64:67]
  v_permlane16_swap_b32 v48, v52
  v_mfma_f32_16x16x32_bf16 v[72:75], a[96:99], a[188:191], v[72:75]
  v_permlane16_swap_b32 v50, v54
  v_mfma_f32_16x16x32_bf16 v[68:71], a[100:103], a[184:187], v[68:71]
  v_accvgpr_write_b32 a24, v48
  v_accvgpr_write_b32 a26, v52
  v_mfma_f32_16x16x32_bf16 v[76:79], a[100:103], a[188:191], v[76:79]
  s_barrier
  s_waitcnt lgkmcnt(4)
  v_mfma_f32_16x16x32_bf16 v[80:83], a[104:107], a[184:187], v[80:83]
  s_add_u32 m0, s45, 98304
  v_accvgpr_write_b32 a25, v50
  v_mfma_f32_16x16x32_bf16 v[88:91], a[104:107], a[188:191], v[88:91]
  s_mov_b32 s55, 32768
  ds_read_b128 a[64:67], v208 offset:0
  v_mfma_f32_16x16x32_bf16 v[84:87], a[108:111], a[184:187], v[84:87]
  ds_read_b128 a[68:71], v208 offset:4096
  v_accvgpr_write_b32 a27, v54
  v_mfma_f32_16x16x32_bf16 v[92:95], a[108:111], a[188:191], v[92:95]
  s_waitcnt vmcnt(5)
  buffer_load_dwordx4 v212, s[12:15], s55 offen offset:0 nt lds
  s_add_u32 m0, s45, 131072
  s_add_u32 s54, s54, 524288
  s_and_b32 s54, s54, 0x3fffff
  v_mul_f32 v56, s64, v56
  v_mfma_f32_16x16x32_bf16 v[96:99], a[112:115], a[184:187], v[96:99]
  ds_read_b128 a[72:75], v209 offset:0
  v_mul_f32 v57, s64, v57
  v_mfma_f32_16x16x32_bf16 v[104:107], a[112:115], a[188:191], v[104:107]
  buffer_load_dwordx4 v218, s[20:23], s54 offen offset:0 lds
  v_mul_f32 v58, s64, v58
  v_mfma_f32_16x16x32_bf16 v[100:103], a[116:119], a[184:187], v[100:103]
  ds_read_b128 a[76:79], v209 offset:4096
  v_mul_f32 v59, s64, v59
  v_mfma_f32_16x16x32_bf16 v[108:111], a[116:119], a[188:191], v[108:111]
  ds_read_b128 a[80:83], v210 offset:0
  v_mul_f32 v60, s64, v60
  s_waitcnt lgkmcnt(4)
  v_mfma_f32_16x16x32_bf16 v[112:115], a[120:123], a[184:187], v[112:115]
  ds_read_b128 a[84:87], v210 offset:4096
  v_mul_f32 v61, s64, v61
  v_mfma_f32_16x16x32_bf16 v[120:123], a[120:123], a[188:191], v[120:123]
  ds_read_b128 a[88:91], v211 offset:0
  v_mul_f32 v62, s64, v62
  v_mfma_f32_16x16x32_bf16 v[116:119], a[124:127], a[184:187], v[116:119]
  v_mul_f32 v63, s64, v63
  v_cvt_pk_bf16_f32 v56, v56, v57
  v_mfma_f32_16x16x32_bf16 v[124:127], a[124:127], a[188:191], v[124:127]
  ds_read_b128 a[92:95], v211 offset:4096
  v_cvt_pk_bf16_f32 v60, v60, v61
  v_mfma_f32_16x16x32_bf16 v[128:131], a[64:67], a[0:3], 0
  v_cvt_pk_bf16_f32 v58, v58, v59
  v_cvt_pk_bf16_f32 v62, v62, v63
  v_mfma_f32_16x16x32_bf16 v[136:139], a[64:67], a[4:7], 0
  v_permlane16_swap_b32 v56, v60
  s_waitcnt lgkmcnt(3)
  v_mfma_f32_16x16x32_bf16 v[132:135], a[68:71], a[0:3], 0
  v_permlane16_swap_b32 v58, v62
  v_mfma_f32_16x16x32_bf16 v[140:143], a[68:71], a[4:7], 0
  s_barrier
  v_mfma_f32_16x16x32_bf16 v[128:131], a[72:75], a[8:11], v[128:131]
  s_add_u32 m0, s45, 98304
  v_accvgpr_write_b32 a28, v56
  v_mfma_f32_16x16x32_bf16 v[136:139], a[72:75], a[12:15], v[136:139]
  ds_read_b64_tr_b16 a[96:97], v184 offset:49152
  ds_read_b64_tr_b16 a[98:99], v184 offset:53248
  v_mfma_f32_16x16x32_bf16 v[132:135], a[76:79], a[8:11], v[132:135]
  ds_read_b64_tr_b16 a[100:101], v185 offset:49152
  v_accvgpr_write_b32 a30, v60
  v_mfma_f32_16x16x32_bf16 v[140:143], a[76:79], a[12:15], v[140:143]
  ds_read_b64_tr_b16 a[102:103], v185 offset:53248
  v_accvgpr_write_b32 a29, v58
  v_mfma_f32_16x16x32_bf16 v[128:131], a[80:83], a[16:19], v[128:131]
  ds_read_b64_tr_b16 a[104:105], v186 offset:49152
  v_accvgpr_write_b32 a31, v62
  v_mfma_f32_16x16x32_bf16 v[136:139], a[80:83], a[20:23], v[136:139]
  s_waitcnt vmcnt(6)
  buffer_load_dwordx4 v213, s[12:15], s55 offen offset:1024 nt lds
  ds_read_b64_tr_b16 a[106:107], v186 offset:53248
  s_waitcnt lgkmcnt(6)
  v_mfma_f32_16x16x32_bf16 v[132:135], a[84:87], a[16:19], v[132:135]
  s_add_u32 m0, s45, 131072
  ds_read_b64_tr_b16 a[108:109], v187 offset:49152
  v_mfma_f32_16x16x32_bf16 v[140:143], a[84:87], a[20:23], v[140:143]
  ds_read_b64_tr_b16 a[110:111], v187 offset:53248
  ds_read_b64_tr_b16 a[112:113], v188 offset:49152
  v_mfma_f32_16x16x32_bf16 v[128:131], a[88:91], a[24:27], v[128:131]
  buffer_load_dwordx4 v219, s[20:23], s54 offen offset:1024 lds
  v_mfma_f32_16x16x32_bf16 v[136:139], a[88:91], a[28:31], v[136:139]
  ds_read_b64_tr_b16 a[114:115], v188 offset:53248
  ds_read_b64_tr_b16 a[116:117], v189 offset:49152
  v_mfma_f32_16x16x32_bf16 v[132:135], a[92:95], a[24:27], v[132:135]
  ds_read_b64_tr_b16 a[118:119], v189 offset:53248
  ds_read_b64_tr_b16 a[120:121], v190 offset:49152
  v_mfma_f32_16x16x32_bf16 v[140:143], a[92:95], a[28:31], v[140:143]
  ds_read_b64_tr_b16 a[122:123], v190 offset:53248
  ds_read_b64_tr_b16 a[124:125], v191 offset:49152
  s_waitcnt lgkmcnt(9)
  v_mfma_f32_16x16x32_bf16 v[64:67], a[96:99], a[192:195], v[64:67]
  ds_read_b64_tr_b16 a[126:127], v191 offset:53248
  v_mfma_f32_16x16x32_bf16 v[72:75], a[96:99], a[196:199], v[72:75]
  ds_read_b128 a[64:67], v208 offset:8192
  v_max3_f32 v238, v128, v129, v130
  v_mfma_f32_16x16x32_bf16 v[68:71], a[100:103], a[192:195], v[68:71]
  v_max3_f32 v238, v238, v131, v132
  v_max3_f32 v238, v238, v133, v134
  v_mfma_f32_16x16x32_bf16 v[76:79], a[100:103], a[196:199], v[76:79]
  ds_read_b128 a[68:71], v208 offset:12288
  v_max3_f32 v238, v238, v135, v247
  v_mfma_f32_16x16x32_bf16 v[80:83], a[104:107], a[192:195], v[80:83]
  s_add_u32 m0, s45, 98304
  v_max3_f32 v239, v136, v137, v138
  v_mfma_f32_16x16x32_bf16 v[88:91], a[104:107], a[196:199], v[88:91]
  ds_read_b128 a[72:75], v209 offset:8192
  v_max3_f32 v239, v239, v139, v140
  s_waitcnt lgkmcnt(4)
  v_mfma_f32_16x16x32_bf16 v[84:87], a[108:111], a[192:195], v[84:87]
  v_max3_f32 v239, v239, v141, v142
  v_max3_f32 v239, v239, v143, v247
  v_mov_b32 v240, v238
  v_mfma_f32_16x16x32_bf16 v[92:95], a[108:111], a[196:199], v[92:95]
  ds_read_b128 a[76:79], v209 offset:12288
  v_mov_b32 v241, v239
  v_mfma_f32_16x16x32_bf16 v[96:99], a[112:115], a[192:195], v[96:99]
  v_permlane32_swap_b32 v238, v240
  v_mfma_f32_16x16x32_bf16 v[104:107], a[112:115], a[196:199], v[104:107]
  s_waitcnt vmcnt(7)
  buffer_load_dwordx4 v214, s[12:15], s55 offen offset:2048 nt lds
  v_permlane32_swap_b32 v239, v241
  v_max_f32 v238, v238, v240
  v_max_f32 v239, v239, v241
  v_mfma_f32_16x16x32_bf16 v[100:103], a[116:119], a[192:195], v[100:103]
  ds_read_b128 a[80:83], v210 offset:8192
  v_mov_b32 v240, v238
  v_mov_b32 v241, v239
  v_mfma_f32_16x16x32_bf16 v[108:111], a[116:119], a[196:199], v[108:111]
  v_permlane16_swap_b32 v238, v240
  v_mfma_f32_16x16x32_bf16 v[112:115], a[120:123], a[192:195], v[112:115]
  v_permlane16_swap_b32 v239, v241
  v_mfma_f32_16x16x32_bf16 v[120:123], a[120:123], a[196:199], v[120:123]
  ds_read_b128 a[84:87], v210 offset:12288
  v_max_f32 v238, v238, v240
  v_max_f32 v239, v239, v241
  v_sub_f32 v176, 0, v238
  s_waitcnt lgkmcnt(2)
  v_mfma_f32_16x16x32_bf16 v[116:119], a[124:127], a[192:195], v[116:119]
  ds_read_b128 a[88:91], v211 offset:8192
  v_sub_f32 v177, 0, v238
  v_sub_f32 v178, 0, v238
  v_mfma_f32_16x16x32_bf16 v[124:127], a[124:127], a[196:199], v[124:127]
  v_sub_f32 v179, 0, v238
  v_sub_f32 v180, 0, v239
  v_sub_f32 v181, 0, v239
  v_sub_f32 v182, 0, v239
  v_sub_f32 v183, 0, v239
L_pg2:
  s_cbranch_execz L_pg6
  v_mfma_f32_16x16x32_bf16 v[144:147], a[64:67], a[0:3], v[176:179]
  ds_read_b128 a[92:95], v211 offset:12288
  v_sub_f32 v128, v128, v238
  v_mfma_f32_16x16x32_bf16 v[152:155], a[64:67], a[4:7], v[180:183]
  s_add_u32 m0, s45, 131072
  s_nop 0
  buffer_load_dwordx4 v220, s[20:23], s54 offen offset:2048 lds
  v_mfma_f32_16x16x32_bf16 v[148:151], a[68:71], a[0:3], v[176:179]
  ds_read_b64_tr_b16 a[96:97], v184 offset:57344
  v_sub_f32 v129, v129, v238
  v_mfma_f32_16x16x32_bf16 v[156:159], a[68:71], a[4:7], v[180:183]
  v_exp_f32 v222, v128
  v_mfma_f32_16x16x32_bf16 v[144:147], a[72:75], a[8:11], v[144:147]
  v_exp_f32 v223, v129
  v_mfma_f32_16x16x32_bf16 v[152:155], a[72:75], a[12:15], v[152:155]
  ds_read_b64_tr_b16 a[98:99], v184 offset:61440
  v_sub_f32 v130, v130, v238
  v_sub_f32 v131, v131, v238
  v_mfma_f32_16x16x32_bf16 v[148:151], a[76:79], a[8:11], v[148:151]
  v_exp_f32 v224, v130
  v_mfma_f32_16x16x32_bf16 v[156:159], a[76:79], a[12:15], v[156:159]
  ds_read_b64_tr_b16 a[100:101], v185 offset:57344
  ds_read_b64_tr_b16 a[102:103], v185 offset:61440
  s_waitcnt lgkmcnt(4)
  v_mfma_f32_16x16x32_bf16 v[144:147], a[80:83], a[16:19], v[144:147]
  v_exp_f32 v225, v131
  v_mfma_f32_16x16x32_bf16 v[152:155], a[80:83], a[20:23], v[152:155]
  s_add_u32 m0, s45, 98304
  s_waitcnt vmcnt(8)
  buffer_load_dwordx4 v215, s[12:15], s55 offen offset:3072 nt lds
  ds_read_b64_tr_b16 a[104:105], v186 offset:57344
  ds_read_b64_tr_b16 a[106:107], v186 offset:61440
  v_sub_f32 v132, v132, v238
  v_sub_f32 v133, v133, v238
  v_mfma_f32_16x16x32_bf16 v[148:151], a[84:87], a[16:19], v[148:151]
  v_exp_f32 v226, v132
  v_mfma_f32_16x16x32_bf16 v[156:159], a[84:87], a[20:23], v[156:159]
  ds_read_b64_tr_b16 a[108:109], v187 offset:57344
  ds_read_b64_tr_b16 a[110:111], v187 offset:61440
  v_cvt_pk_bf16_f32 v160, v222, v223
  v_mfma_f32_16x16x32_bf16 v[144:147], a[88:91], a[24:27], v[144:147]
  v_exp_f32 v227, v133
  v_sub_f32 v134, v134, v238
  v_add_f32 v234, v222, v223
  v_mfma_f32_16x16x32_bf16 v[152:155], a[88:91], a[28:31], v[152:155]
  ds_read_b64_tr_b16 a[112:113], v188 offset:57344
  ds_read_b64_tr_b16 a[114:115], v188 offset:61440
  v_sub_f32 v135, v135, v238
  v_cvt_pk_bf16_f32 v161, v224, v225
  v_mfma_f32_16x16x32_bf16 v[148:151], a[92:95], a[24:27], v[148:151]
  v_exp_f32 v228, v134
  v_add_f32 v234, v234, v224
  v_mfma_f32_16x16x32_bf16 v[156:159], a[92:95], a[28:31], v[156:159]
  ds_read_b64_tr_b16 a[116:117], v189 offset:57344
  ds_read_b64_tr_b16 a[118:119], v189 offset:61440
  v_exp_f32 v229, v135
  v_add_f32 v234, v234, v225
  s_waitcnt lgkmcnt(6)
  v_mfma_f32_16x16x32_bf16 v[64:67], a[96:99], a[200:203], v[64:67]
  v_sub_f32 v136, v136, v239
  v_cvt_pk_bf16_f32 v162, v226, v227
  v_mfma_f32_16x16x32_bf16 v[72:75], a[96:99], a[204:207], v[72:75]
  ds_read_b64_tr_b16 a[120:121], v190 offset:57344
  ds_read_b64_tr_b16 a[122:123], v190 offset:61440
  v_sub_f32 v137, v137, v239
  v_add_f32 v234, v234, v226
  v_mfma_f32_16x16x32_bf16 v[68:71], a[100:103], a[200:203], v[68:71]
  v_exp_f32 v222, v136
  v_add_f32 v234, v234, v227
  v_mfma_f32_16x16x32_bf16 v[76:79], a[100:103], a[204:207], v[76:79]
  ds_read_b64_tr_b16 a[124:125], v191 offset:57344
  ds_read_b64_tr_b16 a[126:127], v191 offset:61440
  v_exp_f32 v223, v137
  v_cvt_pk_bf16_f32 v163, v228, v229
  s_barrier
  v_mfma_f32_16x16x32_bf16 v[80:83], a[104:107], a[200:203], v[80:83]
  v_sub_f32 v138, v138, v239
  v_add_f32 v234, v234, v228
  v_sub_f32 v139, v139, v239
  v_mfma_f32_16x16x32_bf16 v[88:91], a[104:107], a[204:207], v[88:91]
  s_add_u32 m0, s45, 131072
  s_nop 0
  buffer_load_dwordx4 v221, s[20:23], s54 offen offset:3072 lds
  ds_read_b64_tr_b16 a[64:65], v184 offset:0
  ds_read_b64_tr_b16 a[66:67], v184 offset:4096
  v_add_f32 v234, v234, v229
  s_waitcnt lgkmcnt(6)
  v_mfma_f32_16x16x32_bf16 v[84:87], a[108:111], a[200:203], v[84:87]
  v_exp_f32 v224, v138
  v_cvt_pk_bf16_f32 v164, v222, v223
  v_mfma_f32_16x16x32_bf16 v[92:95], a[108:111], a[204:207], v[92:95]
  s_add_u32 m0, s45, 32768
  s_mov_b32 s55, 32768
  ds_read_b64_tr_b16 a[68:69], v185 offset:0
  ds_read_b64_tr_b16 a[70:71], v185 offset:4096
  v_exp_f32 v225, v139
  v_add_f32 v235, v222, v223
  v_mfma_f32_16x16x32_bf16 v[96:99], a[112:115], a[200:203], v[96:99]
  v_sub_f32 v140, v140, v239
  v_cvt_pk_bf16_f32 v165, v224, v225
  v_sub_f32 v141, v141, v239
  v_mfma_f32_16x16x32_bf16 v[104:107], a[112:115], a[204:207], v[104:107]
  s_waitcnt vmcnt(9)
  buffer_load_dwordx4 v216, s[16:19], s55 offen offset:0 nt lds
  ds_read_b64_tr_b16 a[72:73], v186 offset:0
  ds_read_b64_tr_b16 a[74:75], v186 offset:4096
  v_exp_f32 v226, v140
  v_add_f32 v235, v235, v224
  v_mfma_f32_16x16x32_bf16 v[100:103], a[116:119], a[200:203], v[100:103]
  ds_read_b64_tr_b16 a[76:77], v187 offset:0
  v_add_f32 v235, v235, v225
  v_mfma_f32_16x16x32_bf16 v[108:111], a[116:119], a[204:207], v[108:111]
  ds_read_b64_tr_b16 a[78:79], v187 offset:4096
  ds_read_b64_tr_b16 a[80:81], v188 offset:0
  v_exp_f32 v227, v141
  v_sub_f32 v142, v142, v239
  s_waitcnt lgkmcnt(7)
  v_mfma_f32_16x16x32_bf16 v[112:115], a[120:123], a[200:203], v[112:115]
  v_sub_f32 v143, v143, v239
  v_cvt_pk_bf16_f32 v166, v226, v227
  v_add_f32 v235, v235, v226
  v_mfma_f32_16x16x32_bf16 v[120:123], a[120:123], a[204:207], v[120:123]
  ds_read_b64_tr_b16 a[82:83], v188 offset:4096
  v_exp_f32 v228, v142
  v_exp_f32 v229, v143
  v_add_f32 v235, v235, v227
  v_mfma_f32_16x16x32_bf16 v[116:119], a[124:127], a[200:203], v[116:119]
  ds_read_b64_tr_b16 a[84:85], v189 offset:0
  v_cvt_pk_bf16_f32 v167, v228, v229
  v_mfma_f32_16x16x32_bf16 v[124:127], a[124:127], a[204:207], v[124:127]
  s_waitcnt vmcnt(9)
  buffer_load_dwordx4 v217, s[16:19], s55 offen offset:1024 nt lds
  ds_read_b64_tr_b16 a[86:87], v189 offset:4096
  v_add_f32 v235, v235, v228
  v_add_f32 v235, v235, v229
  v_mfma_f32_16x16x32_bf16 v[0:3], a[64:67], v[160:163], 0
  v_exp_f32 v222, v144
  v_mfma_f32_16x16x32_bf16 v[8:11], a[64:67], v[164:167], 0
  ds_read_b64_tr_b16 a[88:89], v190 offset:0
  ds_read_b64_tr_b16 a[90:91], v190 offset:4096
  s_waitcnt lgkmcnt(5)
  v_mfma_f32_16x16x32_bf16 v[4:7], a[68:71], v[160:163], 0
  v_exp_f32 v223, v145
  v_mfma_f32_16x16x32_bf16 v[12:15], a[68:71], v[164:167], 0
  ds_read_b64_tr_b16 a[92:93], v191 offset:0
  ds_read_b64_tr_b16 a[94:95], v191 offset:4096
  s_barrier
  v_mfma_f32_16x16x32_bf16 v[16:19], a[72:75], v[160:163], 0
  v_exp_f32 v224, v146
  v_mfma_f32_16x16x32_bf16 v[24:27], a[72:75], v[164:167], 0
  ds_read_b128 a[96:99], v208 offset:16384
  v_cvt_pk_bf16_f32 v168, v222, v223
  v_mfma_f32_16x16x32_bf16 v[20:23], a[76:79], v[160:163], 0
  v_exp_f32 v225, v147
  v_mfma_f32_16x16x32_bf16 v[28:31], a[76:79], v[164:167], 0
  s_waitcnt vmcnt(9)
  buffer_load_dwordx4 v216, s[16:19], s55 offen offset:2048 nt lds
  ds_read_b128 a[100:103], v208 offset:20480
  s_waitcnt lgkmcnt(4)
  v_mfma_f32_16x16x32_bf16 v[32:35], a[80:83], v[160:163], 0
  v_exp_f32 v226, v148
  v_add_f32 v236, v222, v223
  v_mfma_f32_16x16x32_bf16 v[40:43], a[80:83], v[164:167], 0
  ds_read_b128 a[104:107], v209 offset:16384
  v_cvt_pk_bf16_f32 v169, v224, v225
  v_mfma_f32_16x16x32_bf16 v[36:39], a[84:87], v[160:163], 0
  v_exp_f32 v227, v149
  v_add_f32 v236, v236, v224
  v_mfma_f32_16x16x32_bf16 v[44:47], a[84:87], v[164:167], 0
  ds_read_b128 a[108:111], v209 offset:20480
  v_add_f32 v236, v236, v225
  v_mfma_f32_16x16x32_bf16 v[48:51], a[88:91], v[160:163], 0
  v_exp_f32 v228, v150
  v_cvt_pk_bf16_f32 v170, v226, v227
  v_mfma_f32_16x16x32_bf16 v[56:59], a[88:91], v[164:167], 0
  ds_read_b128 a[112:115], v210 offset:16384
  v_add_f32 v236, v236, v226
  s_waitcnt lgkmcnt(3)
  v_mfma_f32_16x16x32_bf16 v[52:55], a[92:95], v[160:163], 0
  v_exp_f32 v229, v151
  v_add_f32 v236, v236, v227
  v_mfma_f32_16x16x32_bf16 v[60:63], a[92:95], v[164:167], 0
  s_waitcnt vmcnt(8)
  buffer_load_dwordx4 v217, s[16:19], s55 offen offset:3072 nt lds
  ds_read_b128 a[116:119], v210 offset:20480
  v_cvt_pk_bf16_f32 v171, v228, v229
  v_mfma_f32_16x16x32_bf16 v[128:131], a[96:99], a[0:3], v[176:179]
  v_exp_f32 v222, v152
  v_add_f32 v236, v236, v228
  v_mfma_f32_16x16x32_bf16 v[136:139], a[96:99], a[4:7], v[180:183]
  ds_read_b128 a[120:123], v211 offset:16384
  v_add_f32 v236, v236, v229
  v_mfma_f32_16x16x32_bf16 v[132:135], a[100:103], a[0:3], v[176:179]
  v_exp_f32 v223, v153
  v_mfma_f32_16x16x32_bf16 v[140:143], a[100:103], a[4:7], v[180:183]
  ds_read_b128 a[124:127], v211 offset:20480
  v_cvt_pk_bf16_f32 v172, v222, v223
  v_add_f32 v237, v222, v223
  s_waitcnt lgkmcnt(3)
  v_mfma_f32_16x16x32_bf16 v[128:131], a[104:107], a[8:11], v[128:131]
  v_exp_f32 v224, v154
  v_mfma_f32_16x16x32_bf16 v[136:139], a[104:107], a[12:15], v[136:139]
  s_add_u32 m0, s45, 65536
  s_mov_b32 s55, 49152
  ds_read_b64_tr_b16 a[64:65], v184 offset:8192
  ds_read_b64_tr_b16 a[66:67], v184 offset:12288
  v_mfma_f32_16x16x32_bf16 v[132:135], a[108:111], a[8:11], v[132:135]
  v_exp_f32 v225, v155
  v_mfma_f32_16x16x32_bf16 v[140:143], a[108:111], a[12:15], v[140:143]
  s_waitcnt vmcnt(7)
  buffer_load_dwordx4 v212, s[12:15], s55 offen offset:0 nt lds
  ds_read_b64_tr_b16 a[68:69], v185 offset:8192
  ds_read_b64_tr_b16 a[70:71], v185 offset:12288
  v_cvt_pk_bf16_f32 v173, v224, v225
  v_add_f32 v237, v237, v224
  v_add_f32 v237, v237, v225
  v_mfma_f32_16x16x32_bf16 v[128:131], a[112:115], a[16:19], v[128:131]
  v_exp_f32 v226, v156
  v_mfma_f32_16x16x32_bf16 v[136:139], a[112:115], a[20:23], v[136:139]
  ds_read_b64_tr_b16 a[72:73], v186 offset:8192
  ds_read_b64_tr_b16 a[74:75], v186 offset:12288
  s_waitcnt lgkmcnt(6)
  v_mfma_f32_16x16x32_bf16 v[132:135], a[116:119], a[16:19], v[132:135]
  v_exp_f32 v227, v157
  v_mfma_f32_16x16x32_bf16 v[140:143], a[116:119], a[20:23], v[140:143]
  ds_read_b64_tr_b16 a[76:77], v187 offset:8192
  ds_read_b64_tr_b16 a[78:79], v187 offset:12288
  v_cvt_pk_bf16_f32 v174, v226, v227
  v_add_f32 v237, v237, v226
  v_add_f32 v237, v237, v227
  v_mfma_f32_16x16x32_bf16 v[128:131], a[120:123], a[24:27], v[128:131]
  v_exp_f32 v228, v158
  v_mfma_f32_16x16x32_bf16 v[136:139], a[120:123], a[28:31], v[136:139]
  s_waitcnt vmcnt(6)
  buffer_load_dwordx4 v213, s[12:15], s55 offen offset:1024 nt lds
  ds_read_b64_tr_b16 a[80:81], v188 offset:8192
  ds_read_b64_tr_b16 a[82:83], v188 offset:12288
  v_exp_f32 v229, v159
  v_mfma_f32_16x16x32_bf16 v[132:135], a[124:127], a[24:27], v[132:135]
  ds_read_b64_tr_b16 a[84:85], v189 offset:8192
  v_cvt_pk_bf16_f32 v175, v228, v229
  v_add_f32 v237, v237, v228
  v_add_f32 v237, v237, v229
  v_max_f32 v240, v236, v237
  v_cmp_lt_f32 vcc, s63, v240
  v_mfma_f32_16x16x32_bf16 v[140:143], a[124:127], a[28:31], v[140:143]
  ds_read_b64_tr_b16 a[86:87], v189 offset:12288
  s_cbranch_vccnz L_nors_39_r
L_nors_39:
  s_waitcnt lgkmcnt(6)
  v_mfma_f32_16x16x32_bf16 v[0:3], a[64:67], v[168:171], v[0:3]
  ds_read_b64_tr_b16 a[88:89], v190 offset:8192
  v_add_f32 v234, v234, v236
  v_mfma_f32_16x16x32_bf16 v[8:11], a[64:67], v[172:175], v[8:11]
  ds_read_b64_tr_b16 a[90:91], v190 offset:12288
  v_add_f32 v235, v235, v237
  v_mfma_f32_16x16x32_bf16 v[4:7], a[68:71], v[168:171], v[4:7]
  ds_read_b64_tr_b16 a[92:93], v191 offset:8192
  ds_read_b64_tr_b16 a[94:95], v191 offset:12288
  v_mfma_f32_16x16x32_bf16 v[12:15], a[68:71], v[172:175], v[12:15]
  v_exp_f32 v222, v128
  v_mfma_f32_16x16x32_bf16 v[16:19], a[72:75], v[168:171], v[16:19]
  v_exp_f32 v223, v129
  v_mfma_f32_16x16x32_bf16 v[24:27], a[72:75], v[172:175], v[24:27]
  s_waitcnt vmcnt(5)
  buffer_load_dwordx4 v214, s[12:15], s55 offen offset:2048 nt lds
  ds_read_b128 a[96:99], v208 offset:24576
  s_waitcnt lgkmcnt(5)
  v_mfma_f32_16x16x32_bf16 v[20:23], a[76:79], v[168:171], v[20:23]
  ds_read_b128 a[100:103], v208 offset:28672
  v_cvt_pk_bf16_f32 v160, v222, v223
  v_mfma_f32_16x16x32_bf16 v[28:31], a[76:79], v[172:175], v[28:31]
  v_exp_f32 v224, v130
  v_mfma_f32_16x16x32_bf16 v[32:35], a[80:83], v[168:171], v[32:35]
  ds_read_b128 a[104:107], v209 offset:24576
  v_add_f32 v236, v222, v223
  v_mfma_f32_16x16x32_bf16 v[40:43], a[80:83], v[172:175], v[40:43]
  v_exp_f32 v225, v131
  v_mfma_f32_16x16x32_bf16 v[36:39], a[84:87], v[168:171], v[36:39]
  ds_read_b128 a[108:111], v209 offset:28672
  v_cvt_pk_bf16_f32 v161, v224, v225
  v_add_f32 v236, v236, v224
  v_mfma_f32_16x16x32_bf16 v[44:47], a[84:87], v[172:175], v[44:47]
  v_exp_f32 v226, v132
  v_add_f32 v236, v236, v225
  s_waitcnt lgkmcnt(3)
  v_mfma_f32_16x16x32_bf16 v[48:51], a[88:91], v[168:171], v[48:51]
  v_exp_f32 v227, v133
  v_mfma_f32_16x16x32_bf16 v[56:59], a[88:91], v[172:175], v[56:59]
  s_waitcnt vmcnt(5)
  buffer_load_dwordx4 v215, s[12:15], s55 offen offset:3072 nt lds
  ds_read_b128 a[112:115], v210 offset:24576
  v_cvt_pk_bf16_f32 v162, v226, v227
  v_add_f32 v236, v236, v226
  v_mfma_f32_16x16x32_bf16 v[52:55], a[92:95], v[168:171], v[52:55]
  ds_read_b128 a[116:119], v210 offset:28672
  v_add_f32 v236, v236, v227
  v_mfma_f32_16x16x32_bf16 v[60:63], a[92:95], v[172:175], v[60:63]
  v_exp_f32 v228, v134
  s_barrier
  v_mfma_f32_16x16x32_bf16 v[144:147], a[96:99], a[0:3], v[176:179]
  v_exp_f32 v229, v135
  v_mfma_f32_16x16x32_bf16 v[152:155], a[96:99], a[4:7], v[180:183]
  ds_read_b128 a[120:123], v211 offset:24576
  v_cvt_pk_bf16_f32 v163, v228, v229
  v_add_f32 v236, v236, v228
  v_add_f32 v236, v236, v229
  s_waitcnt lgkmcnt(3)
  v_mfma_f32_16x16x32_bf16 v[148:151], a[100:103], a[0:3], v[176:179]
  v_exp_f32 v222, v136
  v_mfma_f32_16x16x32_bf16 v[156:159], a[100:103], a[4:7], v[180:183]
  s_add_u32 m0, s45, 0
  s_mov_b32 s55, 49152
  ds_read_b128 a[124:127], v211 offset:28672
  v_mfma_f32_16x16x32_bf16 v[144:147], a[104:107], a[8:11], v[144:147]
  v_exp_f32 v223, v137
  v_mfma_f32_16x16x32_bf16 v[152:155], a[104:107], a[12:15], v[152:155]
  s_waitcnt vmcnt(5)
  buffer_load_dwordx4 v216, s[16:19], s55 offen offset:0 nt lds
  ds_read_b64_tr_b16 a[64:65], v184 offset:16384
  ds_read_b64_tr_b16 a[66:67], v184 offset:20480
  v_cvt_pk_bf16_f32 v164, v222, v223
  v_add_f32 v237, v222, v223
  v_mfma_f32_16x16x32_bf16 v[148:151], a[108:111], a[8:11], v[148:151]
  v_exp_f32 v224, v138
  v_mfma_f32_16x16x32_bf16 v[156:159], a[108:111], a[12:15], v[156:159]
  ds_read_b64_tr_b16 a[68:69], v185 offset:16384
  ds_read_b64_tr_b16 a[70:71], v185 offset:20480
  v_exp_f32 v225, v139
  s_waitcnt lgkmcnt(5)
  v_mfma_f32_16x16x32_bf16 v[144:147], a[112:115], a[16:19], v[144:147]
  ds_read_b64_tr_b16 a[72:73], v186 offset:16384
  v_cvt_pk_bf16_f32 v165, v224, v225
  v_add_f32 v237, v237, v224
  v_add_f32 v237, v237, v225
  v_mfma_f32_16x16x32_bf16 v[152:155], a[112:115], a[20:23], v[152:155]
  ds_read_b64_tr_b16 a[74:75], v186 offset:20480
  ds_read_b64_tr_b16 a[76:77], v187 offset:16384
  v_exp_f32 v226, v140
  v_mfma_f32_16x16x32_bf16 v[148:151], a[116:119], a[16:19], v[148:151]
  v_exp_f32 v227, v141
  v_mfma_f32_16x16x32_bf16 v[156:159], a[116:119], a[20:23], v[156:159]
  ds_read_b64_tr_b16 a[78:79], v187 offset:20480
  v_cvt_pk_bf16_f32 v166, v226, v227
  v_add_f32 v237, v237, v226
  v_add_f32 v237, v237, v227
  v_mfma_f32_16x16x32_bf16 v[144:147], a[120:123], a[24:27], v[144:147]
  v_exp_f32 v228, v142
  v_mfma_f32_16x16x32_bf16 v[152:155], a[120:123], a[28:31], v[152:155]
  ds_read_b64_tr_b16 a[80:81], v188 offset:16384
  ds_read_b64_tr_b16 a[82:83], v188 offset:20480
  v_exp_f32 v229, v143
  s_waitcnt lgkmcnt(6)
  v_mfma_f32_16x16x32_bf16 v[148:151], a[124:127], a[24:27], v[148:151]
  ds_read_b64_tr_b16 a[84:85], v189 offset:16384
  v_cvt_pk_bf16_f32 v167, v228, v229
  v_add_f32 v237, v237, v228
  v_add_f32 v237, v237, v229
  v_max_f32 v240, v236, v237
  v_cmp_lt_f32 vcc, s63, v240
  v_mfma_f32_16x16x32_bf16 v[156:159], a[124:127], a[28:31], v[156:159]
  s_waitcnt vmcnt(5)
  buffer_load_dwordx4 v217, s[16:19], s55 offen offset:1024 nt lds
  ds_read_b64_tr_b16 a[86:87], v189 offset:20480
  s_cbranch_vccnz L_nors_40_r
L_nors_40:
  v_mfma_f32_16x16x32_bf16 v[0:3], a[64:67], v[160:163], v[0:3]
  ds_read_b64_tr_b16 a[88:89], v190 offset:16384
  v_add_f32 v234, v234, v236
  v_mfma_f32_16x16x32_bf16 v[8:11], a[64:67], v[164:167], v[8:11]
  ds_read_b64_tr_b16 a[90:91], v190 offset:20480
  v_add_f32 v235, v235, v237
  v_mfma_f32_16x16x32_bf16 v[4:7], a[68:71], v[160:163], v[4:7]
  ds_read_b64_tr_b16 a[92:93], v191 offset:16384
  ds_read_b64_tr_b16 a[94:95], v191 offset:20480
  v_mfma_f32_16x16x32_bf16 v[12:15], a[68:71], v[164:167], v[12:15]
  s_barrier
  s_waitcnt lgkmcnt(6)
  v_mfma_f32_16x16x32_bf16 v[16:19], a[72:75], v[160:163], v[16:19]
  v_exp_f32 v222, v144
  v_mfma_f32_16x16x32_bf16 v[24:27], a[72:75], v[164:167], v[24:27]
  ds_read_b128 a[96:99], v208 offset:32768
  ds_read_b128 a[100:103], v208 offset:36864
  v_mfma_f32_16x16x32_bf16 v[20:23], a[76:79], v[160:163], v[20:23]
  s_waitcnt vmcnt(5)
  buffer_load_dwordx4 v216, s[16:19], s55 offen offset:2048 nt lds
  v_mfma_f32_16x16x32_bf16 v[28:31], a[76:79], v[164:167], v[28:31]
  s_add_u32 m0, s45, 49152
  s_add_u32 s54, s54, 524288
  s_and_b32 s54, s54, 0x3fffff
  v_mfma_f32_16x16x32_bf16 v[32:35], a[80:83], v[160:163], v[32:35]
  buffer_load_dwordx4 v218, s[20:23], s54 offen offset:0 lds
  v_mfma_f32_16x16x32_bf16 v[40:43], a[80:83], v[164:167], v[40:43]
  ds_read_b128 a[104:107], v209 offset:32768
  ds_read_b128 a[108:111], v209 offset:36864
  s_waitcnt lgkmcnt(4)
  v_mfma_f32_16x16x32_bf16 v[36:39], a[84:87], v[160:163], v[36:39]
  v_exp_f32 v223, v145
  v_mfma_f32_16x16x32_bf16 v[44:47], a[84:87], v[164:167], v[44:47]
  v_exp_f32 v224, v146
  v_mfma_f32_16x16x32_bf16 v[48:51], a[88:91], v[160:163], v[48:51]
  ds_read_b128 a[112:115], v210 offset:32768
  v_cvt_pk_bf16_f32 v168, v222, v223
  v_mfma_f32_16x16x32_bf16 v[56:59], a[88:91], v[164:167], v[56:59]
  v_exp_f32 v225, v147
  v_mfma_f32_16x16x32_bf16 v[52:55], a[92:95], v[160:163], v[52:55]
  ds_read_b128 a[116:119], v210 offset:36864
  v_add_f32 v236, v222, v223
  v_mfma_f32_16x16x32_bf16 v[60:63], a[92:95], v[164:167], v[60:63]
  v_exp_f32 v226, v148
  s_waitcnt lgkmcnt(2)
  v_mfma_f32_16x16x32_bf16 v[128:131], a[96:99], a[0:3], v[176:179]
  ds_read_b128 a[120:123], v211 offset:32768
  v_cvt_pk_bf16_f32 v169, v224, v225
  v_mfma_f32_16x16x32_bf16 v[136:139], a[96:99], a[4:7], v[180:183]
  s_add_u32 m0, s45, 0
  v_add_f32 v236, v236, v224
  v_mfma_f32_16x16x32_bf16 v[132:135], a[100:103], a[0:3], v[176:179]
  v_exp_f32 v227, v149
  v_mfma_f32_16x16x32_bf16 v[140:143], a[100:103], a[4:7], v[180:183]
  s_waitcnt vmcnt(6)
  buffer_load_dwordx4 v217, s[16:19], s55 offen offset:3072 nt lds
  ds_read_b128 a[124:127], v211 offset:36864
  v_mfma_f32_16x16x32_bf16 v[128:131], a[104:107], a[8:11], v[128:131]
  ds_read_b64_tr_b16 a[64:65], v200 offset:0
  v_add_f32 v236, v236, v225
  v_mfma_f32_16x16x32_bf16 v[136:139], a[104:107], a[12:15], v[136:139]
  ds_read_b64_tr_b16 a[66:67], v200 offset:4096
  ds_read_b64_tr_b16 a[68:69], v201 offset:0
  v_mfma_f32_16x16x32_bf16 v[132:135], a[108:111], a[8:11], v[132:135]
  v_exp_f32 v228, v150
  v_mfma_f32_16x16x32_bf16 v[140:143], a[108:111], a[12:15], v[140:143]
  ds_read_b64_tr_b16 a[70:71], v201 offset:4096
  ds_read_b64_tr_b16 a[72:73], v202 offset:0
  s_waitcnt lgkmcnt(6)
  v_mfma_f32_16x16x32_bf16 v[128:131], a[112:115], a[16:19], v[128:131]
  v_exp_f32 v229, v151
  v_mfma_f32_16x16x32_bf16 v[136:139], a[112:115], a[20:23], v[136:139]
  ds_read_b64_tr_b16 a[74:75], v202 offset:4096
  ds_read_b64_tr_b16 a[76:77], v203 offset:0
  v_mfma_f32_16x16x32_bf16 v[132:135], a[116:119], a[16:19], v[132:135]
  v_exp_f32 v222, v152
  v_mfma_f32_16x16x32_bf16 v[140:143], a[116:119], a[20:23], v[140:143]
  s_add_u32 m0, s45, 81920
  s_mov_b32 s55, 65536
  ds_read_b64_tr_b16 a[78:79], v203 offset:4096
  v_mfma_f32_16x16x32_bf16 v[128:131], a[120:123], a[24:27], v[128:131]
  v_exp_f32 v223, v153
  v_cvt_pk_bf16_f32 v170, v226, v227
  v_mfma_f32_16x16x32_bf16 v[136:139], a[120:123], a[28:31], v[136:139]
  s_waitcnt vmcnt(6)
  buffer_load_dwordx4 v212, s[12:15], s55 offen offset:0 nt lds
  ds_read_b64_tr_b16 a[80:81], v204 offset:0
  ds_read_b64_tr_b16 a[82:83], v204 offset:4096
  v_add_f32 v236, v236, v226
  s_waitcnt lgkmcnt(5)
  v_mfma_f32_16x16x32_bf16 v[132:135], a[124:127], a[24:27], v[132:135]
  v_exp_f32 v224, v154
  v_add_f32 v236, v236, v227
  v_mfma_f32_16x16x32_bf16 v[140:143], a[124:127], a[28:31], v[140:143]
  ds_read_b64_tr_b16 a[84:85], v205 offset:0
  ds_read_b64_tr_b16 a[86:87], v205 offset:4096
  v_cvt_pk_bf16_f32 v171, v228, v229
  v_mfma_f32_16x16x32_bf16 v[64:67], a[64:67], a[208:211], v[64:67]
  v_exp_f32 v225, v155
  v_add_f32 v236, v236, v228
  v_mfma_f32_16x16x32_bf16 v[72:75], a[64:67], a[212:215], v[72:75]
  s_add_u32 m0, s45, 49152
  s_nop 0
  buffer_load_dwordx4 v219, s[20:23], s54 offen offset:1024 lds
  ds_read_b64_tr_b16 a[88:89], v206 offset:0
  ds_read_b64_tr_b16 a[90:91], v206 offset:4096
  v_add_f32 v236, v236, v229
  v_mfma_f32_16x16x32_bf16 v[68:71], a[68:71], a[208:211], v[68:71]
  v_exp_f32 v226, v156
  v_cvt_pk_bf16_f32 v172, v222, v223
  v_mfma_f32_16x16x32_bf16 v[76:79], a[68:71], a[212:215], v[76:79]
  ds_read_b64_tr_b16 a[92:93], v207 offset:0
  ds_read_b64_tr_b16 a[94:95], v207 offset:4096
  v_add_f32 v237, v222, v223
  s_waitcnt lgkmcnt(6)
  v_mfma_f32_16x16x32_bf16 v[80:83], a[72:75], a[208:211], v[80:83]
  v_exp_f32 v227, v157
  v_cvt_pk_bf16_f32 v173, v224, v225
  v_mfma_f32_16x16x32_bf16 v[88:91], a[72:75], a[212:215], v[88:91]
  ds_read_b64_tr_b16 a[96:97], v184 offset:24576
  ds_read_b64_tr_b16 a[98:99], v184 offset:28672
  v_add_f32 v237, v237, v224
  v_mfma_f32_16x16x32_bf16 v[84:87], a[76:79], a[208:211], v[84:87]
  v_exp_f32 v228, v158
  v_add_f32 v237, v237, v225
  v_mfma_f32_16x16x32_bf16 v[92:95], a[76:79], a[212:215], v[92:95]
  s_add_u32 m0, s45, 81920
  s_waitcnt vmcnt(7)
  buffer_load_dwordx4 v213, s[12:15], s55 offen offset:1024 nt lds
  ds_read_b64_tr_b16 a[100:101], v185 offset:24576
  ds_read_b64_tr_b16 a[102:103], v185 offset:28672
  v_cvt_pk_bf16_f32 v174, v226, v227
  v_mfma_f32_16x16x32_bf16 v[96:99], a[80:83], a[208:211], v[96:99]
  v_exp_f32 v229, v159
  v_add_f32 v237, v237, v226
  v_mfma_f32_16x16x32_bf16 v[104:107], a[80:83], a[212:215], v[104:107]
  ds_read_b64_tr_b16 a[104:105], v186 offset:24576
  ds_read_b64_tr_b16 a[106:107], v186 offset:28672
  v_add_f32 v237, v237, v227
  s_waitcnt lgkmcnt(6)
  v_mfma_f32_16x16x32_bf16 v[100:103], a[84:87], a[208:211], v[100:103]
  ds_read_b64_tr_b16 a[108:109], v187 offset:24576
  v_cvt_pk_bf16_f32 v175, v228, v229
  v_mfma_f32_16x16x32_bf16 v[108:111], a[84:87], a[212:215], v[108:111]
  ds_read_b64_tr_b16 a[110:111], v187 offset:28672
  v_add_f32 v237, v237, v228
  v_mfma_f32_16x16x32_bf16 v[112:115], a[88:91], a[208:211], v[112:115]
  ds_read_b64_tr_b16 a[112:113], v188 offset:24576
  v_add_f32 v237, v237, v229
  v_mfma_f32_16x16x32_bf16 v[120:123], a[88:91], a[212:215], v[120:123]
  ds_read_b64_tr_b16 a[114:115], v188 offset:28672
  v_max_f32 v240, v236, v237
  v_mfma_f32_16x16x32_bf16 v[116:119], a[92:95], a[208:211], v[116:119]
  ds_read_b64_tr_b16 a[116:117], v189 offset:24576
  v_cmp_lt_f32 vcc, s63, v240
  v_mfma_f32_16x16x32_bf16 v[124:127], a[92:95], a[212:215], v[124:127]
  ds_read_b64_tr_b16 a[118:119], v189 offset:28672
  s_cbranch_vccnz L_nors_41_r
L_nors_41:
  s_waitcnt lgkmcnt(6)
  v_mfma_f32_16x16x32_bf16 v[0:3], a[96:99], v[168:171], v[0:3]
  ds_read_b64_tr_b16 a[120:121], v190 offset:24576
  v_add_f32 v234, v234, v236
  v_mfma_f32_16x16x32_bf16 v[8:11], a[96:99], v[172:175], v[8:11]
  s_waitcnt vmcnt(7)
  buffer_load_dwordx4 v214, s[12:15], s55 offen offset:2048 nt lds
  ds_read_b64_tr_b16 a[122:123], v190 offset:28672
  v_add_f32 v235, v235, v237
  v_mfma_f32_16x16x32_bf16 v[4:7], a[100:103], v[168:171], v[4:7]
  v_exp_f32 v222, v128
  v_exp_f32 v223, v129
  v_exp_f32 v224, v130
  v_exp_f32 v225, v131
  v_exp_f32 v226, v132
  v_mfma_f32_16x16x32_bf16 v[12:15], a[100:103], v[172:175], v[12:15]
  ds_read_b64_tr_b16 a[124:125], v191 offset:24576
  ds_read_b64_tr_b16 a[126:127], v191 offset:28672
  v_mfma_f32_16x16x32_bf16 v[16:19], a[104:107], v[168:171], v[16:19]
  v_exp_f32 v227, v133
  v_mfma_f32_16x16x32_bf16 v[24:27], a[104:107], v[172:175], v[24:27]
  ds_read_b128 a[64:67], v208 offset:40960
  ds_read_b128 a[68:71], v208 offset:45056
  s_waitcnt lgkmcnt(6)
  v_mfma_f32_16x16x32_bf16 v[20:23], a[108:111], v[168:171], v[20:23]
  v_exp_f32 v228, v134
  v_mfma_f32_16x16x32_bf16 v[28:31], a[108:111], v[172:175], v[28:31]
  v_exp_f32 v229, v135
  v_mfma_f32_16x16x32_bf16 v[32:35], a[112:115], v[168:171], v[32:35]
  s_add_u32 m0, s45, 49152
  v_cvt_pk_bf16_f32 v160, v222, v223
  v_mfma_f32_16x16x32_bf16 v[40:43], a[112:115], v[172:175], v[40:43]
  buffer_load_dwordx4 v220, s[20:23], s54 offen offset:2048 lds
  ds_read_b128 a[72:75], v209 offset:40960
  v_mfma_f32_16x16x32_bf16 v[36:39], a[116:119], v[168:171], v[36:39]
  s_add_u32 m0, s45, 81920
  v_add_f32 v236, v222, v223
  v_mfma_f32_16x16x32_bf16 v[44:47], a[116:119], v[172:175], v[44:47]
  s_waitcnt vmcnt(8)
  buffer_load_dwordx4 v215, s[12:15], s55 offen offset:3072 nt lds
  ds_read_b128 a[76:79], v209 offset:45056
  v_exp_f32 v222, v136
  s_waitcnt lgkmcnt(2)
  v_mfma_f32_16x16x32_bf16 v[48:51], a[120:123], v[168:171], v[48:51]
  v_exp_f32 v223, v137
  v_mfma_f32_16x16x32_bf16 v[56:59], a[120:123], v[172:175], v[56:59]
  ds_read_b128 a[80:83], v210 offset:40960
  ds_read_b128 a[84:87], v210 offset:45056
  v_mfma_f32_16x16x32_bf16 v[52:55], a[124:127], v[168:171], v[52:55]
  ds_read_b128 a[88:91], v211 offset:40960
  v_cvt_pk_bf16_f32 v161, v224, v225
  v_mfma_f32_16x16x32_bf16 v[60:63], a[124:127], v[172:175], v[60:63]
  s_barrier
  v_mfma_f32_16x16x32_bf16 v[144:147], a[64:67], a[0:3], v[176:179]
  s_add_u32 m0, s45, 16384
  v_add_f32 v236, v236, v224
  v_mfma_f32_16x16x32_bf16 v[152:155], a[64:67], a[4:7], v[180:183]
  ds_read_b128 a[92:95], v211 offset:45056
  v_add_f32 v236, v236, v225
  v_mfma_f32_16x16x32_bf16 v[148:151], a[68:71], a[0:3], v[176:179]
  v_exp_f32 v224, v138
  v_exp_f32 v225, v139
  v_mfma_f32_16x16x32_bf16 v[156:159], a[68:71], a[4:7], v[180:183]
  s_mov_b32 s55, 65536
  ds_read_b64_tr_b16 a[96:97], v200 offset:8192
  s_waitcnt lgkmcnt(3)
  v_mfma_f32_16x16x32_bf16 v[144:147], a[72:75], a[8:11], v[144:147]
  ds_read_b64_tr_b16 a[98:99], v200 offset:12288
  v_cvt_pk_bf16_f32 v162, v226, v227
  v_mfma_f32_16x16x32_bf16 v[152:155], a[72:75], a[12:15], v[152:155]
  s_waitcnt vmcnt(8)
  buffer_load_dwordx4 v216, s[16:19], s55 offen offset:0 nt lds
  v_mfma_f32_16x16x32_bf16 v[148:151], a[76:79], a[8:11], v[148:151]
  ds_read_b64_tr_b16 a[100:101], v201 offset:8192
  v_add_f32 v236, v236, v226
  v_mfma_f32_16x16x32_bf16 v[156:159], a[76:79], a[12:15], v[156:159]
  ds_read_b64_tr_b16 a[102:103], v201 offset:12288
  ds_read_b64_tr_b16 a[104:105], v202 offset:8192
  v_mfma_f32_16x16x32_bf16 v[144:147], a[80:83], a[16:19], v[144:147]
  ds_read_b64_tr_b16 a[106:107], v202 offset:12288
  v_add_f32 v236, v236, v227
  v_mfma_f32_16x16x32_bf16 v[152:155], a[80:83], a[20:23], v[152:155]
  v_exp_f32 v226, v140
  v_exp_f32 v227, v141
  v_mfma_f32_16x16x32_bf16 v[148:151], a[84:87], a[16:19], v[148:151]
  ds_read_b64_tr_b16 a[108:109], v203 offset:8192
  v_cvt_pk_bf16_f32 v163, v228, v229
  v_mfma_f32_16x16x32_bf16 v[156:159], a[84:87], a[20:23], v[156:159]
  ds_read_b64_tr_b16 a[110:111], v203 offset:12288
  ds_read_b64_tr_b16 a[112:113], v204 offset:8192
  s_waitcnt lgkmcnt(7)
  v_mfma_f32_16x16x32_bf16 v[144:147], a[88:91], a[24:27], v[144:147]
  ds_read_b64_tr_b16 a[114:115], v204 offset:12288
  v_add_f32 v236, v236, v228
  v_mfma_f32_16x16x32_bf16 v[152:155], a[88:91], a[28:31], v[152:155]
  ds_read_b64_tr_b16 a[116:117], v205 offset:8192
  v_add_f32 v236, v236, v229
  v_mfma_f32_16x16x32_bf16 v[148:151], a[92:95], a[24:27], v[148:151]
  v_exp_f32 v228, v142
  v_exp_f32 v229, v143
  v_mfma_f32_16x16x32_bf16 v[156:159], a[92:95], a[28:31], v[156:159]
  s_waitcnt vmcnt(7)
  buffer_load_dwordx4 v217, s[16:19], s55 offen offset:1024 nt lds
L_pg3:
  s_cbranch_execz L_pg7
  ds_read_b64_tr_b16 a[118:119], v205 offset:12288
  v_mfma_f32_16x16x32_bf16 v[64:67], a[96:99], a[216:219], v[64:67]
  s_add_u32 m0, s45, 49152
  v_cvt_pk_bf16_f32 v164, v222, v223
  v_mfma_f32_16x16x32_bf16 v[72:75], a[96:99], a[220:223], v[72:75]
  buffer_load_dwordx4 v221, s[20:23], s54 offen offset:3072 lds
  ds_read_b64_tr_b16 a[120:121], v206 offset:8192
  ds_read_b64_tr_b16 a[122:123], v206 offset:12288
  s_waitcnt lgkmcnt(5)
  v_mfma_f32_16x16x32_bf16 v[68:71], a[100:103], a[216:219], v[68:71]
  ds_read_b64_tr_b16 a[124:125], v207 offset:8192
  v_add_f32 v237, v222, v223
  v_mfma_f32_16x16x32_bf16 v[76:79], a[100:103], a[220:223], v[76:79]
  ds_read_b64_tr_b16 a[126:127], v207 offset:12288
  v_cvt_pk_bf16_f32 v165, v224, v225
  v_mfma_f32_16x16x32_bf16 v[80:83], a[104:107], a[216:219], v[80:83]
  ds_read_b64_tr_b16 a[64:65], v184 offset:32768
  v_add_f32 v237, v237, v224
  v_mfma_f32_16x16x32_bf16 v[88:91], a[104:107], a[220:223], v[88:91]
  ds_read_b64_tr_b16 a[66:67], v184 offset:36864
  v_add_f32 v237, v237, v225
  v_mfma_f32_16x16x32_bf16 v[84:87], a[108:111], a[216:219], v[84:87]
  ds_read_b64_tr_b16 a[68:69], v185 offset:32768
  v_cvt_pk_bf16_f32 v166, v226, v227
  v_mfma_f32_16x16x32_bf16 v[92:95], a[108:111], a[220:223], v[92:95]
  ds_read_b64_tr_b16 a[70:71], v185 offset:36864
  v_add_f32 v237, v237, v226
  s_waitcnt lgkmcnt(6)
  v_mfma_f32_16x16x32_bf16 v[96:99], a[112:115], a[216:219], v[96:99]
  ds_read_b64_tr_b16 a[72:73], v186 offset:32768
  v_add_f32 v237, v237, v227
  v_mfma_f32_16x16x32_bf16 v[104:107], a[112:115], a[220:223], v[104:107]
  s_add_u32 m0, s45, 16384
  s_waitcnt vmcnt(8)
  buffer_load_dwordx4 v216, s[16:19], s55 offen offset:2048 nt lds
  ds_read_b64_tr_b16 a[74:75], v186 offset:36864
  v_mfma_f32_16x16x32_bf16 v[100:103], a[116:119], a[216:219], v[100:103]
  ds_read_b64_tr_b16 a[76:77], v187 offset:32768
  v_cvt_pk_bf16_f32 v167, v228, v229
  v_mfma_f32_16x16x32_bf16 v[108:111], a[116:119], a[220:223], v[108:111]
  ds_read_b64_tr_b16 a[78:79], v187 offset:36864
  v_add_f32 v237, v237, v228
  v_mfma_f32_16x16x32_bf16 v[112:115], a[120:123], a[216:219], v[112:115]
  ds_read_b64_tr_b16 a[80:81], v188 offset:32768
  v_add_f32 v237, v237, v229
  v_mfma_f32_16x16x32_bf16 v[120:123], a[120:123], a[220:223], v[120:123]
  ds_read_b64_tr_b16 a[82:83], v188 offset:36864
  v_max_f32 v240, v236, v237
  s_waitcnt lgkmcnt(6)
  v_mfma_f32_16x16x32_bf16 v[116:119], a[124:127], a[216:219], v[116:119]
  ds_read_b64_tr_b16 a[84:85], v189 offset:32768
  v_cmp_lt_f32 vcc, s63, v240
  v_mfma_f32_16x16x32_bf16 v[124:127], a[124:127], a[220:223], v[124:127]
  ds_read_b64_tr_b16 a[86:87], v189 offset:36864
  s_cbranch_vccnz L_nors_42_r
L_nors_42:
  v_mfma_f32_16x16x32_bf16 v[0:3], a[64:67], v[160:163], v[0:3]
  ds_read_b64_tr_b16 a[88:89], v190 offset:32768
  v_add_f32 v234, v234, v236
  v_mfma_f32_16x16x32_bf16 v[8:11], a[64:67], v[164:167], v[8:11]
  ds_read_b64_tr_b16 a[90:91], v190 offset:36864
  v_add_f32 v235, v235, v237
  v_mfma_f32_16x16x32_bf16 v[4:7], a[68:71], v[160:163], v[4:7]
  v_exp_f32 v222, v144
  v_exp_f32 v223, v145
  v_exp_f32 v224, v146
  v_exp_f32 v225, v147
  v_exp_f32 v226, v148
  v_mfma_f32_16x16x32_bf16 v[12:15], a[68:71], v[164:167], v[12:15]
  s_waitcnt vmcnt(7)
  buffer_load_dwordx4 v217, s[16:19], s55 offen offset:3072 nt lds
  ds_read_b64_tr_b16 a[92:93], v191 offset:32768
  ds_read_b64_tr_b16 a[94:95], v191 offset:36864
  v_exp_f32 v227, v149
  s_barrier
  s_waitcnt lgkmcnt(6)
  v_mfma_f32_16x16x32_bf16 v[16:19], a[72:75], v[160:163], v[16:19]
  v_exp_f32 v228, v150
  v_mfma_f32_16x16x32_bf16 v[24:27], a[72:75], v[164:167], v[24:27]
  ds_read_b128 a[96:99], v208 offset:0
  v_cvt_pk_bf16_f32 v168, v222, v223
  v_mfma_f32_16x16x32_bf16 v[20:23], a[76:79], v[160:163], v[20:23]
  v_exp_f32 v229, v151
  v_mfma_f32_16x16x32_bf16 v[28:31], a[76:79], v[164:167], v[28:31]
  ds_read_b128 a[100:103], v208 offset:4096
  v_add_f32 v236, v222, v223
  v_mfma_f32_16x16x32_bf16 v[32:35], a[80:83], v[160:163], v[32:35]
  ds_read_b128 a[104:107], v209 offset:0
  v_cvt_pk_bf16_f32 v169, v224, v225
  v_mfma_f32_16x16x32_bf16 v[40:43], a[80:83], v[164:167], v[40:43]
  ds_read_b128 a[108:111], v209 offset:4096
  v_add_f32 v236, v236, v224
  s_waitcnt lgkmcnt(4)
  v_mfma_f32_16x16x32_bf16 v[36:39], a[84:87], v[160:163], v[36:39]
  v_exp_f32 v222, v152
  v_mfma_f32_16x16x32_bf16 v[44:47], a[84:87], v[164:167], v[44:47]
  s_add_u32 m0, s45, 98304
  s_mov_b32 s55, 81920
  v_add_f32 v236, v236, v225
  v_mfma_f32_16x16x32_bf16 v[48:51], a[88:91], v[160:163], v[48:51]
  ds_read_b128 a[112:115], v210 offset:0
  v_cvt_pk_bf16_f32 v170, v226, v227
  v_mfma_f32_16x16x32_bf16 v[56:59], a[88:91], v[164:167], v[56:59]
  s_waitcnt vmcnt(7)
  buffer_load_dwordx4 v212, s[12:15], s55 offen offset:0 nt lds
  v_add_f32 v236, v236, v226
  v_mfma_f32_16x16x32_bf16 v[52:55], a[92:95], v[160:163], v[52:55]
  v_exp_f32 v223, v153
  v_add_f32 v236, v236, v227
  v_mfma_f32_16x16x32_bf16 v[60:63], a[92:95], v[164:167], v[60:63]
  ds_read_b128 a[116:119], v210 offset:4096
  v_cvt_pk_bf16_f32 v171, v228, v229
  s_waitcnt lgkmcnt(2)
  v_mfma_f32_16x16x32_bf16 v[128:131], a[96:99], a[0:3], v[176:179]
  ds_read_b128 a[120:123], v211 offset:0
  v_add_f32 v236, v236, v228
  v_mfma_f32_16x16x32_bf16 v[136:139], a[96:99], a[4:7], v[180:183]
  v_exp_f32 v224, v154
  v_add_f32 v236, v236, v229
  v_mfma_f32_16x16x32_bf16 v[132:135], a[100:103], a[0:3], v[176:179]
  ds_read_b128 a[124:127], v211 offset:4096
  v_cvt_pk_bf16_f32 v172, v222, v223
  v_mfma_f32_16x16x32_bf16 v[140:143], a[100:103], a[4:7], v[180:183]
  v_exp_f32 v225, v155
  v_add_f32 v237, v222, v223
  v_mfma_f32_16x16x32_bf16 v[128:131], a[104:107], a[8:11], v[128:131]
  ds_read_b64_tr_b16 a[64:65], v184 offset:40960
  v_cvt_pk_bf16_f32 v173, v224, v225
  v_mfma_f32_16x16x32_bf16 v[136:139], a[104:107], a[12:15], v[136:139]
  ds_read_b64_tr_b16 a[66:67], v184 offset:45056
  v_add_f32 v237, v237, v224
  v_mfma_f32_16x16x32_bf16 v[132:135], a[108:111], a[8:11], v[132:135]
  v_exp_f32 v226, v156
  v_add_f32 v237, v237, v225
  v_mfma_f32_16x16x32_bf16 v[140:143], a[108:111], a[12:15], v[140:143]
  s_waitcnt vmcnt(6)
  buffer_load_dwordx4 v213, s[12:15], s55 offen offset:1024 nt lds
  ds_read_b64_tr_b16 a[68:69], v185 offset:40960
  ds_read_b64_tr_b16 a[70:71], v185 offset:45056
  s_waitcnt lgkmcnt(5)
  v_mfma_f32_16x16x32_bf16 v[128:131], a[112:115], a[16:19], v[128:131]
  v_exp_f32 v227, v157
  v_mfma_f32_16x16x32_bf16 v[136:139], a[112:115], a[20:23], v[136:139]
  ds_read_b64_tr_b16 a[72:73], v186 offset:40960
  ds_read_b64_tr_b16 a[74:75], v186 offset:45056
  v_cvt_pk_bf16_f32 v174, v226, v227
  v_add_f32 v237, v237, v226
  v_add_f32 v237, v237, v227
  v_mfma_f32_16x16x32_bf16 v[132:135], a[116:119], a[16:19], v[132:135]
  v_exp_f32 v228, v158
  v_mfma_f32_16x16x32_bf16 v[140:143], a[116:119], a[20:23], v[140:143]
  ds_read_b64_tr_b16 a[76:77], v187 offset:40960
  ds_read_b64_tr_b16 a[78:79], v187 offset:45056
  v_mfma_f32_16x16x32_bf16 v[128:131], a[120:123], a[24:27], v[128:131]
  ds_read_b64_tr_b16 a[80:81], v188 offset:40960
  ds_read_b64_tr_b16 a[82:83], v188 offset:45056
  v_mfma_f32_16x16x32_bf16 v[136:139], a[120:123], a[28:31], v[136:139]
  v_exp_f32 v229, v159
  s_waitcnt lgkmcnt(6)
  v_mfma_f32_16x16x32_bf16 v[132:135], a[124:127], a[24:27], v[132:135]
  ds_read_b64_tr_b16 a[84:85], v189 offset:40960
  v_cvt_pk_bf16_f32 v175, v228, v229
  v_add_f32 v237, v237, v228
  v_add_f32 v237, v237, v229
  v_max_f32 v240, v236, v237
  v_cmp_lt_f32 vcc, s63, v240
  v_mfma_f32_16x16x32_bf16 v[140:143], a[124:127], a[28:31], v[140:143]
  ds_read_b64_tr_b16 a[86:87], v189 offset:45056
  s_cbranch_vccnz L_nors_43_r
L_nors_43:
  v_mfma_f32_16x16x32_bf16 v[0:3], a[64:67], v[168:171], v[0:3]
  ds_read_b64_tr_b16 a[88:89], v190 offset:40960
  v_add_f32 v234, v234, v236
  v_mfma_f32_16x16x32_bf16 v[8:11], a[64:67], v[172:175], v[8:11]
  s_waitcnt vmcnt(6)
  buffer_load_dwordx4 v214, s[12:15], s55 offen offset:2048 nt lds
  ds_read_b64_tr_b16 a[90:91], v190 offset:45056
  v_add_f32 v235, v235, v237
  v_mfma_f32_16x16x32_bf16 v[4:7], a[68:71], v[168:171], v[4:7]
  ds_read_b64_tr_b16 a[92:93], v191 offset:40960
  ds_read_b64_tr_b16 a[94:95], v191 offset:45056
  v_mfma_f32_16x16x32_bf16 v[12:15], a[68:71], v[172:175], v[12:15]
  v_exp_f32 v222, v128
  s_waitcnt lgkmcnt(6)
  v_mfma_f32_16x16x32_bf16 v[16:19], a[72:75], v[168:171], v[16:19]
  v_exp_f32 v223, v129
  v_mfma_f32_16x16x32_bf16 v[24:27], a[72:75], v[172:175], v[24:27]
  ds_read_b128 a[96:99], v208 offset:8192
  v_cvt_pk_bf16_f32 v160, v222, v223
  v_mfma_f32_16x16x32_bf16 v[20:23], a[76:79], v[168:171], v[20:23]
  v_exp_f32 v224, v130
  v_mfma_f32_16x16x32_bf16 v[28:31], a[76:79], v[172:175], v[28:31]
  ds_read_b128 a[100:103], v208 offset:12288
  v_add_f32 v236, v222, v223
  v_mfma_f32_16x16x32_bf16 v[32:35], a[80:83], v[168:171], v[32:35]
  v_exp_f32 v225, v131
  v_mfma_f32_16x16x32_bf16 v[40:43], a[80:83], v[172:175], v[40:43]
  ds_read_b128 a[104:107], v209 offset:8192
  v_cvt_pk_bf16_f32 v161, v224, v225
  s_waitcnt lgkmcnt(3)
  v_mfma_f32_16x16x32_bf16 v[36:39], a[84:87], v[168:171], v[36:39]
  ds_read_b128 a[108:111], v209 offset:12288
  v_add_f32 v236, v236, v224
  v_mfma_f32_16x16x32_bf16 v[44:47], a[84:87], v[172:175], v[44:47]
  s_waitcnt vmcnt(6)
  buffer_load_dwordx4 v215, s[12:15], s55 offen offset:3072 nt lds
  v_exp_f32 v226, v132
  v_add_f32 v236, v236, v225
  v_mfma_f32_16x16x32_bf16 v[48:51], a[88:91], v[168:171], v[48:51]
  v_exp_f32 v227, v133
  v_mfma_f32_16x16x32_bf16 v[56:59], a[88:91], v[172:175], v[56:59]
  ds_read_b128 a[112:115], v210 offset:8192
  v_cvt_pk_bf16_f32 v162, v226, v227
  v_add_f32 v236, v236, v226
  v_mfma_f32_16x16x32_bf16 v[52:55], a[92:95], v[168:171], v[52:55]
  ds_read_b128 a[116:119], v210 offset:12288
  v_add_f32 v236, v236, v227
  v_mfma_f32_16x16x32_bf16 v[60:63], a[92:95], v[172:175], v[60:63]
  v_exp_f32 v228, v134
  s_barrier
  s_waitcnt lgkmcnt(3)
  v_mfma_f32_16x16x32_bf16 v[144:147], a[96:99], a[0:3], v[176:179]
  v_exp_f32 v229, v135
  v_mfma_f32_16x16x32_bf16 v[152:155], a[96:99], a[4:7], v[180:183]
  ds_read_b128 a[120:123], v211 offset:8192
  v_cvt_pk_bf16_f32 v163, v228, v229
  v_add_f32 v236, v236, v228
  v_add_f32 v236, v236, v229
  v_mfma_f32_16x16x32_bf16 v[148:151], a[100:103], a[0:3], v[176:179]
  v_exp_f32 v222, v136
  v_mfma_f32_16x16x32_bf16 v[156:159], a[100:103], a[4:7], v[180:183]
  s_add_u32 m0, s45, 32768
  s_mov_b32 s55, 81920
  ds_read_b128 a[124:127], v211 offset:12288
  v_mfma_f32_16x16x32_bf16 v[144:147], a[104:107], a[8:11], v[144:147]
  v_exp_f32 v223, v137
  v_mfma_f32_16x16x32_bf16 v[152:155], a[104:107], a[12:15], v[152:155]
  s_waitcnt vmcnt(5)
  buffer_load_dwordx4 v216, s[16:19], s55 offen offset:0 nt lds
  ds_read_b64_tr_b16 a[64:65], v184 offset:0
  ds_read_b64_tr_b16 a[66:67], v184 offset:4096
  v_cvt_pk_bf16_f32 v164, v222, v223
  v_add_f32 v237, v222, v223
  s_waitcnt lgkmcnt(4)
  v_mfma_f32_16x16x32_bf16 v[148:151], a[108:111], a[8:11], v[148:151]
  v_exp_f32 v224, v138
  v_mfma_f32_16x16x32_bf16 v[156:159], a[108:111], a[12:15], v[156:159]
  ds_read_b64_tr_b16 a[68:69], v185 offset:0
  ds_read_b64_tr_b16 a[70:71], v185 offset:4096
  v_exp_f32 v225, v139
  v_mfma_f32_16x16x32_bf16 v[144:147], a[112:115], a[16:19], v[144:147]
  ds_read_b64_tr_b16 a[72:73], v186 offset:0
  v_cvt_pk_bf16_f32 v165, v224, v225
  v_add_f32 v237, v237, v224
  v_add_f32 v237, v237, v225
  v_mfma_f32_16x16x32_bf16 v[152:155], a[112:115], a[20:23], v[152:155]
  ds_read_b64_tr_b16 a[74:75], v186 offset:4096
  ds_read_b64_tr_b16 a[76:77], v187 offset:0
  v_exp_f32 v226, v140
  v_mfma_f32_16x16x32_bf16 v[148:151], a[116:119], a[16:19], v[148:151]
  v_exp_f32 v227, v141
  v_mfma_f32_16x16x32_bf16 v[156:159], a[116:119], a[20:23], v[156:159]
  ds_read_b64_tr_b16 a[78:79], v187 offset:4096
  v_cvt_pk_bf16_f32 v166, v226, v227
  v_add_f32 v237, v237, v226
  v_add_f32 v237, v237, v227
  s_waitcnt lgkmcnt(6)
  v_mfma_f32_16x16x32_bf16 v[144:147], a[120:123], a[24:27], v[144:147]
  v_exp_f32 v228, v142
  v_mfma_f32_16x16x32_bf16 v[152:155], a[120:123], a[28:31], v[152:155]
  ds_read_b64_tr_b16 a[80:81], v188 offset:0
  ds_read_b64_tr_b16 a[82:83], v188 offset:4096
  v_exp_f32 v229, v143
  v_mfma_f32_16x16x32_bf16 v[148:151], a[124:127], a[24:27], v[148:151]
  ds_read_b64_tr_b16 a[84:85], v189 offset:0
  v_cvt_pk_bf16_f32 v167, v228, v229
  v_add_f32 v237, v237, v228
  v_add_f32 v237, v237, v229
  v_max_f32 v240, v236, v237
  v_cmp_lt_f32 vcc, s63, v240
  v_mfma_f32_16x16x32_bf16 v[156:159], a[124:127], a[28:31], v[156:159]
  s_waitcnt vmcnt(5)
  buffer_load_dwordx4 v217, s[16:19], s55 offen offset:1024 nt lds
  ds_read_b64_tr_b16 a[86:87], v189 offset:4096
  s_cbranch_vccnz L_nors_44_r
L_nors_44:
  v_mfma_f32_16x16x32_bf16 v[0:3], a[64:67], v[160:163], v[0:3]
  ds_read_b64_tr_b16 a[88:89], v190 offset:0
  v_add_f32 v234, v234, v236
  v_mfma_f32_16x16x32_bf16 v[8:11], a[64:67], v[164:167], v[8:11]
  ds_read_b64_tr_b16 a[90:91], v190 offset:4096
  v_add_f32 v235, v235, v237
  s_waitcnt lgkmcnt(6)
  v_mfma_f32_16x16x32_bf16 v[4:7], a[68:71], v[160:163], v[4:7]
  ds_read_b64_tr_b16 a[92:93], v191 offset:0
  ds_read_b64_tr_b16 a[94:95], v191 offset:4096
  v_mfma_f32_16x16x32_bf16 v[12:15], a[68:71], v[164:167], v[12:15]
  s_barrier
  v_mfma_f32_16x16x32_bf16 v[16:19], a[72:75], v[160:163], v[16:19]
  v_exp_f32 v222, v144
  v_mfma_f32_16x16x32_bf16 v[24:27], a[72:75], v[164:167], v[24:27]
  ds_read_b128 a[96:99], v208 offset:16384
  ds_read_b128 a[100:103], v208 offset:20480
  v_mfma_f32_16x16x32_bf16 v[20:23], a[76:79], v[160:163], v[20:23]
  s_waitcnt vmcnt(5)
  buffer_load_dwordx4 v216, s[16:19], s55 offen offset:2048 nt lds
  v_mfma_f32_16x16x32_bf16 v[28:31], a[76:79], v[164:167], v[28:31]
  s_add_u32 m0, s45, 131072
  s_add_u32 s54, s54, 524288
  s_and_b32 s54, s54, 0x3fffff
  s_waitcnt lgkmcnt(4)
  v_mfma_f32_16x16x32_bf16 v[32:35], a[80:83], v[160:163], v[32:35]
  v_exp_f32 v223, v145
  v_mfma_f32_16x16x32_bf16 v[40:43], a[80:83], v[164:167], v[40:43]
  buffer_load_dwordx4 v218, s[20:23], s54 offen offset:0 lds
  ds_read_b128 a[104:107], v209 offset:16384
  v_mfma_f32_16x16x32_bf16 v[36:39], a[84:87], v[160:163], v[36:39]
  v_exp_f32 v224, v146
  v_mfma_f32_16x16x32_bf16 v[44:47], a[84:87], v[164:167], v[44:47]
  ds_read_b128 a[108:111], v209 offset:20480
  ds_read_b128 a[112:115], v210 offset:16384
  v_mfma_f32_16x16x32_bf16 v[48:51], a[88:91], v[160:163], v[48:51]
  v_exp_f32 v225, v147
  v_mfma_f32_16x16x32_bf16 v[56:59], a[88:91], v[164:167], v[56:59]
  v_exp_f32 v226, v148
  s_waitcnt lgkmcnt(3)
  v_mfma_f32_16x16x32_bf16 v[52:55], a[92:95], v[160:163], v[52:55]
  ds_read_b128 a[116:119], v210 offset:20480
  v_cvt_pk_bf16_f32 v168, v222, v223
  v_mfma_f32_16x16x32_bf16 v[60:63], a[92:95], v[164:167], v[60:63]
  ds_read_b128 a[120:123], v211 offset:16384
  v_add_f32 v236, v222, v223
  v_mfma_f32_16x16x32_bf16 v[128:131], a[96:99], a[0:3], v[176:179]
  v_exp_f32 v227, v149
  v_mfma_f32_16x16x32_bf16 v[136:139], a[96:99], a[4:7], v[180:183]
  s_add_u32 m0, s45, 32768
  v_cvt_pk_bf16_f32 v169, v224, v225
  v_mfma_f32_16x16x32_bf16 v[132:135], a[100:103], a[0:3], v[176:179]
  ds_read_b128 a[124:127], v211 offset:20480
  v_add_f32 v236, v236, v224
  v_mfma_f32_16x16x32_bf16 v[140:143], a[100:103], a[4:7], v[180:183]
  s_waitcnt vmcnt(6)
  buffer_load_dwordx4 v217, s[16:19], s55 offen offset:3072 nt lds
  s_waitcnt lgkmcnt(3)
  v_mfma_f32_16x16x32_bf16 v[128:131], a[104:107], a[8:11], v[128:131]
  ds_read_b64_tr_b16 a[64:65], v184 offset:49152
  v_add_f32 v236, v236, v225
  v_mfma_f32_16x16x32_bf16 v[136:139], a[104:107], a[12:15], v[136:139]
  ds_read_b64_tr_b16 a[66:67], v184 offset:53248
  ds_read_b64_tr_b16 a[68:69], v185 offset:49152
  v_mfma_f32_16x16x32_bf16 v[132:135], a[108:111], a[8:11], v[132:135]
  v_exp_f32 v228, v150
  v_mfma_f32_16x16x32_bf16 v[140:143], a[108:111], a[12:15], v[140:143]
  ds_read_b64_tr_b16 a[70:71], v185 offset:53248
  ds_read_b64_tr_b16 a[72:73], v186 offset:49152
  v_mfma_f32_16x16x32_bf16 v[128:131], a[112:115], a[16:19], v[128:131]
  v_exp_f32 v229, v151
  v_mfma_f32_16x16x32_bf16 v[136:139], a[112:115], a[20:23], v[136:139]
  ds_read_b64_tr_b16 a[74:75], v186 offset:53248
  ds_read_b64_tr_b16 a[76:77], v187 offset:49152
  s_waitcnt lgkmcnt(7)
  v_mfma_f32_16x16x32_bf16 v[132:135], a[116:119], a[16:19], v[132:135]
  v_exp_f32 v222, v152
  v_mfma_f32_16x16x32_bf16 v[140:143], a[116:119], a[20:23], v[140:143]
  s_add_u32 m0, s45, 65536
  s_mov_b32 s55, 98304
  ds_read_b64_tr_b16 a[78:79], v187 offset:53248
  v_mfma_f32_16x16x32_bf16 v[128:131], a[120:123], a[24:27], v[128:131]
  ds_read_b64_tr_b16 a[80:81], v188 offset:49152
  v_cvt_pk_bf16_f32 v170, v226, v227
  v_mfma_f32_16x16x32_bf16 v[136:139], a[120:123], a[28:31], v[136:139]
  s_waitcnt vmcnt(6)
  buffer_load_dwordx4 v212, s[12:15], s55 offen offset:0 nt lds
  ds_read_b64_tr_b16 a[82:83], v188 offset:53248
  v_add_f32 v236, v236, v226
  v_mfma_f32_16x16x32_bf16 v[132:135], a[124:127], a[24:27], v[132:135]
  v_exp_f32 v223, v153
  v_add_f32 v236, v236, v227
  v_mfma_f32_16x16x32_bf16 v[140:143], a[124:127], a[28:31], v[140:143]
  ds_read_b64_tr_b16 a[84:85], v189 offset:49152
  ds_read_b64_tr_b16 a[86:87], v189 offset:53248
  v_cvt_pk_bf16_f32 v171, v228, v229
  s_waitcnt lgkmcnt(5)
  v_mfma_f32_16x16x32_bf16 v[64:67], a[64:67], a[224:227], v[64:67]
  ds_read_b64_tr_b16 a[88:89], v190 offset:49152
  v_add_f32 v236, v236, v228
  v_mfma_f32_16x16x32_bf16 v[72:75], a[64:67], a[228:231], v[72:75]
  s_add_u32 m0, s45, 131072
  s_nop 0
  buffer_load_dwordx4 v219, s[20:23], s54 offen offset:1024 lds
  ds_read_b64_tr_b16 a[90:91], v190 offset:53248
  v_exp_f32 v224, v154
  v_add_f32 v236, v236, v229
  v_mfma_f32_16x16x32_bf16 v[68:71], a[68:71], a[224:227], v[68:71]
  ds_read_b64_tr_b16 a[92:93], v191 offset:49152
  v_cvt_pk_bf16_f32 v172, v222, v223
  v_mfma_f32_16x16x32_bf16 v[76:79], a[68:71], a[228:231], v[76:79]
  ds_read_b64_tr_b16 a[94:95], v191 offset:53248
  v_add_f32 v237, v222, v223
  v_exp_f32 v225, v155
  v_mfma_f32_16x16x32_bf16 v[80:83], a[72:75], a[224:227], v[80:83]
  ds_read_b64_tr_b16 a[96:97], v184 offset:8192
  v_cvt_pk_bf16_f32 v173, v224, v225
  v_mfma_f32_16x16x32_bf16 v[88:91], a[72:75], a[228:231], v[88:91]
  ds_read_b64_tr_b16 a[98:99], v184 offset:12288
  v_add_f32 v237, v237, v224
  s_waitcnt lgkmcnt(6)
  v_mfma_f32_16x16x32_bf16 v[84:87], a[76:79], a[224:227], v[84:87]
  v_exp_f32 v226, v156
  v_add_f32 v237, v237, v225
  v_mfma_f32_16x16x32_bf16 v[92:95], a[76:79], a[228:231], v[92:95]
  s_add_u32 m0, s45, 65536
  s_waitcnt vmcnt(7)
  buffer_load_dwordx4 v213, s[12:15], s55 offen offset:1024 nt lds
  ds_read_b64_tr_b16 a[100:101], v185 offset:8192
  ds_read_b64_tr_b16 a[102:103], v185 offset:12288
  v_mfma_f32_16x16x32_bf16 v[96:99], a[80:83], a[224:227], v[96:99]
  v_exp_f32 v227, v157
  v_mfma_f32_16x16x32_bf16 v[104:107], a[80:83], a[228:231], v[104:107]
  ds_read_b64_tr_b16 a[104:105], v186 offset:8192
  ds_read_b64_tr_b16 a[106:107], v186 offset:12288
  v_cvt_pk_bf16_f32 v174, v226, v227
  v_add_f32 v237, v237, v226
  v_add_f32 v237, v237, v227
  v_mfma_f32_16x16x32_bf16 v[100:103], a[84:87], a[224:227], v[100:103]
  v_exp_f32 v228, v158
  v_mfma_f32_16x16x32_bf16 v[108:111], a[84:87], a[228:231], v[108:111]
  ds_read_b64_tr_b16 a[108:109], v187 offset:8192
  ds_read_b64_tr_b16 a[110:111], v187 offset:12288
  s_waitcnt lgkmcnt(6)
  v_mfma_f32_16x16x32_bf16 v[112:115], a[88:91], a[224:227], v[112:115]
  ds_read_b64_tr_b16 a[112:113], v188 offset:8192
  ds_read_b64_tr_b16 a[114:115], v188 offset:12288
  v_mfma_f32_16x16x32_bf16 v[120:123], a[88:91], a[228:231], v[120:123]
  v_exp_f32 v229, v159
  v_mfma_f32_16x16x32_bf16 v[116:119], a[92:95], a[224:227], v[116:119]
  ds_read_b64_tr_b16 a[116:117], v189 offset:8192
  v_cvt_pk_bf16_f32 v175, v228, v229
  v_add_f32 v237, v237, v228
  v_add_f32 v237, v237, v229
  v_max_f32 v240, v236, v237
  v_cmp_lt_f32 vcc, s63, v240
  v_mfma_f32_16x16x32_bf16 v[124:127], a[92:95], a[228:231], v[124:127]
  ds_read_b64_tr_b16 a[118:119], v189 offset:12288
  s_cbranch_vccnz L_nors_45_r
L_nors_45:
  v_mfma_f32_16x16x32_bf16 v[0:3], a[96:99], v[168:171], v[0:3]
  ds_read_b64_tr_b16 a[120:121], v190 offset:8192
  v_add_f32 v234, v234, v236
  v_mfma_f32_16x16x32_bf16 v[8:11], a[96:99], v[172:175], v[8:11]
  s_waitcnt vmcnt(7)
  buffer_load_dwordx4 v214, s[12:15], s55 offen offset:2048 nt lds
  ds_read_b64_tr_b16 a[122:123], v190 offset:12288
  v_add_f32 v235, v235, v237
  s_waitcnt lgkmcnt(6)
  v_mfma_f32_16x16x32_bf16 v[4:7], a[100:103], v[168:171], v[4:7]
  v_exp_f32 v222, v128
  v_mfma_f32_16x16x32_bf16 v[12:15], a[100:103], v[172:175], v[12:15]
  ds_read_b64_tr_b16 a[124:125], v191 offset:8192
  ds_read_b64_tr_b16 a[126:127], v191 offset:12288
  v_mfma_f32_16x16x32_bf16 v[16:19], a[104:107], v[168:171], v[16:19]
  v_exp_f32 v223, v129
  v_mfma_f32_16x16x32_bf16 v[24:27], a[104:107], v[172:175], v[24:27]
  ds_read_b128 a[64:67], v208 offset:24576
  ds_read_b128 a[68:71], v208 offset:28672
  v_mfma_f32_16x16x32_bf16 v[20:23], a[108:111], v[168:171], v[20:23]
  v_exp_f32 v224, v130
  v_mfma_f32_16x16x32_bf16 v[28:31], a[108:111], v[172:175], v[28:31]
  s_add_u32 m0, s45, 131072
  v_cvt_pk_bf16_f32 v160, v222, v223
  s_waitcnt lgkmcnt(4)
  v_mfma_f32_16x16x32_bf16 v[32:35], a[112:115], v[168:171], v[32:35]
  v_exp_f32 v225, v131
  v_mfma_f32_16x16x32_bf16 v[40:43], a[112:115], v[172:175], v[40:43]
  buffer_load_dwordx4 v220, s[20:23], s54 offen offset:2048 lds
  ds_read_b128 a[72:75], v209 offset:24576
  v_mfma_f32_16x16x32_bf16 v[36:39], a[116:119], v[168:171], v[36:39]
  s_add_u32 m0, s45, 65536
  v_add_f32 v236, v222, v223
  v_mfma_f32_16x16x32_bf16 v[44:47], a[116:119], v[172:175], v[44:47]
  s_waitcnt vmcnt(8)
  buffer_load_dwordx4 v215, s[12:15], s55 offen offset:3072 nt lds
  ds_read_b128 a[76:79], v209 offset:28672
  v_mfma_f32_16x16x32_bf16 v[48:51], a[120:123], v[168:171], v[48:51]
  v_exp_f32 v226, v132
  v_mfma_f32_16x16x32_bf16 v[56:59], a[120:123], v[172:175], v[56:59]
  ds_read_b128 a[80:83], v210 offset:24576
  ds_read_b128 a[84:87], v210 offset:28672
  s_waitcnt lgkmcnt(4)
  v_mfma_f32_16x16x32_bf16 v[52:55], a[124:127], v[168:171], v[52:55]
  v_exp_f32 v227, v133
  v_mfma_f32_16x16x32_bf16 v[60:63], a[124:127], v[172:175], v[60:63]
  s_barrier
  v_mfma_f32_16x16x32_bf16 v[144:147], a[64:67], a[0:3], v[176:179]
  ds_read_b128 a[88:91], v211 offset:24576
  v_cvt_pk_bf16_f32 v161, v224, v225
  v_mfma_f32_16x16x32_bf16 v[152:155], a[64:67], a[4:7], v[180:183]
  v_exp_f32 v228, v134
  v_mfma_f32_16x16x32_bf16 v[148:151], a[68:71], a[0:3], v[176:179]
  s_add_u32 m0, s45, 0
  v_add_f32 v236, v236, v224
  v_mfma_f32_16x16x32_bf16 v[156:159], a[68:71], a[4:7], v[180:183]
  s_mov_b32 s55, 98304
  ds_read_b128 a[92:95], v211 offset:28672
  s_waitcnt lgkmcnt(2)
  v_mfma_f32_16x16x32_bf16 v[144:147], a[72:75], a[8:11], v[144:147]
  ds_read_b64_tr_b16 a[96:97], v184 offset:57344
  v_add_f32 v236, v236, v225
  v_mfma_f32_16x16x32_bf16 v[152:155], a[72:75], a[12:15], v[152:155]
  s_waitcnt vmcnt(8)
  buffer_load_dwordx4 v216, s[16:19], s55 offen offset:0 nt lds
  ds_read_b64_tr_b16 a[98:99], v184 offset:61440
  v_mfma_f32_16x16x32_bf16 v[148:151], a[76:79], a[8:11], v[148:151]
  v_exp_f32 v229, v135
  v_mfma_f32_16x16x32_bf16 v[156:159], a[76:79], a[12:15], v[156:159]
  ds_read_b64_tr_b16 a[100:101], v185 offset:57344
  ds_read_b64_tr_b16 a[102:103], v185 offset:61440
  v_mfma_f32_16x16x32_bf16 v[144:147], a[80:83], a[16:19], v[144:147]
  v_exp_f32 v222, v136
  v_mfma_f32_16x16x32_bf16 v[152:155], a[80:83], a[20:23], v[152:155]
  ds_read_b64_tr_b16 a[104:105], v186 offset:57344
  ds_read_b64_tr_b16 a[106:107], v186 offset:61440
  v_mfma_f32_16x16x32_bf16 v[148:151], a[84:87], a[16:19], v[148:151]
  ds_read_b64_tr_b16 a[108:109], v187 offset:57344
  v_cvt_pk_bf16_f32 v162, v226, v227
  v_mfma_f32_16x16x32_bf16 v[156:159], a[84:87], a[20:23], v[156:159]
  ds_read_b64_tr_b16 a[110:111], v187 offset:61440
  v_add_f32 v236, v236, v226
  s_waitcnt lgkmcnt(6)
  v_mfma_f32_16x16x32_bf16 v[144:147], a[88:91], a[24:27], v[144:147]
  v_exp_f32 v223, v137
  v_mfma_f32_16x16x32_bf16 v[152:155], a[88:91], a[28:31], v[152:155]
  ds_read_b64_tr_b16 a[112:113], v188 offset:57344
  ds_read_b64_tr_b16 a[114:115], v188 offset:61440
  v_mfma_f32_16x16x32_bf16 v[148:151], a[92:95], a[24:27], v[148:151]
  ds_read_b64_tr_b16 a[116:117], v189 offset:57344
  v_add_f32 v236, v236, v227
  v_mfma_f32_16x16x32_bf16 v[156:159], a[92:95], a[28:31], v[156:159]
  s_waitcnt vmcnt(7)
  buffer_load_dwordx4 v217, s[16:19], s55 offen offset:1024 nt lds
  ds_read_b64_tr_b16 a[118:119], v189 offset:61440
  v_exp_f32 v224, v138
  v_cvt_pk_bf16_f32 v163, v228, v229
  v_mfma_f32_16x16x32_bf16 v[64:67], a[96:99], a[232:235], v[64:67]
  ds_read_b64_tr_b16 a[120:121], v190 offset:57344
  v_add_f32 v236, v236, v228
  v_mfma_f32_16x16x32_bf16 v[72:75], a[96:99], a[236:239], v[72:75]
  s_add_u32 m0, s45, 131072
  s_nop 0
  buffer_load_dwordx4 v221, s[20:23], s54 offen offset:3072 lds
  ds_read_b64_tr_b16 a[122:123], v190 offset:61440
  v_add_f32 v236, v236, v229
  s_waitcnt lgkmcnt(6)
  v_mfma_f32_16x16x32_bf16 v[68:71], a[100:103], a[232:235], v[68:71]
  v_exp_f32 v225, v139
  v_cvt_pk_bf16_f32 v164, v222, v223
  v_mfma_f32_16x16x32_bf16 v[76:79], a[100:103], a[236:239], v[76:79]
  ds_read_b64_tr_b16 a[124:125], v191 offset:57344
  ds_read_b64_tr_b16 a[126:127], v191 offset:61440
  v_add_f32 v237, v222, v223
  v_mfma_f32_16x16x32_bf16 v[80:83], a[104:107], a[232:235], v[80:83]
  ds_read_b64_tr_b16 a[64:65], v184 offset:16384
  v_cvt_pk_bf16_f32 v165, v224, v225
  v_mfma_f32_16x16x32_bf16 v[88:91], a[104:107], a[236:239], v[88:91]
  ds_read_b64_tr_b16 a[66:67], v184 offset:20480
  v_add_f32 v237, v237, v224
  v_exp_f32 v226, v140
  v_mfma_f32_16x16x32_bf16 v[84:87], a[108:111], a[232:235], v[84:87]
  ds_read_b64_tr_b16 a[68:69], v185 offset:16384
  v_add_f32 v237, v237, v225
  v_mfma_f32_16x16x32_bf16 v[92:95], a[108:111], a[236:239], v[92:95]
  s_add_u32 m0, s45, 0
  ds_read_b64_tr_b16 a[70:71], v185 offset:20480
  s_waitcnt lgkmcnt(6)
  v_mfma_f32_16x16x32_bf16 v[96:99], a[112:115], a[232:235], v[96:99]
  v_exp_f32 v227, v141
  v_mfma_f32_16x16x32_bf16 v[104:107], a[112:115], a[236:239], v[104:107]
  s_waitcnt vmcnt(8)
  buffer_load_dwordx4 v216, s[16:19], s55 offen offset:2048 nt lds
  ds_read_b64_tr_b16 a[72:73], v186 offset:16384
  ds_read_b64_tr_b16 a[74:75], v186 offset:20480
  v_cvt_pk_bf16_f32 v166, v226, v227
  v_add_f32 v237, v237, v226
  v_add_f32 v237, v237, v227
  v_mfma_f32_16x16x32_bf16 v[100:103], a[116:119], a[232:235], v[100:103]
  v_exp_f32 v228, v142
  v_mfma_f32_16x16x32_bf16 v[108:111], a[116:119], a[236:239], v[108:111]
  ds_read_b64_tr_b16 a[76:77], v187 offset:16384
  ds_read_b64_tr_b16 a[78:79], v187 offset:20480
  v_mfma_f32_16x16x32_bf16 v[112:115], a[120:123], a[232:235], v[112:115]
  ds_read_b64_tr_b16 a[80:81], v188 offset:16384
  ds_read_b64_tr_b16 a[82:83], v188 offset:20480
  v_mfma_f32_16x16x32_bf16 v[120:123], a[120:123], a[236:239], v[120:123]
  v_exp_f32 v229, v143
  s_waitcnt lgkmcnt(6)
  v_mfma_f32_16x16x32_bf16 v[116:119], a[124:127], a[232:235], v[116:119]
  ds_read_b64_tr_b16 a[84:85], v189 offset:16384
  v_cvt_pk_bf16_f32 v167, v228, v229
  v_add_f32 v237, v237, v228
  v_add_f32 v237, v237, v229
  v_max_f32 v240, v236, v237
  v_cmp_lt_f32 vcc, s63, v240
  v_mfma_f32_16x16x32_bf16 v[124:127], a[124:127], a[236:239], v[124:127]
  ds_read_b64_tr_b16 a[86:87], v189 offset:20480
  s_cbranch_vccnz L_nors_46_r
L_nors_46:
  v_mfma_f32_16x16x32_bf16 v[0:3], a[64:67], v[160:163], v[0:3]
  ds_read_b64_tr_b16 a[88:89], v190 offset:16384
  v_add_f32 v234, v234, v236
  v_mfma_f32_16x16x32_bf16 v[8:11], a[64:67], v[164:167], v[8:11]
  ds_read_b64_tr_b16 a[90:91], v190 offset:20480
  v_add_f32 v235, v235, v237
  v_mfma_f32_16x16x32_bf16 v[4:7], a[68:71], v[160:163], v[4:7]
  v_exp_f32 v222, v144
  v_exp_f32 v223, v145
  v_mfma_f32_16x16x32_bf16 v[12:15], a[68:71], v[164:167], v[12:15]
  s_waitcnt vmcnt(7)
  buffer_load_dwordx4 v217, s[16:19], s55 offen offset:3072 nt lds
  ds_read_b64_tr_b16 a[92:93], v191 offset:16384
  ds_read_b64_tr_b16 a[94:95], v191 offset:20480
  s_barrier
  s_waitcnt lgkmcnt(6)
L_pg4:
  s_cbranch_execz L_pg8
  v_mfma_f32_16x16x32_bf16 v[16:19], a[72:75], v[160:163], v[16:19]
  v_exp_f32 v224, v146
  v_mfma_f32_16x16x32_bf16 v[24:27], a[72:75], v[164:167], v[24:27]
  ds_read_b128 a[96:99], v208 offset:32768
  v_cvt_pk_bf16_f32 v168, v222, v223
  v_mfma_f32_16x16x32_bf16 v[20:23], a[76:79], v[160:163], v[20:23]
  v_exp_f32 v225, v147
  v_mfma_f32_16x16x32_bf16 v[28:31], a[76:79], v[164:167], v[28:31]
  ds_read_b128 a[100:103], v208 offset:36864
  v_add_f32 v236, v222, v223
  v_mfma_f32_16x16x32_bf16 v[32:35], a[80:83], v[160:163], v[32:35]
  v_exp_f32 v226, v148
  v_mfma_f32_16x16x32_bf16 v[40:43], a[80:83], v[164:167], v[40:43]
  s_lshl_b32 s52, s41, 4
  buffer_load_dword v233, v246, s[32:35], s52 offen sc1
  ds_read_b128 a[104:107], v209 offset:32768
  v_cvt_pk_bf16_f32 v169, v224, v225
  s_waitcnt lgkmcnt(3)
  v_mfma_f32_16x16x32_bf16 v[36:39], a[84:87], v[160:163], v[36:39]
  v_exp_f32 v227, v149
  v_add_f32 v236, v236, v224
  v_mfma_f32_16x16x32_bf16 v[44:47], a[84:87], v[164:167], v[44:47]
  s_add_u32 m0, s45, 81920
  s_mov_b32 s55, 114688
  ds_read_b128 a[108:111], v209 offset:36864
  v_add_f32 v236, v236, v225
  v_mfma_f32_16x16x32_bf16 v[48:51], a[88:91], v[160:163], v[48:51]
  v_exp_f32 v228, v150
  v_cvt_pk_bf16_f32 v170, v226, v227
  v_mfma_f32_16x16x32_bf16 v[56:59], a[88:91], v[164:167], v[56:59]
  s_waitcnt vmcnt(8)
  buffer_load_dwordx4 v212, s[12:15], s55 offen offset:0 nt lds
  ds_read_b128 a[112:115], v210 offset:32768
  v_add_f32 v236, v236, v226
  v_mfma_f32_16x16x32_bf16 v[52:55], a[92:95], v[160:163], v[52:55]
  v_exp_f32 v229, v151
  v_add_f32 v236, v236, v227
  v_mfma_f32_16x16x32_bf16 v[60:63], a[92:95], v[164:167], v[60:63]
  ds_read_b128 a[116:119], v210 offset:36864
  v_cvt_pk_bf16_f32 v171, v228, v229
  s_waitcnt lgkmcnt(3)
  v_mfma_f32_16x16x32_bf16 v[128:131], a[96:99], a[0:3], v[176:179]
  v_exp_f32 v222, v152
  v_add_f32 v236, v236, v228
  v_mfma_f32_16x16x32_bf16 v[136:139], a[96:99], a[4:7], v[180:183]
  ds_read_b128 a[120:123], v211 offset:32768
  v_add_f32 v236, v236, v229
  v_mfma_f32_16x16x32_bf16 v[132:135], a[100:103], a[0:3], v[176:179]
  v_exp_f32 v223, v153
  v_mfma_f32_16x16x32_bf16 v[140:143], a[100:103], a[4:7], v[180:183]
  ds_read_b128 a[124:127], v211 offset:36864
  v_cvt_pk_bf16_f32 v172, v222, v223
  v_add_f32 v237, v222, v223
  v_mfma_f32_16x16x32_bf16 v[128:131], a[104:107], a[8:11], v[128:131]
  v_exp_f32 v224, v154
  v_mfma_f32_16x16x32_bf16 v[136:139], a[104:107], a[12:15], v[136:139]
  ds_read_b64_tr_b16 a[64:65], v184 offset:24576
  ds_read_b64_tr_b16 a[66:67], v184 offset:28672
  s_waitcnt lgkmcnt(4)
  v_mfma_f32_16x16x32_bf16 v[132:135], a[108:111], a[8:11], v[132:135]
  v_exp_f32 v225, v155
  v_mfma_f32_16x16x32_bf16 v[140:143], a[108:111], a[12:15], v[140:143]
  s_waitcnt vmcnt(7)
  buffer_load_dwordx4 v213, s[12:15], s55 offen offset:1024 nt lds
  ds_read_b64_tr_b16 a[68:69], v185 offset:24576
  ds_read_b64_tr_b16 a[70:71], v185 offset:28672
  v_cvt_pk_bf16_f32 v173, v224, v225
  v_add_f32 v237, v237, v224
  v_add_f32 v237, v237, v225
  v_mfma_f32_16x16x32_bf16 v[128:131], a[112:115], a[16:19], v[128:131]
  v_exp_f32 v226, v156
  v_mfma_f32_16x16x32_bf16 v[136:139], a[112:115], a[20:23], v[136:139]
  ds_read_b64_tr_b16 a[72:73], v186 offset:24576
  ds_read_b64_tr_b16 a[74:75], v186 offset:28672
  v_mfma_f32_16x16x32_bf16 v[132:135], a[116:119], a[16:19], v[132:135]
  v_exp_f32 v227, v157
  v_mfma_f32_16x16x32_bf16 v[140:143], a[116:119], a[20:23], v[140:143]
  ds_read_b64_tr_b16 a[76:77], v187 offset:24576
  ds_read_b64_tr_b16 a[78:79], v187 offset:28672
  v_cvt_pk_bf16_f32 v174, v226, v227
  v_add_f32 v237, v237, v226
  v_add_f32 v237, v237, v227
  s_waitcnt lgkmcnt(6)
  v_mfma_f32_16x16x32_bf16 v[128:131], a[120:123], a[24:27], v[128:131]
  v_exp_f32 v228, v158
  v_mfma_f32_16x16x32_bf16 v[136:139], a[120:123], a[28:31], v[136:139]
  ds_read_b64_tr_b16 a[80:81], v188 offset:24576
  ds_read_b64_tr_b16 a[82:83], v188 offset:28672
  v_exp_f32 v229, v159
  v_mfma_f32_16x16x32_bf16 v[132:135], a[124:127], a[24:27], v[132:135]
  ds_read_b64_tr_b16 a[84:85], v189 offset:24576
  v_cvt_pk_bf16_f32 v175, v228, v229
  v_add_f32 v237, v237, v228
  v_add_f32 v237, v237, v229
  v_max_f32 v240, v236, v237
  v_cmp_lt_f32 vcc, s63, v240
  v_mfma_f32_16x16x32_bf16 v[140:143], a[124:127], a[28:31], v[140:143]
  ds_read_b64_tr_b16 a[86:87], v189 offset:28672
  s_cbranch_vccnz L_nors_47_r
L_nors_47:
  v_mfma_f32_16x16x32_bf16 v[0:3], a[64:67], v[168:171], v[0:3]
  ds_read_b64_tr_b16 a[88:89], v190 offset:24576
  v_add_f32 v234, v234, v236
  v_mfma_f32_16x16x32_bf16 v[8:11], a[64:67], v[172:175], v[8:11]
  s_waitcnt vmcnt(7)
  buffer_load_dwordx4 v214, s[12:15], s55 offen offset:2048 nt lds
  ds_read_b64_tr_b16 a[90:91], v190 offset:28672
  v_add_f32 v235, v235, v237
  s_waitcnt lgkmcnt(6)
  v_mfma_f32_16x16x32_bf16 v[4:7], a[68:71], v[168:171], v[4:7]
  ds_read_b64_tr_b16 a[92:93], v191 offset:24576
  ds_read_b64_tr_b16 a[94:95], v191 offset:28672
  v_mfma_f32_16x16x32_bf16 v[12:15], a[68:71], v[172:175], v[12:15]
  v_exp_f32 v222, v128
  v_mfma_f32_16x16x32_bf16 v[16:19], a[72:75], v[168:171], v[16:19]
  v_exp_f32 v223, v129
  v_mfma_f32_16x16x32_bf16 v[24:27], a[72:75], v[172:175], v[24:27]
  ds_read_b128 a[96:99], v208 offset:40960
  v_cvt_pk_bf16_f32 v160, v222, v223
  v_mfma_f32_16x16x32_bf16 v[20:23], a[76:79], v[168:171], v[20:23]
  v_exp_f32 v224, v130
  v_mfma_f32_16x16x32_bf16 v[28:31], a[76:79], v[172:175], v[28:31]
  ds_read_b128 a[100:103], v208 offset:45056
  v_add_f32 v236, v222, v223
  s_waitcnt lgkmcnt(4)
  v_mfma_f32_16x16x32_bf16 v[32:35], a[80:83], v[168:171], v[32:35]
  v_exp_f32 v225, v131
  v_mfma_f32_16x16x32_bf16 v[40:43], a[80:83], v[172:175], v[40:43]
  ds_read_b128 a[104:107], v209 offset:40960
  v_cvt_pk_bf16_f32 v161, v224, v225
  v_mfma_f32_16x16x32_bf16 v[36:39], a[84:87], v[168:171], v[36:39]
  ds_read_b128 a[108:111], v209 offset:45056
  v_add_f32 v236, v236, v224
  v_mfma_f32_16x16x32_bf16 v[44:47], a[84:87], v[172:175], v[44:47]
  s_waitcnt vmcnt(7)
  buffer_load_dwordx4 v215, s[12:15], s55 offen offset:3072 nt lds
  v_exp_f32 v226, v132
  v_add_f32 v236, v236, v225
  v_mfma_f32_16x16x32_bf16 v[48:51], a[88:91], v[168:171], v[48:51]
  v_exp_f32 v227, v133
  v_mfma_f32_16x16x32_bf16 v[56:59], a[88:91], v[172:175], v[56:59]
  ds_read_b128 a[112:115], v210 offset:40960
  v_cvt_pk_bf16_f32 v162, v226, v227
  v_add_f32 v236, v236, v226
  s_waitcnt lgkmcnt(3)
  v_mfma_f32_16x16x32_bf16 v[52:55], a[92:95], v[168:171], v[52:55]
  ds_read_b128 a[116:119], v210 offset:45056
  v_add_f32 v236, v236, v227
  v_mfma_f32_16x16x32_bf16 v[60:63], a[92:95], v[172:175], v[60:63]
  v_exp_f32 v228, v134
  s_barrier
  v_mfma_f32_16x16x32_bf16 v[144:147], a[96:99], a[0:3], v[176:179]
  v_exp_f32 v229, v135
  v_mfma_f32_16x16x32_bf16 v[152:155], a[96:99], a[4:7], v[180:183]
  ds_read_b128 a[120:123], v211 offset:40960
  v_cvt_pk_bf16_f32 v163, v228, v229
  v_add_f32 v236, v236, v228
  v_add_f32 v236, v236, v229
  v_mfma_f32_16x16x32_bf16 v[148:151], a[100:103], a[0:3], v[176:179]
  v_exp_f32 v222, v136
  v_mfma_f32_16x16x32_bf16 v[156:159], a[100:103], a[4:7], v[180:183]
  s_add_u32 m0, s45, 16384
  s_mov_b32 s55, 114688
  ds_read_b128 a[124:127], v211 offset:45056
  s_waitcnt lgkmcnt(3)
  v_mfma_f32_16x16x32_bf16 v[144:147], a[104:107], a[8:11], v[144:147]
  v_exp_f32 v223, v137
  v_mfma_f32_16x16x32_bf16 v[152:155], a[104:107], a[12:15], v[152:155]
  s_waitcnt vmcnt(6)
  buffer_load_dwordx4 v216, s[16:19], s55 offen offset:0 nt lds
  ds_read_b64_tr_b16 a[64:65], v184 offset:32768
  ds_read_b64_tr_b16 a[66:67], v184 offset:36864
  v_cvt_pk_bf16_f32 v164, v222, v223
  v_add_f32 v237, v222, v223
  v_mfma_f32_16x16x32_bf16 v[148:151], a[108:111], a[8:11], v[148:151]
  v_exp_f32 v224, v138
  v_mfma_f32_16x16x32_bf16 v[156:159], a[108:111], a[12:15], v[156:159]
  ds_read_b64_tr_b16 a[68:69], v185 offset:32768
  ds_read_b64_tr_b16 a[70:71], v185 offset:36864
  v_exp_f32 v225, v139
  v_mfma_f32_16x16x32_bf16 v[144:147], a[112:115], a[16:19], v[144:147]
  ds_read_b64_tr_b16 a[72:73], v186 offset:32768
  v_cvt_pk_bf16_f32 v165, v224, v225
  v_add_f32 v237, v237, v224
  v_add_f32 v237, v237, v225
  v_mfma_f32_16x16x32_bf16 v[152:155], a[112:115], a[20:23], v[152:155]
  ds_read_b64_tr_b16 a[74:75], v186 offset:36864
  ds_read_b64_tr_b16 a[76:77], v187 offset:32768
  v_exp_f32 v226, v140
  s_waitcnt lgkmcnt(7)
  v_mfma_f32_16x16x32_bf16 v[148:151], a[116:119], a[16:19], v[148:151]
  v_exp_f32 v227, v141
  v_mfma_f32_16x16x32_bf16 v[156:159], a[116:119], a[20:23], v[156:159]
  ds_read_b64_tr_b16 a[78:79], v187 offset:36864
  v_cvt_pk_bf16_f32 v166, v226, v227
  v_add_f32 v237, v237, v226
  v_add_f32 v237, v237, v227
  v_mfma_f32_16x16x32_bf16 v[144:147], a[120:123], a[24:27], v[144:147]
  v_exp_f32 v228, v142
  v_mfma_f32_16x16x32_bf16 v[152:155], a[120:123], a[28:31], v[152:155]
  ds_read_b64_tr_b16 a[80:81], v188 offset:32768
  ds_read_b64_tr_b16 a[82:83], v188 offset:36864
  v_exp_f32 v229, v143
  v_mfma_f32_16x16x32_bf16 v[148:151], a[124:127], a[24:27], v[148:151]
  ds_read_b64_tr_b16 a[84:85], v189 offset:32768
  v_cvt_pk_bf16_f32 v167, v228, v229
  v_add_f32 v237, v237, v228
  v_add_f32 v237, v237, v229
  v_max_f32 v240, v236, v237
  v_cmp_lt_f32 vcc, s63, v240
  v_mfma_f32_16x16x32_bf16 v[156:159], a[124:127], a[28:31], v[156:159]
  s_waitcnt vmcnt(6)
  buffer_load_dwordx4 v217, s[16:19], s55 offen offset:1024 nt lds
  ds_read_b64_tr_b16 a[86:87], v189 offset:36864
  s_cbranch_vccnz L_nors_48_r
L_nors_48:
  s_waitcnt lgkmcnt(5)
  v_mfma_f32_16x16x32_bf16 v[0:3], a[64:67], v[160:163], v[0:3]
  ds_read_b64_tr_b16 a[88:89], v190 offset:32768
  v_add_f32 v234, v234, v236
  v_mfma_f32_16x16x32_bf16 v[8:11], a[64:67], v[164:167], v[8:11]
  ds_read_b64_tr_b16 a[90:91], v190 offset:36864
  v_add_f32 v235, v235, v237
  v_mfma_f32_16x16x32_bf16 v[4:7], a[68:71], v[160:163], v[4:7]
  ds_read_b64_tr_b16 a[92:93], v191 offset:32768
  ds_read_b64_tr_b16 a[94:95], v191 offset:36864
  v_mfma_f32_16x16x32_bf16 v[12:15], a[68:71], v[164:167], v[12:15]
  s_barrier
  v_mfma_f32_16x16x32_bf16 v[16:19], a[72:75], v[160:163], v[16:19]
  v_exp_f32 v222, v144
  v_mfma_f32_16x16x32_bf16 v[24:27], a[72:75], v[164:167], v[24:27]
  ds_read_b128 a[96:99], v208 offset:0
  ds_read_b128 a[100:103], v208 offset:4096
  s_waitcnt lgkmcnt(6)
  v_mfma_f32_16x16x32_bf16 v[20:23], a[76:79], v[160:163], v[20:23]
  v_exp_f32 v223, v145
  v_mfma_f32_16x16x32_bf16 v[28:31], a[76:79], v[164:167], v[28:31]
  ds_read_b128 a[104:107], v209 offset:0
  v_cvt_pk_bf16_f32 v168, v222, v223
  v_mfma_f32_16x16x32_bf16 v[32:35], a[80:83], v[160:163], v[32:35]
  s_waitcnt vmcnt(5)
  buffer_load_dwordx4 v216, s[16:19], s55 offen offset:2048 nt lds
  v_mfma_f32_16x16x32_bf16 v[40:43], a[80:83], v[164:167], v[40:43]
  v_exp_f32 v224, v146
  v_mfma_f32_16x16x32_bf16 v[36:39], a[84:87], v[160:163], v[36:39]
  ds_read_b128 a[108:111], v209 offset:4096
  v_add_f32 v236, v222, v223
  v_mfma_f32_16x16x32_bf16 v[44:47], a[84:87], v[164:167], v[44:47]
  v_exp_f32 v225, v147
  s_waitcnt lgkmcnt(2)
  v_mfma_f32_16x16x32_bf16 v[48:51], a[88:91], v[160:163], v[48:51]
  ds_read_b128 a[112:115], v210 offset:0
  v_cvt_pk_bf16_f32 v169, v224, v225
  v_mfma_f32_16x16x32_bf16 v[56:59], a[88:91], v[164:167], v[56:59]
  v_exp_f32 v226, v148
  v_mfma_f32_16x16x32_bf16 v[52:55], a[92:95], v[160:163], v[52:55]
  ds_read_b128 a[116:119], v210 offset:4096
  v_add_f32 v236, v236, v224
  v_mfma_f32_16x16x32_bf16 v[60:63], a[92:95], v[164:167], v[60:63]
  ds_read_b128 a[120:123], v211 offset:0
  v_add_f32 v236, v236, v225
  v_mfma_f32_16x16x32_bf16 v[128:131], a[96:99], a[0:3], v[176:179]
  v_exp_f32 v227, v149
  v_mfma_f32_16x16x32_bf16 v[136:139], a[96:99], a[4:7], v[180:183]
  ds_read_b128 a[124:127], v211 offset:4096
  v_cvt_pk_bf16_f32 v170, v226, v227
  v_mfma_f32_16x16x32_bf16 v[132:135], a[100:103], a[0:3], v[176:179]
  s_waitcnt vmcnt(5)
  buffer_load_dwordx4 v217, s[16:19], s55 offen offset:3072 nt lds
  v_mfma_f32_16x16x32_bf16 v[140:143], a[100:103], a[4:7], v[180:183]
  ds_read_b64_tr_b16 a[64:65], v200 offset:0
  v_add_f32 v236, v236, v226
  s_waitcnt lgkmcnt(4)
  v_mfma_f32_16x16x32_bf16 v[128:131], a[104:107], a[8:11], v[128:131]
  v_exp_f32 v228, v150
  v_mfma_f32_16x16x32_bf16 v[136:139], a[104:107], a[12:15], v[136:139]
  ds_read_b64_tr_b16 a[66:67], v200 offset:4096
  ds_read_b64_tr_b16 a[68:69], v201 offset:0
  v_mfma_f32_16x16x32_bf16 v[132:135], a[108:111], a[8:11], v[132:135]
  v_exp_f32 v229, v151
  v_mfma_f32_16x16x32_bf16 v[140:143], a[108:111], a[12:15], v[140:143]
  ds_read_b64_tr_b16 a[70:71], v201 offset:4096
  ds_read_b64_tr_b16 a[72:73], v202 offset:0
  v_mfma_f32_16x16x32_bf16 v[128:131], a[112:115], a[16:19], v[128:131]
  ds_read_b64_tr_b16 a[74:75], v202 offset:4096
  v_add_f32 v236, v236, v227
  v_mfma_f32_16x16x32_bf16 v[136:139], a[112:115], a[20:23], v[136:139]
  v_exp_f32 v222, v152
  s_waitcnt lgkmcnt(5)
  v_mfma_f32_16x16x32_bf16 v[132:135], a[116:119], a[16:19], v[132:135]
  ds_read_b64_tr_b16 a[76:77], v203 offset:0
  v_cvt_pk_bf16_f32 v171, v228, v229
  v_mfma_f32_16x16x32_bf16 v[140:143], a[116:119], a[20:23], v[140:143]
  s_add_u32 m0, s45, 98304
  s_mov_b32 s55, 131072
  ds_read_b64_tr_b16 a[78:79], v203 offset:4096
  v_mfma_f32_16x16x32_bf16 v[128:131], a[120:123], a[24:27], v[128:131]
  ds_read_b64_tr_b16 a[80:81], v204 offset:0
  v_add_f32 v236, v236, v228
  v_mfma_f32_16x16x32_bf16 v[136:139], a[120:123], a[28:31], v[136:139]
  s_waitcnt vmcnt(5)
  buffer_load_dwordx4 v212, s[12:15], s55 offen offset:0 nt lds
  ds_read_b64_tr_b16 a[82:83], v204 offset:4096
  v_mfma_f32_16x16x32_bf16 v[132:135], a[124:127], a[24:27], v[132:135]
  v_exp_f32 v223, v153
  v_mfma_f32_16x16x32_bf16 v[140:143], a[124:127], a[28:31], v[140:143]
  ds_read_b64_tr_b16 a[84:85], v205 offset:0
  ds_read_b64_tr_b16 a[86:87], v205 offset:4096
  s_waitcnt lgkmcnt(6)
  v_mfma_f32_16x16x32_bf16 v[64:67], a[64:67], a[240:243], v[64:67]
  v_exp_f32 v224, v154
  v_mfma_f32_16x16x32_bf16 v[72:75], a[64:67], a[244:247], v[72:75]
  ds_read_b64_tr_b16 a[88:89], v206 offset:0
  ds_read_b64_tr_b16 a[90:91], v206 offset:4096
  v_add_f32 v236, v236, v229
  v_mfma_f32_16x16x32_bf16 v[68:71], a[68:71], a[240:243], v[68:71]
  ds_read_b64_tr_b16 a[92:93], v207 offset:0
  v_cvt_pk_bf16_f32 v172, v222, v223
  v_mfma_f32_16x16x32_bf16 v[76:79], a[68:71], a[244:247], v[76:79]
  ds_read_b64_tr_b16 a[94:95], v207 offset:4096
  v_add_f32 v237, v222, v223
  v_exp_f32 v225, v155
  v_mfma_f32_16x16x32_bf16 v[80:83], a[72:75], a[240:243], v[80:83]
  ds_read_b64_tr_b16 a[96:97], v184 offset:40960
  v_cvt_pk_bf16_f32 v173, v224, v225
  v_mfma_f32_16x16x32_bf16 v[88:91], a[72:75], a[244:247], v[88:91]
  ds_read_b64_tr_b16 a[98:99], v184 offset:45056
  v_add_f32 v237, v237, v224
  s_waitcnt lgkmcnt(6)
  v_mfma_f32_16x16x32_bf16 v[84:87], a[76:79], a[240:243], v[84:87]
  v_exp_f32 v226, v156
  v_add_f32 v237, v237, v225
  v_mfma_f32_16x16x32_bf16 v[92:95], a[76:79], a[244:247], v[92:95]
  s_waitcnt vmcnt(5)
  buffer_load_dwordx4 v213, s[12:15], s55 offen offset:1024 nt lds
  ds_read_b64_tr_b16 a[100:101], v185 offset:40960
  ds_read_b64_tr_b16 a[102:103], v185 offset:45056
  v_mfma_f32_16x16x32_bf16 v[96:99], a[80:83], a[240:243], v[96:99]
  v_exp_f32 v227, v157
  v_mfma_f32_16x16x32_bf16 v[104:107], a[80:83], a[244:247], v[104:107]
  ds_read_b64_tr_b16 a[104:105], v186 offset:40960
  ds_read_b64_tr_b16 a[106:107], v186 offset:45056
  v_cvt_pk_bf16_f32 v174, v226, v227
  v_add_f32 v237, v237, v226
  v_add_f32 v237, v237, v227
  v_mfma_f32_16x16x32_bf16 v[100:103], a[84:87], a[240:243], v[100:103]
  v_exp_f32 v228, v158
  v_mfma_f32_16x16x32_bf16 v[108:111], a[84:87], a[244:247], v[108:111]
  ds_read_b64_tr_b16 a[108:109], v187 offset:40960
  ds_read_b64_tr_b16 a[110:111], v187 offset:45056
  s_waitcnt lgkmcnt(6)
  v_mfma_f32_16x16x32_bf16 v[112:115], a[88:91], a[240:243], v[112:115]
  ds_read_b64_tr_b16 a[112:113], v188 offset:40960
  ds_read_b64_tr_b16 a[114:115], v188 offset:45056
  v_mfma_f32_16x16x32_bf16 v[120:123], a[88:91], a[244:247], v[120:123]
  v_exp_f32 v229, v159
  v_mfma_f32_16x16x32_bf16 v[116:119], a[92:95], a[240:243], v[116:119]
  ds_read_b64_tr_b16 a[116:117], v189 offset:40960
  v_cvt_pk_bf16_f32 v175, v228, v229
  v_add_f32 v237, v237, v228
  v_add_f32 v237, v237, v229
  v_max_f32 v240, v236, v237
  v_cmp_lt_f32 vcc, s63, v240
  v_mfma_f32_16x16x32_bf16 v[124:127], a[92:95], a[244:247], v[124:127]
  ds_read_b64_tr_b16 a[118:119], v189 offset:45056
  s_cbranch_vccnz L_nors_49_r
L_nors_49:
  v_mfma_f32_16x16x32_bf16 v[0:3], a[96:99], v[168:171], v[0:3]
  ds_read_b64_tr_b16 a[120:121], v190 offset:40960
  v_add_f32 v234, v234, v236
  v_mfma_f32_16x16x32_bf16 v[8:11], a[96:99], v[172:175], v[8:11]
  s_waitcnt vmcnt(5)
  buffer_load_dwordx4 v214, s[12:15], s55 offen offset:2048 nt lds
  ds_read_b64_tr_b16 a[122:123], v190 offset:45056
  v_add_f32 v235, v235, v237
  s_waitcnt lgkmcnt(6)
  v_mfma_f32_16x16x32_bf16 v[4:7], a[100:103], v[168:171], v[4:7]
  v_exp_f32 v222, v128
  v_mfma_f32_16x16x32_bf16 v[12:15], a[100:103], v[172:175], v[12:15]
  ds_read_b64_tr_b16 a[124:125], v191 offset:40960
  ds_read_b64_tr_b16 a[126:127], v191 offset:45056
  v_mfma_f32_16x16x32_bf16 v[16:19], a[104:107], v[168:171], v[16:19]
  v_exp_f32 v223, v129
  v_mfma_f32_16x16x32_bf16 v[24:27], a[104:107], v[172:175], v[24:27]
  ds_read_b128 a[64:67], v208 offset:8192
  ds_read_b128 a[68:71], v208 offset:12288
  v_mfma_f32_16x16x32_bf16 v[20:23], a[108:111], v[168:171], v[20:23]
  v_exp_f32 v224, v130
  v_mfma_f32_16x16x32_bf16 v[28:31], a[108:111], v[172:175], v[28:31]
  v_exp_f32 v225, v131
  s_waitcnt lgkmcnt(4)
  v_mfma_f32_16x16x32_bf16 v[32:35], a[112:115], v[168:171], v[32:35]
  ds_read_b128 a[72:75], v209 offset:8192
  v_cvt_pk_bf16_f32 v160, v222, v223
  v_mfma_f32_16x16x32_bf16 v[40:43], a[112:115], v[172:175], v[40:43]
  ds_read_b128 a[76:79], v209 offset:12288
  v_add_f32 v236, v222, v223
  v_mfma_f32_16x16x32_bf16 v[36:39], a[116:119], v[168:171], v[36:39]
  s_waitcnt vmcnt(5)
  buffer_load_dwordx4 v215, s[12:15], s55 offen offset:3072 nt lds
  v_mfma_f32_16x16x32_bf16 v[44:47], a[116:119], v[172:175], v[44:47]
  v_exp_f32 v226, v132
  v_mfma_f32_16x16x32_bf16 v[48:51], a[120:123], v[168:171], v[48:51]
  ds_read_b128 a[80:83], v210 offset:8192
  v_cvt_pk_bf16_f32 v161, v224, v225
  v_mfma_f32_16x16x32_bf16 v[56:59], a[120:123], v[172:175], v[56:59]
  v_exp_f32 v227, v133
  s_waitcnt lgkmcnt(3)
  v_mfma_f32_16x16x32_bf16 v[52:55], a[124:127], v[168:171], v[52:55]
  ds_read_b128 a[84:87], v210 offset:12288
  v_add_f32 v236, v236, v224
  v_mfma_f32_16x16x32_bf16 v[60:63], a[124:127], v[172:175], v[60:63]
  s_barrier
  v_mfma_f32_16x16x32_bf16 v[144:147], a[64:67], a[0:3], v[176:179]
  ds_read_b128 a[88:91], v211 offset:8192
  v_add_f32 v236, v236, v225
  v_mfma_f32_16x16x32_bf16 v[152:155], a[64:67], a[4:7], v[180:183]
  v_exp_f32 v228, v134
  v_mfma_f32_16x16x32_bf16 v[148:151], a[68:71], a[0:3], v[176:179]
  s_add_u32 m0, s45, 32768
  v_cvt_pk_bf16_f32 v162, v226, v227
  v_mfma_f32_16x16x32_bf16 v[156:159], a[68:71], a[4:7], v[180:183]
  s_mov_b32 s55, 131072
  ds_read_b128 a[92:95], v211 offset:12288
  s_waitcnt lgkmcnt(3)
  v_mfma_f32_16x16x32_bf16 v[144:147], a[72:75], a[8:11], v[144:147]
  ds_read_b64_tr_b16 a[96:97], v200 offset:8192
  v_add_f32 v236, v236, v226
  v_mfma_f32_16x16x32_bf16 v[152:155], a[72:75], a[12:15], v[152:155]
  s_waitcnt vmcnt(5)
  buffer_load_dwordx4 v216, s[16:19], s55 offen offset:0 nt lds
  ds_read_b64_tr_b16 a[98:99], v200 offset:12288
  v_mfma_f32_16x16x32_bf16 v[148:151], a[76:79], a[8:11], v[148:151]
  v_exp_f32 v229, v135
  v_mfma_f32_16x16x32_bf16 v[156:159], a[76:79], a[12:15], v[156:159]
  ds_read_b64_tr_b16 a[100:101], v201 offset:8192
  ds_read_b64_tr_b16 a[102:103], v201 offset:12288
  v_mfma_f32_16x16x32_bf16 v[144:147], a[80:83], a[16:19], v[144:147]
  v_exp_f32 v222, v136
  v_mfma_f32_16x16x32_bf16 v[152:155], a[80:83], a[20:23], v[152:155]
  ds_read_b64_tr_b16 a[104:105], v202 offset:8192
  ds_read_b64_tr_b16 a[106:107], v202 offset:12288
  s_waitcnt lgkmcnt(6)
  v_mfma_f32_16x16x32_bf16 v[148:151], a[84:87], a[16:19], v[148:151]
  ds_read_b64_tr_b16 a[108:109], v203 offset:8192
  v_add_f32 v236, v236, v227
  v_mfma_f32_16x16x32_bf16 v[156:159], a[84:87], a[20:23], v[156:159]
  ds_read_b64_tr_b16 a[110:111], v203 offset:12288
  ds_read_b64_tr_b16 a[112:113], v204 offset:8192
  v_mfma_f32_16x16x32_bf16 v[144:147], a[88:91], a[24:27], v[144:147]
  v_exp_f32 v223, v137
  v_mfma_f32_16x16x32_bf16 v[152:155], a[88:91], a[28:31], v[152:155]
  ds_read_b64_tr_b16 a[114:115], v204 offset:12288
  v_cvt_pk_bf16_f32 v163, v228, v229
  v_mfma_f32_16x16x32_bf16 v[148:151], a[92:95], a[24:27], v[148:151]
  v_exp_f32 v224, v138
  v_mfma_f32_16x16x32_bf16 v[156:159], a[92:95], a[28:31], v[156:159]
  s_waitcnt vmcnt(5)
  buffer_load_dwordx4 v217, s[16:19], s55 offen offset:1024 nt lds
  ds_read_b64_tr_b16 a[116:117], v205 offset:8192
  ds_read_b64_tr_b16 a[118:119], v205 offset:12288
  s_waitcnt lgkmcnt(6)
  v_mfma_f32_16x16x32_bf16 v[64:67], a[96:99], a[248:251], v[64:67]
  ds_read_b64_tr_b16 a[120:121], v206 offset:8192
  v_add_f32 v236, v236, v228
  v_mfma_f32_16x16x32_bf16 v[72:75], a[96:99], a[252:255], v[72:75]
  ds_read_b64_tr_b16 a[122:123], v206 offset:12288
  v_add_f32 v236, v236, v229
  v_mfma_f32_16x16x32_bf16 v[68:71], a[100:103], a[248:251], v[68:71]
  v_exp_f32 v225, v139
  v_cvt_pk_bf16_f32 v164, v222, v223
  v_mfma_f32_16x16x32_bf16 v[76:79], a[100:103], a[252:255], v[76:79]
  ds_read_b64_tr_b16 a[124:125], v207 offset:8192
  ds_read_b64_tr_b16 a[126:127], v207 offset:12288
  v_add_f32 v237, v222, v223
  v_mfma_f32_16x16x32_bf16 v[80:83], a[104:107], a[248:251], v[80:83]
  ds_read_b64_tr_b16 a[64:65], v184 offset:0
  v_cvt_pk_bf16_f32 v165, v224, v225
  v_mfma_f32_16x16x32_bf16 v[88:91], a[104:107], a[252:255], v[88:91]
  ds_read_b64_tr_b16 a[66:67], v184 offset:4096
  v_add_f32 v237, v237, v224
  v_exp_f32 v226, v140
  s_waitcnt lgkmcnt(6)
  v_mfma_f32_16x16x32_bf16 v[84:87], a[108:111], a[248:251], v[84:87]
  ds_read_b64_tr_b16 a[68:69], v185 offset:0
  v_add_f32 v237, v237, v225
  v_mfma_f32_16x16x32_bf16 v[92:95], a[108:111], a[252:255], v[92:95]
  ds_read_b64_tr_b16 a[70:71], v185 offset:4096
  ds_read_b64_tr_b16 a[72:73], v186 offset:0
  v_mfma_f32_16x16x32_bf16 v[96:99], a[112:115], a[248:251], v[96:99]
  v_exp_f32 v227, v141
  v_mfma_f32_16x16x32_bf16 v[104:107], a[112:115], a[252:255], v[104:107]
  s_waitcnt vmcnt(5)
  buffer_load_dwordx4 v216, s[16:19], s55 offen offset:2048 nt lds
  ds_read_b64_tr_b16 a[74:75], v186 offset:4096
  v_cvt_pk_bf16_f32 v166, v226, v227
  v_add_f32 v237, v237, v226
  v_add_f32 v237, v237, v227
  v_mfma_f32_16x16x32_bf16 v[100:103], a[116:119], a[248:251], v[100:103]
  v_exp_f32 v228, v142
  v_mfma_f32_16x16x32_bf16 v[108:111], a[116:119], a[252:255], v[108:111]
  ds_read_b64_tr_b16 a[76:77], v187 offset:0
  ds_read_b64_tr_b16 a[78:79], v187 offset:4096
  s_waitcnt lgkmcnt(6)
  v_mfma_f32_16x16x32_bf16 v[112:115], a[120:123], a[248:251], v[112:115]
  ds_read_b64_tr_b16 a[80:81], v188 offset:0
  ds_read_b64_tr_b16 a[82:83], v188 offset:4096
  v_mfma_f32_16x16x32_bf16 v[120:123], a[120:123], a[252:255], v[120:123]
  v_exp_f32 v229, v143
  v_mfma_f32_16x16x32_bf16 v[116:119], a[124:127], a[248:251], v[116:119]
  ds_read_b64_tr_b16 a[84:85], v189 offset:0
  v_cvt_pk_bf16_f32 v167, v228, v229
  v_add_f32 v237, v237, v228
  v_add_f32 v237, v237, v229
  v_max_f32 v240, v236, v237
  v_cmp_lt_f32 vcc, s63, v240
  v_mfma_f32_16x16x32_bf16 v[124:127], a[124:127], a[252:255], v[124:127]
  ds_read_b64_tr_b16 a[86:87], v189 offset:4096
  s_cbranch_vccnz L_nors_50_r
L_nors_50:
  v_mfma_f32_16x16x32_bf16 v[0:3], a[64:67], v[160:163], v[0:3]
  ds_read_b64_tr_b16 a[88:89], v190 offset:0
  v_add_f32 v234, v234, v236
  v_mfma_f32_16x16x32_bf16 v[8:11], a[64:67], v[164:167], v[8:11]
  ds_read_b64_tr_b16 a[90:91], v190 offset:4096
  v_add_f32 v235, v235, v237
  s_waitcnt lgkmcnt(6)
  v_mfma_f32_16x16x32_bf16 v[4:7], a[68:71], v[160:163], v[4:7]
  v_exp_f32 v222, v144
  v_exp_f32 v223, v145
  v_mfma_f32_16x16x32_bf16 v[12:15], a[68:71], v[164:167], v[12:15]
  s_waitcnt vmcnt(5)
  buffer_load_dwordx4 v217, s[16:19], s55 offen offset:3072 nt lds
  ds_read_b64_tr_b16 a[92:93], v191 offset:0
  ds_read_b64_tr_b16 a[94:95], v191 offset:4096
  s_barrier
  v_mfma_f32_16x16x32_bf16 v[16:19], a[72:75], v[160:163], v[16:19]
  v_exp_f32 v224, v146
  v_mfma_f32_16x16x32_bf16 v[24:27], a[72:75], v[164:167], v[24:27]
  ds_read_b128 a[96:99], v208 offset:16384
  v_mul_f32 v64, s64, v64
  v_mfma_f32_16x16x32_bf16 v[20:23], a[76:79], v[160:163], v[20:23]
  v_exp_f32 v225, v147
  v_mfma_f32_16x16x32_bf16 v[28:31], a[76:79], v[164:167], v[28:31]
  v_cmp_gt_u32 s[100:101], 16, v233
  s_nop 0
  s_cmp_eq_u64 s[100:101], 0
  s_cbranch_scc1 L_ok_102
  s_mov_b32 s62, 0x40000
L_spin_103:
  buffer_load_dword v233, v246, s[32:35], s52 offen sc1
  s_waitcnt vmcnt(0)
  v_cmp_gt_u32 s[100:101], 16, v233
  s_sub_u32 s62, s62, 1
  s_cmp_eq_u32 s62, 0
  s_cbranch_scc1 L_ok_102
  s_cmp_lg_u64 s[100:101], 0
  s_cbranch_scc1 L_spin_103
L_ok_102:
  ds_read_b128 a[100:103], v208 offset:20480
  v_cvt_pk_bf16_f32 v168, v222, v223
  s_waitcnt lgkmcnt(4)
  v_mfma_f32_16x16x32_bf16 v[32:35], a[80:83], v[160:163], v[32:35]
  v_add_f32 v236, v222, v223
  v_exp_f32 v226, v148
  v_mul_f32 v65, s64, v65
  v_mfma_f32_16x16x32_bf16 v[40:43], a[80:83], v[164:167], v[40:43]
  ds_read_b128 a[104:107], v209 offset:16384
  v_cvt_pk_bf16_f32 v169, v224, v225
  v_mfma_f32_16x16x32_bf16 v[36:39], a[84:87], v[160:163], v[36:39]
  v_add_f32 v236, v236, v224
  v_exp_f32 v227, v149
  v_mul_f32 v66, s64, v66
  v_mfma_f32_16x16x32_bf16 v[44:47], a[84:87], v[164:167], v[44:47]
  s_add_u32 m0, s45, 65536
  s_mov_b32 s55, 147456
  ds_read_b128 a[108:111], v209 offset:20480
  v_add_f32 v236, v236, v225
  v_mfma_f32_16x16x32_bf16 v[48:51], a[88:91], v[160:163], v[48:51]
  v_cvt_pk_bf16_f32 v170, v226, v227
  v_exp_f32 v228, v150
  v_mul_f32 v67, s64, v67
  v_mfma_f32_16x16x32_bf16 v[56:59], a[88:91], v[164:167], v[56:59]
  s_waitcnt vmcnt(5)
  buffer_load_dwordx4 v212, s[12:15], s55 offen offset:0 nt lds
  ds_read_b128 a[112:115], v210 offset:16384
  v_add_f32 v236, v236, v226
  s_waitcnt lgkmcnt(3)
  v_mfma_f32_16x16x32_bf16 v[52:55], a[92:95], v[160:163], v[52:55]
  v_add_f32 v236, v236, v227
  v_exp_f32 v229, v151
  v_mul_f32 v68, s64, v68
  v_mfma_f32_16x16x32_bf16 v[60:63], a[92:95], v[164:167], v[60:63]
  ds_read_b128 a[116:119], v210 offset:20480
  v_cvt_pk_bf16_f32 v171, v228, v229
  v_mfma_f32_16x16x32_bf16 v[128:131], a[96:99], a[0:3], v[176:179]
  v_add_f32 v236, v236, v228
  v_exp_f32 v222, v152
  v_mul_f32 v69, s64, v69
  v_mfma_f32_16x16x32_bf16 v[136:139], a[96:99], a[4:7], v[180:183]
  ds_read_b128 a[120:123], v211 offset:16384
  v_add_f32 v236, v236, v229
  v_mul_f32 v70, s64, v70
  v_mfma_f32_16x16x32_bf16 v[132:135], a[100:103], a[0:3], v[176:179]
  v_exp_f32 v223, v153
  v_mfma_f32_16x16x32_bf16 v[140:143], a[100:103], a[4:7], v[180:183]
  ds_read_b128 a[124:127], v211 offset:20480
  v_cvt_pk_bf16_f32 v172, v222, v223
  v_add_f32 v237, v222, v223
  v_mul_f32 v71, s64, v71
  s_waitcnt lgkmcnt(3)
  v_mfma_f32_16x16x32_bf16 v[128:131], a[104:107], a[8:11], v[128:131]
  v_exp_f32 v224, v154
  v_mfma_f32_16x16x32_bf16 v[136:139], a[104:107], a[12:15], v[136:139]
  ds_read_b64_tr_b16 a[64:65], v184 offset:8192
  ds_read_b64_tr_b16 a[66:67], v184 offset:12288
  v_cvt_pk_bf16_f32 v64, v64, v65
  v_mfma_f32_16x16x32_bf16 v[132:135], a[108:111], a[8:11], v[132:135]
  v_exp_f32 v225, v155
  v_mfma_f32_16x16x32_bf16 v[140:143], a[108:111], a[12:15], v[140:143]
  s_waitcnt vmcnt(5)
  buffer_load_dwordx4 v213, s[12:15], s55 offen offset:1024 nt lds
  ds_read_b64_tr_b16 a[68:69], v185 offset:8192
  ds_read_b64_tr_b16 a[70:71], v185 offset:12288
  v_cvt_pk_bf16_f32 v173, v224, v225
  v_add_f32 v237, v237, v224
  v_add_f32 v237, v237, v225
  v_cvt_pk_bf16_f32 v68, v68, v69
  v_mfma_f32_16x16x32_bf16 v[128:131], a[112:115], a[16:19], v[128:131]
  v_exp_f32 v226, v156
  v_mfma_f32_16x16x32_bf16 v[136:139], a[112:115], a[20:23], v[136:139]
  ds_read_b64_tr_b16 a[72:73], v186 offset:8192
L_pg5:
  s_cbranch_execz L_pg9
  ds_read_b64_tr_b16 a[74:75], v186 offset:12288
  v_cvt_pk_bf16_f32 v66, v66, v67
  s_waitcnt lgkmcnt(6)
  v_mfma_f32_16x16x32_bf16 v[132:135], a[116:119], a[16:19], v[132:135]
  v_exp_f32 v227, v157
  v_mfma_f32_16x16x32_bf16 v[140:143], a[116:119], a[20:23], v[140:143]
  ds_read_b64_tr_b16 a[76:77], v187 offset:8192
  ds_read_b64_tr_b16 a[78:79], v187 offset:12288
  v_cvt_pk_bf16_f32 v174, v226, v227
  v_add_f32 v237, v237, v226
  v_add_f32 v237, v237, v227
  v_cvt_pk_bf16_f32 v70, v70, v71
  v_mfma_f32_16x16x32_bf16 v[128:131], a[120:123], a[24:27], v[128:131]
  v_exp_f32 v228, v158
  v_mfma_f32_16x16x32_bf16 v[136:139], a[120:123], a[28:31], v[136:139]
  ds_read_b64_tr_b16 a[80:81], v188 offset:8192
  ds_read_b64_tr_b16 a[82:83], v188 offset:12288
  v_exp_f32 v229, v159
  v_mfma_f32_16x16x32_bf16 v[132:135], a[124:127], a[24:27], v[132:135]
  v_cvt_pk_bf16_f32 v175, v228, v229
  v_add_f32 v237, v237, v228
  v_add_f32 v237, v237, v229
  v_max_f32 v240, v236, v237
  v_cmp_lt_f32 vcc, s63, v240
  v_permlane16_swap_b32 v64, v68
  s_add_u32 s49, s42, 1
  v_mfma_f32_16x16x32_bf16 v[140:143], a[124:127], a[28:31], v[140:143]
  ds_read_b64_tr_b16 a[84:85], v189 offset:8192
  ds_read_b64_tr_b16 a[86:87], v189 offset:12288
  s_cbranch_vccnz L_nors_51_r
L_nors_51:
  s_waitcnt lgkmcnt(6)
  v_mfma_f32_16x16x32_bf16 v[0:3], a[64:67], v[168:171], v[0:3]
  v_add_f32 v234, v234, v236
  s_lshl_b32 s49, s49, 2
  v_mfma_f32_16x16x32_bf16 v[8:11], a[64:67], v[172:175], v[8:11]
  s_waitcnt vmcnt(5)
  buffer_load_dwordx4 v214, s[12:15], s55 offen offset:2048 nt lds
  ds_read_b64_tr_b16 a[88:89], v190 offset:8192
  ds_read_b64_tr_b16 a[90:91], v190 offset:12288
  v_add_f32 v235, v235, v237
  v_mfma_f32_16x16x32_bf16 v[4:7], a[68:71], v[168:171], v[4:7]
  v_permlane16_swap_b32 v66, v70
  v_mfma_f32_16x16x32_bf16 v[12:15], a[68:71], v[172:175], v[12:15]
  ds_read_b64_tr_b16 a[92:93], v191 offset:8192
  ds_read_b64_tr_b16 a[94:95], v191 offset:12288
  v_mfma_f32_16x16x32_bf16 v[16:19], a[72:75], v[168:171], v[16:19]
  v_exp_f32 v222, v128
  v_accvgpr_write_b32 a32, v64
  v_add_u32 v249, s49, v249
  v_mfma_f32_16x16x32_bf16 v[24:27], a[72:75], v[172:175], v[24:27]
  ds_read_b128 a[96:99], v208 offset:24576
  v_accvgpr_write_b32 a34, v68
  s_waitcnt lgkmcnt(5)
  v_mfma_f32_16x16x32_bf16 v[20:23], a[76:79], v[168:171], v[20:23]
  v_exp_f32 v223, v129
  v_mfma_f32_16x16x32_bf16 v[28:31], a[76:79], v[172:175], v[28:31]
  ds_read_b128 a[100:103], v208 offset:28672
  v_cvt_pk_bf16_f32 v160, v222, v223
  v_mfma_f32_16x16x32_bf16 v[32:35], a[80:83], v[168:171], v[32:35]
  v_add_f32 v236, v222, v223
  v_exp_f32 v224, v130
  v_accvgpr_write_b32 a33, v66
  v_mfma_f32_16x16x32_bf16 v[40:43], a[80:83], v[172:175], v[40:43]
  ds_read_b128 a[104:107], v209 offset:24576
  v_exp_f32 v225, v131
  v_accvgpr_write_b32 a35, v70
  v_mfma_f32_16x16x32_bf16 v[36:39], a[84:87], v[168:171], v[36:39]
  v_cvt_pk_bf16_f32 v161, v224, v225
  v_add_f32 v236, v236, v224
  v_and_b32 v249, 15, v249
  v_mfma_f32_16x16x32_bf16 v[44:47], a[84:87], v[172:175], v[44:47]
  s_waitcnt vmcnt(5)
  buffer_load_dwordx4 v215, s[12:15], s55 offen offset:3072 nt lds
  ds_read_b128 a[108:111], v209 offset:28672
  v_exp_f32 v226, v132
  v_add_f32 v236, v236, v225
  v_mul_f32 v72, s64, v72
  s_waitcnt lgkmcnt(3)
  v_mfma_f32_16x16x32_bf16 v[48:51], a[88:91], v[168:171], v[48:51]
  v_exp_f32 v227, v133
  v_mfma_f32_16x16x32_bf16 v[56:59], a[88:91], v[172:175], v[56:59]
  ds_read_b128 a[112:115], v210 offset:24576
  v_cvt_pk_bf16_f32 v162, v226, v227
  v_add_f32 v236, v236, v226
  v_mul_f32 v73, s64, v73
  v_mfma_f32_16x16x32_bf16 v[52:55], a[92:95], v[168:171], v[52:55]
  v_add_f32 v236, v236, v227
  v_lshlrev_b32 v248, 10, v248
  v_mfma_f32_16x16x32_bf16 v[60:63], a[92:95], v[172:175], v[60:63]
  ds_read_b128 a[116:119], v210 offset:28672
  v_exp_f32 v228, v134
  v_mul_f32 v74, s64, v74
  s_barrier
  v_mfma_f32_16x16x32_bf16 v[144:147], a[96:99], a[0:3], v[176:179]
  v_exp_f32 v229, v135
  v_mfma_f32_16x16x32_bf16 v[152:155], a[96:99], a[4:7], v[180:183]
  ds_read_b128 a[120:123], v211 offset:24576
  v_cvt_pk_bf16_f32 v163, v228, v229
  v_add_f32 v236, v236, v228
  v_add_f32 v236, v236, v229
  v_mul_f32 v75, s64, v75
  s_waitcnt lgkmcnt(3)
  v_mfma_f32_16x16x32_bf16 v[148:151], a[100:103], a[0:3], v[176:179]
  v_exp_f32 v222, v136
  v_mfma_f32_16x16x32_bf16 v[156:159], a[100:103], a[4:7], v[180:183]
  ds_read_b128 a[124:127], v211 offset:28672
  v_mul_f32 v76, s64, v76
  v_mfma_f32_16x16x32_bf16 v[144:147], a[104:107], a[8:11], v[144:147]
  v_exp_f32 v223, v137
  v_mfma_f32_16x16x32_bf16 v[152:155], a[104:107], a[12:15], v[152:155]
  s_add_u32 m0, s45, 0
  s_mov_b32 s55, 147456
  ds_read_b64_tr_b16 a[64:65], v184 offset:16384
  ds_read_b64_tr_b16 a[66:67], v184 offset:20480
  v_cvt_pk_bf16_f32 v164, v222, v223
  v_add_f32 v237, v222, v223
  v_mul_f32 v77, s64, v77
  v_mfma_f32_16x16x32_bf16 v[148:151], a[108:111], a[8:11], v[148:151]
  v_exp_f32 v224, v138
  v_mul_f32 v78, s64, v78
  v_mfma_f32_16x16x32_bf16 v[156:159], a[108:111], a[12:15], v[156:159]
  s_waitcnt vmcnt(5)
  buffer_load_dwordx4 v216, s[16:19], s55 offen offset:0 nt lds
  ds_read_b64_tr_b16 a[68:69], v185 offset:16384
  ds_read_b64_tr_b16 a[70:71], v185 offset:20480
  v_exp_f32 v225, v139
  s_waitcnt lgkmcnt(5)
  v_mfma_f32_16x16x32_bf16 v[144:147], a[112:115], a[16:19], v[144:147]
  v_cvt_pk_bf16_f32 v165, v224, v225
  v_add_f32 v237, v237, v224
  v_add_f32 v237, v237, v225
  v_mul_f32 v79, s64, v79
  v_lshl_add_u32 v218, v249, 4, v248
  v_mfma_f32_16x16x32_bf16 v[152:155], a[112:115], a[20:23], v[152:155]
  ds_read_b64_tr_b16 a[72:73], v186 offset:16384
  ds_read_b64_tr_b16 a[74:75], v186 offset:20480
  v_exp_f32 v226, v140
  v_xor_b32 v248, 0x80, v218
  v_add_u32 v219, 3072, v248
  v_add_u32 v220, 6144, v218
  v_add_u32 v221, 9216, v248
  v_mfma_f32_16x16x32_bf16 v[148:151], a[116:119], a[16:19], v[148:151]
  ds_read_b64_tr_b16 a[76:77], v187 offset:16384
  v_cvt_pk_bf16_f32 v72, v72, v73
  v_mfma_f32_16x16x32_bf16 v[156:159], a[116:119], a[20:23], v[156:159]
  ds_read_b64_tr_b16 a[78:79], v187 offset:20480
  v_exp_f32 v227, v141
  v_cvt_pk_bf16_f32 v76, v76, v77
  v_mfma_f32_16x16x32_bf16 v[144:147], a[120:123], a[24:27], v[144:147]
  v_cvt_pk_bf16_f32 v166, v226, v227
  v_add_f32 v237, v237, v226
  v_add_f32 v237, v237, v227
  v_cvt_pk_bf16_f32 v74, v74, v75
  v_mfma_f32_16x16x32_bf16 v[152:155], a[120:123], a[28:31], v[152:155]
  ds_read_b64_tr_b16 a[80:81], v188 offset:16384
  ds_read_b64_tr_b16 a[82:83], v188 offset:20480
  v_exp_f32 v228, v142
  v_exp_f32 v229, v143
  s_waitcnt lgkmcnt(6)
  v_mfma_f32_16x16x32_bf16 v[148:151], a[124:127], a[24:27], v[148:151]
  v_cvt_pk_bf16_f32 v167, v228, v229
  v_add_f32 v237, v237, v228
  v_add_f32 v237, v237, v229
  v_max_f32 v240, v236, v237
  v_cmp_lt_f32 vcc, s63, v240
  v_cvt_pk_bf16_f32 v78, v78, v79
  v_mfma_f32_16x16x32_bf16 v[156:159], a[124:127], a[28:31], v[156:159]
  s_waitcnt vmcnt(5)
  buffer_load_dwordx4 v217, s[16:19], s55 offen offset:1024 nt lds
  ds_read_b64_tr_b16 a[84:85], v189 offset:16384
  ds_read_b64_tr_b16 a[86:87], v189 offset:20480
  s_cbranch_vccnz L_nors_52_r
L_nors_52:
  v_mfma_f32_16x16x32_bf16 v[0:3], a[64:67], v[160:163], v[0:3]
  ds_read_b64_tr_b16 a[88:89], v190 offset:16384
  v_add_f32 v234, v234, v236
  v_mfma_f32_16x16x32_bf16 v[8:11], a[64:67], v[164:167], v[8:11]
  ds_read_b64_tr_b16 a[90:91], v190 offset:20480
  v_add_f32 v235, v235, v237
  v_mfma_f32_16x16x32_bf16 v[4:7], a[68:71], v[160:163], v[4:7]
  v_permlane16_swap_b32 v72, v76
  v_mfma_f32_16x16x32_bf16 v[12:15], a[68:71], v[164:167], v[12:15]
  ds_read_b64_tr_b16 a[92:93], v191 offset:16384
  ds_read_b64_tr_b16 a[94:95], v191 offset:20480
  s_barrier
  s_waitcnt lgkmcnt(6)
  v_mfma_f32_16x16x32_bf16 v[16:19], a[72:75], v[160:163], v[16:19]
  v_exp_f32 v222, v144
  v_mfma_f32_16x16x32_bf16 v[24:27], a[72:75], v[164:167], v[24:27]
  ds_read_b128 a[96:99], v208 offset:32768
  ds_read_b128 a[100:103], v208 offset:36864
  v_mfma_f32_16x16x32_bf16 v[20:23], a[76:79], v[160:163], v[20:23]
  v_exp_f32 v223, v145
  v_mfma_f32_16x16x32_bf16 v[28:31], a[76:79], v[164:167], v[28:31]
  s_waitcnt vmcnt(5)
  buffer_load_dwordx4 v216, s[16:19], s55 offen offset:2048 nt lds
  v_cvt_pk_bf16_f32 v168, v222, v223
  v_permlane16_swap_b32 v74, v78
  v_mfma_f32_16x16x32_bf16 v[32:35], a[80:83], v[160:163], v[32:35]
  v_exp_f32 v224, v146
  v_add_f32 v236, v222, v223
  v_mfma_f32_16x16x32_bf16 v[40:43], a[80:83], v[164:167], v[40:43]
  ds_read_b128 a[104:107], v209 offset:32768
  v_exp_f32 v225, v147
  v_accvgpr_write_b32 a36, v72
  s_waitcnt lgkmcnt(3)
  v_mfma_f32_16x16x32_bf16 v[36:39], a[84:87], v[160:163], v[36:39]
  v_cvt_pk_bf16_f32 v169, v224, v225
  v_add_f32 v236, v236, v224
  v_accvgpr_write_b32 a38, v76
  v_mfma_f32_16x16x32_bf16 v[44:47], a[84:87], v[164:167], v[44:47]
  ds_read_b128 a[108:111], v209 offset:36864
  v_add_f32 v236, v236, v225
  v_exp_f32 v226, v148
  v_mfma_f32_16x16x32_bf16 v[48:51], a[88:91], v[160:163], v[48:51]
  ds_read_b128 a[112:115], v210 offset:32768
  v_accvgpr_write_b32 a37, v74
  v_mfma_f32_16x16x32_bf16 v[56:59], a[88:91], v[164:167], v[56:59]
  v_exp_f32 v227, v149
  v_accvgpr_write_b32 a39, v78
  v_mul_f32 v80, s64, v80
  v_mfma_f32_16x16x32_bf16 v[52:55], a[92:95], v[160:163], v[52:55]
  v_cvt_pk_bf16_f32 v170, v226, v227
  v_add_f32 v236, v236, v226
  v_add_f32 v236, v236, v227
  v_mul_f32 v81, s64, v81
  v_mfma_f32_16x16x32_bf16 v[60:63], a[92:95], v[164:167], v[60:63]
  s_waitcnt vmcnt(5)
  buffer_load_dwordx4 v217, s[16:19], s55 offen offset:3072 nt lds
  ds_read_b128 a[116:119], v210 offset:36864
  v_exp_f32 v228, v150
  v_mul_f32 v82, s64, v82
  v_mul_f32 v83, s64, v83
  v_mul_f32 v84, s64, v84
  v_mul_f32 v85, s64, v85
  v_mul_f32 v86, s64, v86
  v_mul_f32 v87, s64, v87
  v_cvt_pk_bf16_f32 v80, v80, v81
  v_cvt_pk_bf16_f32 v84, v84, v85
  s_waitcnt lgkmcnt(3)
  v_mfma_f32_16x16x32_bf16 v[128:131], a[96:99], a[32:35], 0
  ds_read_b128 a[120:123], v211 offset:32768
  v_exp_f32 v229, v151
  v_cvt_pk_bf16_f32 v82, v82, v83
  v_cvt_pk_bf16_f32 v86, v86, v87
  v_permlane16_swap_b32 v80, v84
  s_nop 0
  v_permlane16_swap_b32 v82, v86
  v_accvgpr_write_b32 a40, v80
  v_accvgpr_write_b32 a42, v84
  v_accvgpr_write_b32 a41, v82
  v_accvgpr_write_b32 a43, v86
  v_mfma_f32_16x16x32_bf16 v[136:139], a[96:99], a[36:39], 0
  v_cvt_pk_bf16_f32 v171, v228, v229
  v_add_f32 v236, v236, v228
  v_add_f32 v236, v236, v229
  v_mul_f32 v88, s64, v88
  v_mul_f32 v89, s64, v89
  v_mul_f32 v90, s64, v90
  v_mul_f32 v91, s64, v91
  v_mul_f32 v92, s64, v92
  v_mul_f32 v93, s64, v93
  v_mul_f32 v94, s64, v94
  v_mul_f32 v95, s64, v95
  v_cvt_pk_bf16_f32 v88, v88, v89
  v_cvt_pk_bf16_f32 v92, v92, v93
  v_cvt_pk_bf16_f32 v90, v90, v91
  v_cvt_pk_bf16_f32 v94, v94, v95
  v_permlane16_swap_b32 v88, v92
  s_nop 0
  v_permlane16_swap_b32 v90, v94
  v_accvgpr_write_b32 a44, v88
  v_accvgpr_write_b32 a46, v92
  v_accvgpr_write_b32 a45, v90
  v_accvgpr_write_b32 a47, v94
  v_mfma_f32_16x16x32_bf16 v[132:135], a[100:103], a[32:35], 0
  v_exp_f32 v222, v152
  v_mfma_f32_16x16x32_bf16 v[140:143], a[100:103], a[36:39], 0
  ds_read_b128 a[124:127], v211 offset:36864
  v_mul_f32 v96, s64, v96
  v_mul_f32 v97, s64, v97
  v_mul_f32 v98, s64, v98
  v_mul_f32 v99, s64, v99
  v_mul_f32 v100, s64, v100
  v_mul_f32 v101, s64, v101
  v_mul_f32 v102, s64, v102
  v_mul_f32 v103, s64, v103
  v_cvt_pk_bf16_f32 v96, v96, v97
  v_cvt_pk_bf16_f32 v100, v100, v101
  v_mfma_f32_16x16x32_bf16 v[128:131], a[104:107], a[40:43], v[128:131]
  ds_read_b64_tr_b16 a[64:65], v184 offset:24576
  v_exp_f32 v223, v153
  v_cvt_pk_bf16_f32 v98, v98, v99
  v_cvt_pk_bf16_f32 v102, v102, v103
  v_permlane16_swap_b32 v96, v100
  s_nop 0
  v_permlane16_swap_b32 v98, v102
  v_accvgpr_write_b32 a48, v96
  v_accvgpr_write_b32 a50, v100
  v_accvgpr_write_b32 a49, v98
  v_accvgpr_write_b32 a51, v102
  v_mfma_f32_16x16x32_bf16 v[136:139], a[104:107], a[44:47], v[136:139]
  ds_read_b64_tr_b16 a[66:67], v184 offset:28672
  v_cvt_pk_bf16_f32 v172, v222, v223
  v_add_f32 v237, v222, v223
  v_mul_f32 v104, s64, v104
  v_mul_f32 v105, s64, v105
  v_mul_f32 v106, s64, v106
  v_mul_f32 v107, s64, v107
  v_mul_f32 v108, s64, v108
  v_mul_f32 v109, s64, v109
  v_mul_f32 v110, s64, v110
  v_mul_f32 v111, s64, v111
  v_cvt_pk_bf16_f32 v104, v104, v105
  v_cvt_pk_bf16_f32 v108, v108, v109
  v_cvt_pk_bf16_f32 v106, v106, v107
  v_cvt_pk_bf16_f32 v110, v110, v111
  v_permlane16_swap_b32 v104, v108
  s_nop 0
  v_permlane16_swap_b32 v106, v110
  v_accvgpr_write_b32 a52, v104
  v_accvgpr_write_b32 a54, v108
  v_accvgpr_write_b32 a53, v106
  v_accvgpr_write_b32 a55, v110
  v_mul_f32 v112, s64, v112
  v_mul_f32 v113, s64, v113
  v_mul_f32 v114, s64, v114
  v_mul_f32 v115, s64, v115
  v_mul_f32 v116, s64, v116
  v_mul_f32 v117, s64, v117
  v_mul_f32 v118, s64, v118
  v_mul_f32 v119, s64, v119
  v_cvt_pk_bf16_f32 v112, v112, v113
  v_cvt_pk_bf16_f32 v116, v116, v117
  v_cvt_pk_bf16_f32 v114, v114, v115
  v_cvt_pk_bf16_f32 v118, v118, v119
  v_permlane16_swap_b32 v112, v116
  s_nop 0
  v_permlane16_swap_b32 v114, v118
  v_accvgpr_write_b32 a56, v112
  v_accvgpr_write_b32 a58, v116
  v_accvgpr_write_b32 a57, v114
  v_accvgpr_write_b32 a59, v118
  v_mul_f32 v120, s64, v120
  v_mul_f32 v121, s64, v121
  v_mul_f32 v122, s64, v122
  v_mul_f32 v123, s64, v123
  v_mul_f32 v124, s64, v124
  v_mul_f32 v125, s64, v125
  v_mul_f32 v126, s64, v126
  v_mul_f32 v127, s64, v127
  v_cvt_pk_bf16_f32 v120, v120, v121
  v_cvt_pk_bf16_f32 v124, v124, v125
  v_cvt_pk_bf16_f32 v122, v122, v123
  v_cvt_pk_bf16_f32 v126, v126, v127
  v_permlane16_swap_b32 v120, v124
  s_nop 0
  v_permlane16_swap_b32 v122, v126
  s_waitcnt lgkmcnt(4)
  v_mfma_f32_16x16x32_bf16 v[132:135], a[108:111], a[40:43], v[132:135]
  v_exp_f32 v224, v154
  v_accvgpr_write_b32 a60, v120
  v_mfma_f32_16x16x32_bf16 v[140:143], a[108:111], a[44:47], v[140:143]
  s_add_u32 m0, s45, 81920
  s_mov_b32 s55, 163840
  ds_read_b64_tr_b16 a[68:69], v185 offset:24576
  ds_read_b64_tr_b16 a[70:71], v185 offset:28672
  v_exp_f32 v225, v155
  v_mfma_f32_16x16x32_bf16 v[128:131], a[112:115], a[48:51], v[128:131]
  v_cvt_pk_bf16_f32 v173, v224, v225
  v_add_f32 v237, v237, v224
  v_add_f32 v237, v237, v225
  v_accvgpr_write_b32 a62, v124
  v_mfma_f32_16x16x32_bf16 v[136:139], a[112:115], a[52:55], v[136:139]
  s_waitcnt vmcnt(5)
  buffer_load_dwordx4 v212, s[12:15], s55 offen offset:0 nt lds
  ds_read_b64_tr_b16 a[72:73], v186 offset:24576
  ds_read_b64_tr_b16 a[74:75], v186 offset:28672
  v_exp_f32 v226, v156
  v_accvgpr_write_b32 a61, v122
  v_accvgpr_write_b32 a63, v126
  v_mfma_f32_16x16x32_bf16 v[132:135], a[116:119], a[48:51], v[132:135]
  v_exp_f32 v227, v157
  v_mfma_f32_16x16x32_bf16 v[140:143], a[116:119], a[52:55], v[140:143]
  ds_read_b64_tr_b16 a[76:77], v187 offset:24576
  ds_read_b64_tr_b16 a[78:79], v187 offset:28672
  v_cvt_pk_bf16_f32 v174, v226, v227
  v_add_f32 v237, v237, v226
  v_add_f32 v237, v237, v227
  s_waitcnt lgkmcnt(6)
  v_mfma_f32_16x16x32_bf16 v[128:131], a[120:123], a[56:59], v[128:131]
  v_exp_f32 v228, v158
  v_mfma_f32_16x16x32_bf16 v[136:139], a[120:123], a[60:63], v[136:139]
  ds_read_b64_tr_b16 a[80:81], v188 offset:24576
  ds_read_b64_tr_b16 a[82:83], v188 offset:28672
  v_exp_f32 v229, v159
  v_mfma_f32_16x16x32_bf16 v[132:135], a[124:127], a[56:59], v[132:135]
  ds_read_b64_tr_b16 a[84:85], v189 offset:24576
  v_cvt_pk_bf16_f32 v175, v228, v229
  v_add_f32 v237, v237, v228
  v_add_f32 v237, v237, v229
  v_max_f32 v240, v236, v237
  v_cmp_lt_f32 vcc, s63, v240
  v_mfma_f32_16x16x32_bf16 v[140:143], a[124:127], a[60:63], v[140:143]
  ds_read_b64_tr_b16 a[86:87], v189 offset:28672
  s_cbranch_vccnz L_nors_53_r
L_nors_53:
  v_mfma_f32_16x16x32_bf16 v[0:3], a[64:67], v[168:171], v[0:3]
  ds_read_b64_tr_b16 a[88:89], v190 offset:24576
  v_add_f32 v234, v234, v236
  v_mfma_f32_16x16x32_bf16 v[8:11], a[64:67], v[172:175], v[8:11]
  s_waitcnt vmcnt(5)
  buffer_load_dwordx4 v213, s[12:15], s55 offen offset:1024 nt lds
  ds_read_b64_tr_b16 a[90:91], v190 offset:28672
  v_add_f32 v235, v235, v237
  s_waitcnt lgkmcnt(6)
  v_mfma_f32_16x16x32_bf16 v[4:7], a[68:71], v[168:171], v[4:7]
  ds_read_b64_tr_b16 a[92:93], v191 offset:24576
  v_mov_b32 v240, v234
  v_mfma_f32_16x16x32_bf16 v[12:15], a[68:71], v[172:175], v[12:15]
  ds_read_b64_tr_b16 a[94:95], v191 offset:28672
  v_mov_b32 v241, v235
  v_mfma_f32_16x16x32_bf16 v[16:19], a[72:75], v[168:171], v[16:19]
  v_permlane32_swap_b32 v234, v240
  v_permlane32_swap_b32 v235, v241
  v_add_f32 v234, v234, v240
  v_mfma_f32_16x16x32_bf16 v[24:27], a[72:75], v[172:175], v[24:27]
  ds_read_b128 a[96:99], v208 offset:40960
  v_add_f32 v235, v235, v241
  v_mov_b32 v240, v234
  v_mov_b32 v241, v235
  v_mfma_f32_16x16x32_bf16 v[20:23], a[76:79], v[168:171], v[20:23]
  v_permlane16_swap_b32 v234, v240
  v_permlane16_swap_b32 v235, v241
  v_add_f32 v234, v234, v240
  v_mfma_f32_16x16x32_bf16 v[28:31], a[76:79], v[172:175], v[28:31]
  ds_read_b128 a[100:103], v208 offset:45056
  v_add_f32 v235, v235, v241
  v_max_f32 v242, v234, v247
  v_max_f32 v244, v235, v247
  s_waitcnt lgkmcnt(4)
  v_mfma_f32_16x16x32_bf16 v[32:35], a[80:83], v[168:171], v[32:35]
  v_rcp_f32 v242, v242
  v_rcp_f32 v244, v244
  v_max3_f32 v238, v128, v129, v130
  v_mfma_f32_16x16x32_bf16 v[40:43], a[80:83], v[172:175], v[40:43]
  s_waitcnt vmcnt(5)
  buffer_load_dwordx4 v214, s[12:15], s55 offen offset:2048 nt lds
  ds_read_b128 a[104:107], v209 offset:40960
  v_max3_f32 v238, v238, v131, v132
  v_max3_f32 v238, v238, v133, v134
  v_max3_f32 v238, v238, v135, v247
  v_max3_f32 v239, v136, v137, v138
  v_mfma_f32_16x16x32_bf16 v[36:39], a[84:87], v[168:171], v[36:39]
  ds_read_b128 a[108:111], v209 offset:45056
  v_max3_f32 v239, v239, v139, v140
  v_max3_f32 v239, v239, v141, v142
  v_max3_f32 v239, v239, v143, v247
  v_mfma_f32_16x16x32_bf16 v[44:47], a[84:87], v[172:175], v[44:47]
  ds_read_b128 a[112:115], v210 offset:40960
  v_mov_b32 v240, v238
  v_mov_b32 v241, v239
  s_nop 0
  v_permlane32_swap_b32 v238, v240
  v_mfma_f32_16x16x32_bf16 v[48:51], a[88:91], v[168:171], v[48:51]
  v_permlane32_swap_b32 v239, v241
  v_max_f32 v238, v238, v240
  v_max_f32 v239, v239, v241
  v_mfma_f32_16x16x32_bf16 v[56:59], a[88:91], v[172:175], v[56:59]
  ds_read_b128 a[116:119], v210 offset:45056
  v_mov_b32 v240, v238
  v_mov_b32 v241, v239
  s_nop 0
  v_permlane16_swap_b32 v238, v240
  s_waitcnt lgkmcnt(4)
  v_mfma_f32_16x16x32_bf16 v[52:55], a[92:95], v[168:171], v[52:55]
  v_permlane16_swap_b32 v239, v241
  v_max_f32 v238, v238, v240
  v_max_f32 v239, v239, v241
  v_mfma_f32_16x16x32_bf16 v[60:63], a[92:95], v[172:175], v[60:63]
  v_sub_f32 v176, 0, v238
  v_sub_f32 v177, 0, v238
  v_sub_f32 v178, 0, v238
  v_sub_f32 v179, 0, v238
  v_sub_f32 v180, 0, v239
  v_sub_f32 v181, 0, v239
  v_sub_f32 v182, 0, v239
  v_sub_f32 v183, 0, v239
  s_barrier
  v_mfma_f32_16x16x32_bf16 v[144:147], a[96:99], a[32:35], v[176:179]
  ds_read_b128 a[120:123], v211 offset:40960
  v_sub_f32 v128, v128, v238
  v_mfma_f32_16x16x32_bf16 v[152:155], a[96:99], a[36:39], v[180:183]
  s_waitcnt vmcnt(5)
  buffer_load_dwordx4 v215, s[12:15], s55 offen offset:3072 nt lds
  v_sub_f32 v129, v129, v238
  v_mfma_f32_16x16x32_bf16 v[148:151], a[100:103], a[32:35], v[176:179]
  v_exp_f32 v222, v128
  v_exp_f32 v223, v129
  v_mfma_f32_16x16x32_bf16 v[156:159], a[100:103], a[36:39], v[180:183]
  ds_read_b128 a[124:127], v211 offset:45056
  v_cvt_pk_bf16_f32 v160, v222, v223
  v_add_f32 v234, v222, v223
  v_sub_f32 v130, v130, v238
  v_sub_f32 v131, v131, v238
  v_exp_f32 v224, v130
  s_waitcnt lgkmcnt(2)
  v_mfma_f32_16x16x32_bf16 v[144:147], a[104:107], a[40:43], v[144:147]
  v_exp_f32 v225, v131
  v_sub_f32 v132, v132, v238
  v_mfma_f32_16x16x32_bf16 v[152:155], a[104:107], a[44:47], v[152:155]
  ds_read_b64_tr_b16 a[64:65], v184 offset:32768
  ds_read_b64_tr_b16 a[66:67], v184 offset:36864
  v_cvt_pk_bf16_f32 v161, v224, v225
  v_add_f32 v234, v234, v224
  v_add_f32 v234, v234, v225
  v_sub_f32 v133, v133, v238
  v_exp_f32 v226, v132
  v_mfma_f32_16x16x32_bf16 v[148:151], a[108:111], a[40:43], v[148:151]
  v_exp_f32 v227, v133
  v_sub_f32 v134, v134, v238
  v_sub_f32 v135, v135, v238
  v_mfma_f32_16x16x32_bf16 v[156:159], a[108:111], a[44:47], v[156:159]
  ds_read_b64_tr_b16 a[68:69], v185 offset:32768
  ds_read_b64_tr_b16 a[70:71], v185 offset:36864
  v_cvt_pk_bf16_f32 v162, v226, v227
  v_add_f32 v234, v234, v226
  v_add_f32 v234, v234, v227
  v_exp_f32 v228, v134
  v_exp_f32 v229, v135
  v_mfma_f32_16x16x32_bf16 v[144:147], a[112:115], a[48:51], v[144:147]
  v_sub_f32 v136, v136, v239
  v_cvt_pk_bf16_f32 v163, v228, v229
  v_add_f32 v234, v234, v228
  v_add_f32 v234, v234, v229
  v_sub_f32 v137, v137, v239
  v_mfma_f32_16x16x32_bf16 v[152:155], a[112:115], a[52:55], v[152:155]
  s_add_u32 m0, s45, 16384
  s_mov_b32 s55, 163840
  ds_read_b64_tr_b16 a[72:73], v186 offset:32768
  ds_read_b64_tr_b16 a[74:75], v186 offset:36864
  v_exp_f32 v222, v136
  v_exp_f32 v223, v137
  v_mfma_f32_16x16x32_bf16 v[148:151], a[116:119], a[48:51], v[148:151]
  v_sub_f32 v138, v138, v239
  v_cvt_pk_bf16_f32 v164, v222, v223
  v_add_f32 v235, v222, v223
  v_sub_f32 v139, v139, v239
  v_exp_f32 v224, v138
  v_mfma_f32_16x16x32_bf16 v[156:159], a[116:119], a[52:55], v[156:159]
  s_waitcnt vmcnt(5)
  buffer_load_dwordx4 v216, s[16:19], s55 offen offset:0 nt lds
  ds_read_b64_tr_b16 a[76:77], v187 offset:32768
  ds_read_b64_tr_b16 a[78:79], v187 offset:36864
  v_exp_f32 v225, v139
  v_sub_f32 v140, v140, v239
  s_waitcnt lgkmcnt(6)
  v_mfma_f32_16x16x32_bf16 v[144:147], a[120:123], a[56:59], v[144:147]
  v_sub_f32 v141, v141, v239
  v_cvt_pk_bf16_f32 v165, v224, v225
  v_add_f32 v235, v235, v224
  v_add_f32 v235, v235, v225
  v_exp_f32 v226, v140
  v_mfma_f32_16x16x32_bf16 v[152:155], a[120:123], a[60:63], v[152:155]
  ds_read_b64_tr_b16 a[80:81], v188 offset:32768
  ds_read_b64_tr_b16 a[82:83], v188 offset:36864
  v_exp_f32 v227, v141
  v_sub_f32 v142, v142, v239
  v_sub_f32 v143, v143, v239
  v_exp_f32 v228, v142
  v_exp_f32 v229, v143
  v_mfma_f32_16x16x32_bf16 v[148:151], a[124:127], a[56:59], v[148:151]
  v_cvt_pk_bf16_f32 v166, v226, v227
  v_add_f32 v235, v235, v226
  v_add_f32 v235, v235, v227
  v_cvt_pk_bf16_f32 v167, v228, v229
  v_mul_f32 v0, v0, v242
  v_mfma_f32_16x16x32_bf16 v[156:159], a[124:127], a[60:63], v[156:159]
  ds_read_b64_tr_b16 a[84:85], v189 offset:32768
  ds_read_b64_tr_b16 a[86:87], v189 offset:36864
  v_add_f32 v235, v235, v228
  v_add_f32 v235, v235, v229
  v_mfma_f32_16x16x32_bf16 v[64:67], a[64:67], v[160:163], 0
  ds_read_b64_tr_b16 a[88:89], v190 offset:32768
  v_mul_f32 v1, v1, v242
  v_mfma_f32_16x16x32_bf16 v[72:75], a[64:67], v[164:167], 0
  ds_read_b64_tr_b16 a[90:91], v190 offset:36864
  ds_read_b64_tr_b16 a[92:93], v191 offset:32768
  s_waitcnt lgkmcnt(7)
  v_mfma_f32_16x16x32_bf16 v[68:71], a[68:71], v[160:163], 0
  v_exp_f32 v222, v144
  v_mfma_f32_16x16x32_bf16 v[76:79], a[68:71], v[164:167], 0
  s_waitcnt vmcnt(5)
  buffer_load_dwordx4 v217, s[16:19], s55 offen offset:1024 nt lds
  ds_read_b64_tr_b16 a[94:95], v191 offset:36864
  s_barrier
  v_mfma_f32_16x16x32_bf16 v[80:83], a[72:75], v[160:163], 0
  v_exp_f32 v223, v145
  v_mfma_f32_16x16x32_bf16 v[88:91], a[72:75], v[164:167], 0
  ds_read_b128 a[96:99], v208 offset:0
  v_cvt_pk_bf16_f32 v168, v222, v223
  v_mfma_f32_16x16x32_bf16 v[84:87], a[76:79], v[160:163], 0
  v_exp_f32 v224, v146
  v_mfma_f32_16x16x32_bf16 v[92:95], a[76:79], v[164:167], 0
  s_add_u32 m0, s45, 147456
  s_add_u32 s54, s56, 131072
  ds_read_b128 a[100:103], v208 offset:4096
  s_waitcnt lgkmcnt(3)
  v_mfma_f32_16x16x32_bf16 v[96:99], a[80:83], v[160:163], 0
  v_add_f32 v236, v222, v223
  v_cvt_pk_bf16_f32 v0, v0, v1
  v_mfma_f32_16x16x32_bf16 v[104:107], a[80:83], v[164:167], 0
  buffer_load_dwordx4 v218, s[24:27], s54 offen offset:0 lds
  ds_read_b128 a[104:107], v209 offset:0
  v_exp_f32 v225, v147
  v_mfma_f32_16x16x32_bf16 v[100:103], a[84:87], v[160:163], 0
  v_cvt_pk_bf16_f32 v169, v224, v225
  v_add_f32 v236, v236, v224
  v_accvgpr_write_b32 a128, v0
  v_mfma_f32_16x16x32_bf16 v[108:111], a[84:87], v[164:167], 0
  s_add_u32 m0, s45, 16384
  s_waitcnt vmcnt(6)
  buffer_load_dwordx4 v216, s[16:19], s55 offen offset:2048 nt lds
  ds_read_b128 a[108:111], v209 offset:4096
  v_exp_f32 v226, v148
  v_add_f32 v236, v236, v225
  v_mfma_f32_16x16x32_bf16 v[112:115], a[88:91], v[160:163], 0
  v_exp_f32 v227, v149
  v_mfma_f32_16x16x32_bf16 v[120:123], a[88:91], v[164:167], 0
  ds_read_b128 a[112:115], v210 offset:0
  v_cvt_pk_bf16_f32 v170, v226, v227
  v_add_f32 v236, v236, v226
  s_waitcnt lgkmcnt(3)
  v_mfma_f32_16x16x32_bf16 v[116:119], a[92:95], v[160:163], 0
  v_add_f32 v236, v236, v227
  v_mul_f32 v2, v2, v242
  v_mfma_f32_16x16x32_bf16 v[124:127], a[92:95], v[164:167], 0
  ds_read_b128 a[116:119], v210 offset:4096
  ds_read_b128 a[120:123], v211 offset:0
  v_exp_f32 v228, v150
  v_mfma_f32_16x16x32_bf16 v[128:131], a[96:99], a[32:35], v[176:179]
  v_exp_f32 v229, v151
  v_mfma_f32_16x16x32_bf16 v[136:139], a[96:99], a[36:39], v[180:183]
  v_cvt_pk_bf16_f32 v171, v228, v229
  v_add_f32 v236, v236, v228
  v_add_f32 v236, v236, v229
  v_mul_f32 v3, v3, v242
  v_mfma_f32_16x16x32_bf16 v[132:135], a[100:103], a[32:35], v[176:179]
  v_exp_f32 v222, v152
  v_mfma_f32_16x16x32_bf16 v[140:143], a[100:103], a[36:39], v[180:183]
  s_waitcnt vmcnt(6)
  buffer_load_dwordx4 v217, s[16:19], s55 offen offset:3072 nt lds
  ds_read_b128 a[124:127], v211 offset:4096
  s_waitcnt lgkmcnt(3)
  v_mfma_f32_16x16x32_bf16 v[128:131], a[104:107], a[40:43], v[128:131]
  v_exp_f32 v223, v153
  v_mfma_f32_16x16x32_bf16 v[136:139], a[104:107], a[44:47], v[136:139]
  ds_read_b64_tr_b16 a[64:65], v184 offset:40960
  ds_read_b64_tr_b16 a[66:67], v184 offset:45056
  v_cvt_pk_bf16_f32 v172, v222, v223
  v_add_f32 v237, v222, v223
  v_mfma_f32_16x16x32_bf16 v[132:135], a[108:111], a[40:43], v[132:135]
  v_exp_f32 v224, v154
  v_mfma_f32_16x16x32_bf16 v[140:143], a[108:111], a[44:47], v[140:143]
  ds_read_b64_tr_b16 a[68:69], v185 offset:40960
  ds_read_b64_tr_b16 a[70:71], v185 offset:45056
  v_exp_f32 v225, v155
  v_mfma_f32_16x16x32_bf16 v[128:131], a[112:115], a[48:51], v[128:131]
  v_cvt_pk_bf16_f32 v173, v224, v225
  v_add_f32 v237, v237, v224
L_pg6:
  s_cbranch_execz L_pg10
  v_add_f32 v237, v237, v225
  v_cvt_pk_bf16_f32 v2, v2, v3
  v_mfma_f32_16x16x32_bf16 v[136:139], a[112:115], a[52:55], v[136:139]
  s_add_u32 m0, s45, 147456
  s_nop 0
  buffer_load_dwordx4 v219, s[24:27], s54 offen offset:1024 lds
  ds_read_b64_tr_b16 a[72:73], v186 offset:40960
  ds_read_b64_tr_b16 a[74:75], v186 offset:45056
  v_exp_f32 v226, v156
  s_waitcnt lgkmcnt(6)
  v_mfma_f32_16x16x32_bf16 v[132:135], a[116:119], a[48:51], v[132:135]
  v_exp_f32 v227, v157
  v_mfma_f32_16x16x32_bf16 v[140:143], a[116:119], a[52:55], v[140:143]
  s_add_u32 m0, s45, 98304
  s_mov_b32 s55, 180224
  ds_read_b64_tr_b16 a[76:77], v187 offset:40960
  ds_read_b64_tr_b16 a[78:79], v187 offset:45056
  v_cvt_pk_bf16_f32 v174, v226, v227
  v_add_f32 v237, v237, v226
  v_add_f32 v237, v237, v227
  v_mfma_f32_16x16x32_bf16 v[128:131], a[120:123], a[56:59], v[128:131]
  v_exp_f32 v228, v158
  v_mfma_f32_16x16x32_bf16 v[136:139], a[120:123], a[60:63], v[136:139]
  s_waitcnt vmcnt(7)
  buffer_load_dwordx4 v212, s[12:15], s55 offen offset:0 nt lds
  ds_read_b64_tr_b16 a[80:81], v188 offset:40960
  ds_read_b64_tr_b16 a[82:83], v188 offset:45056
  v_exp_f32 v229, v159
  v_mfma_f32_16x16x32_bf16 v[132:135], a[124:127], a[56:59], v[132:135]
  v_cvt_pk_bf16_f32 v175, v228, v229
  v_add_f32 v237, v237, v228
  v_add_f32 v237, v237, v229
  v_max_f32 v240, v236, v237
  v_cmp_lt_f32 vcc, s63, v240
  v_accvgpr_write_b32 a129, v2
  v_mfma_f32_16x16x32_bf16 v[140:143], a[124:127], a[60:63], v[140:143]
  ds_read_b64_tr_b16 a[84:85], v189 offset:40960
  ds_read_b64_tr_b16 a[86:87], v189 offset:45056
  s_cbranch_vccnz L_nors_54_r
L_nors_54:
  s_waitcnt lgkmcnt(6)
  v_mfma_f32_16x16x32_bf16 v[64:67], a[64:67], v[168:171], v[64:67]
  v_add_f32 v234, v234, v236
  v_mul_f32 v4, v4, v242
  v_mfma_f32_16x16x32_bf16 v[72:75], a[64:67], v[172:175], v[72:75]
  ds_read_b64_tr_b16 a[88:89], v190 offset:40960
  ds_read_b64_tr_b16 a[90:91], v190 offset:45056
  v_add_f32 v235, v235, v237
  v_mfma_f32_16x16x32_bf16 v[68:71], a[68:71], v[168:171], v[68:71]
  ds_read_b64_tr_b16 a[92:93], v191 offset:40960
  v_mul_f32 v5, v5, v242
  v_mfma_f32_16x16x32_bf16 v[76:79], a[68:71], v[172:175], v[76:79]
  ds_read_b64_tr_b16 a[94:95], v191 offset:45056
  ds_read_b128 a[96:99], v208 offset:8192
  v_mfma_f32_16x16x32_bf16 v[80:83], a[72:75], v[168:171], v[80:83]
  v_exp_f32 v222, v128
  v_mfma_f32_16x16x32_bf16 v[88:91], a[72:75], v[172:175], v[88:91]
  s_waitcnt vmcnt(7)
  buffer_load_dwordx4 v213, s[12:15], s55 offen offset:1024 nt lds
  s_waitcnt lgkmcnt(5)
  v_mfma_f32_16x16x32_bf16 v[84:87], a[76:79], v[168:171], v[84:87]
  v_exp_f32 v223, v129
  v_mfma_f32_16x16x32_bf16 v[92:95], a[76:79], v[172:175], v[92:95]
  ds_read_b128 a[100:103], v208 offset:12288
  v_cvt_pk_bf16_f32 v160, v222, v223
  v_mfma_f32_16x16x32_bf16 v[96:99], a[80:83], v[168:171], v[96:99]
  v_exp_f32 v224, v130
  v_add_f32 v236, v222, v223
  v_mfma_f32_16x16x32_bf16 v[104:107], a[80:83], v[172:175], v[104:107]
  s_add_u32 m0, s45, 147456
  s_nop 0
  buffer_load_dwordx4 v220, s[24:27], s54 offen offset:2048 lds
  ds_read_b128 a[104:107], v209 offset:8192
  v_exp_f32 v225, v131
  v_mfma_f32_16x16x32_bf16 v[100:103], a[84:87], v[168:171], v[100:103]
  v_cvt_pk_bf16_f32 v161, v224, v225
  v_add_f32 v236, v236, v224
  v_cvt_pk_bf16_f32 v4, v4, v5
  v_mfma_f32_16x16x32_bf16 v[108:111], a[84:87], v[172:175], v[108:111]
  ds_read_b128 a[108:111], v209 offset:12288
  v_add_f32 v236, v236, v225
  v_exp_f32 v226, v132
  s_waitcnt lgkmcnt(3)
  v_mfma_f32_16x16x32_bf16 v[112:115], a[88:91], v[168:171], v[112:115]
  v_exp_f32 v227, v133
  v_mfma_f32_16x16x32_bf16 v[120:123], a[88:91], v[172:175], v[120:123]
  s_add_u32 m0, s45, 98304
  s_waitcnt vmcnt(8)
  buffer_load_dwordx4 v214, s[12:15], s55 offen offset:2048 nt lds
  ds_read_b128 a[112:115], v210 offset:8192
  v_cvt_pk_bf16_f32 v162, v226, v227
  v_add_f32 v236, v236, v226
  v_mfma_f32_16x16x32_bf16 v[116:119], a[92:95], v[168:171], v[116:119]
  v_add_f32 v236, v236, v227
  v_accvgpr_write_b32 a130, v4
  v_mfma_f32_16x16x32_bf16 v[124:127], a[92:95], v[172:175], v[124:127]
  ds_read_b128 a[116:119], v210 offset:12288
  v_exp_f32 v228, v134
  s_barrier
  v_mfma_f32_16x16x32_bf16 v[144:147], a[96:99], a[32:35], v[176:179]
  v_exp_f32 v229, v135
  v_mfma_f32_16x16x32_bf16 v[152:155], a[96:99], a[36:39], v[180:183]
  ds_read_b128 a[120:123], v211 offset:8192
  v_cvt_pk_bf16_f32 v163, v228, v229
  v_add_f32 v236, v236, v228
  v_add_f32 v236, v236, v229
  s_waitcnt lgkmcnt(3)
  v_mfma_f32_16x16x32_bf16 v[148:151], a[100:103], a[32:35], v[176:179]
  v_exp_f32 v222, v136
  v_mfma_f32_16x16x32_bf16 v[156:159], a[100:103], a[36:39], v[180:183]
  ds_read_b128 a[124:127], v211 offset:12288
  ds_read_b64_tr_b16 a[64:65], v184 offset:0
  v_mfma_f32_16x16x32_bf16 v[144:147], a[104:107], a[40:43], v[144:147]
  v_exp_f32 v223, v137
  v_mfma_f32_16x16x32_bf16 v[152:155], a[104:107], a[44:47], v[152:155]
  s_waitcnt vmcnt(8)
  buffer_load_dwordx4 v215, s[12:15], s55 offen offset:3072 nt lds
  ds_read_b64_tr_b16 a[66:67], v184 offset:4096
  v_cvt_pk_bf16_f32 v164, v222, v223
  v_add_f32 v237, v222, v223
  v_mfma_f32_16x16x32_bf16 v[148:151], a[108:111], a[40:43], v[148:151]
  v_exp_f32 v224, v138
  v_mfma_f32_16x16x32_bf16 v[156:159], a[108:111], a[44:47], v[156:159]
  ds_read_b64_tr_b16 a[68:69], v185 offset:0
  ds_read_b64_tr_b16 a[70:71], v185 offset:4096
  v_exp_f32 v225, v139
  s_waitcnt lgkmcnt(5)
  v_mfma_f32_16x16x32_bf16 v[144:147], a[112:115], a[48:51], v[144:147]
  v_cvt_pk_bf16_f32 v165, v224, v225
  v_add_f32 v237, v237, v224
  v_add_f32 v237, v237, v225
  v_mul_f32 v6, v6, v242
  v_mfma_f32_16x16x32_bf16 v[152:155], a[112:115], a[52:55], v[152:155]
  s_add_u32 m0, s45, 147456
  s_nop 0
  buffer_load_dwordx4 v221, s[24:27], s54 offen offset:3072 lds
  ds_read_b64_tr_b16 a[72:73], v186 offset:0
  ds_read_b64_tr_b16 a[74:75], v186 offset:4096
  v_exp_f32 v226, v140
  v_mfma_f32_16x16x32_bf16 v[148:151], a[116:119], a[48:51], v[148:151]
  v_exp_f32 v227, v141
  v_mfma_f32_16x16x32_bf16 v[156:159], a[116:119], a[52:55], v[156:159]
  ds_read_b64_tr_b16 a[76:77], v187 offset:0
  ds_read_b64_tr_b16 a[78:79], v187 offset:4096
  v_cvt_pk_bf16_f32 v166, v226, v227
  v_add_f32 v237, v237, v226
  v_add_f32 v237, v237, v227
  v_mfma_f32_16x16x32_bf16 v[144:147], a[120:123], a[56:59], v[144:147]
  v_exp_f32 v228, v142
  v_mfma_f32_16x16x32_bf16 v[152:155], a[120:123], a[60:63], v[152:155]
  s_add_u32 m0, s45, 32768
  s_mov_b32 s55, 180224
  ds_read_b64_tr_b16 a[80:81], v188 offset:0
  ds_read_b64_tr_b16 a[82:83], v188 offset:4096
  v_exp_f32 v229, v143
  s_waitcnt lgkmcnt(6)
  v_mfma_f32_16x16x32_bf16 v[148:151], a[124:127], a[56:59], v[148:151]
  v_cvt_pk_bf16_f32 v167, v228, v229
  v_add_f32 v237, v237, v228
  v_add_f32 v237, v237, v229
  v_max_f32 v240, v236, v237
  v_cmp_lt_f32 vcc, s63, v240
  v_mul_f32 v7, v7, v242
  v_mfma_f32_16x16x32_bf16 v[156:159], a[124:127], a[60:63], v[156:159]
  s_waitcnt vmcnt(8)
  buffer_load_dwordx4 v216, s[16:19], s55 offen offset:0 nt lds
  ds_read_b64_tr_b16 a[84:85], v189 offset:0
  ds_read_b64_tr_b16 a[86:87], v189 offset:4096
  s_cbranch_vccnz L_nors_55_r
L_nors_55:
  v_mfma_f32_16x16x32_bf16 v[64:67], a[64:67], v[160:163], v[64:67]
  v_add_f32 v234, v234, v236
  v_cvt_pk_bf16_f32 v6, v6, v7
  v_mfma_f32_16x16x32_bf16 v[72:75], a[64:67], v[164:167], v[72:75]
  ds_read_b64_tr_b16 a[88:89], v190 offset:0
  ds_read_b64_tr_b16 a[90:91], v190 offset:4096
  v_add_f32 v235, v235, v237
  v_mfma_f32_16x16x32_bf16 v[68:71], a[68:71], v[160:163], v[68:71]
  ds_read_b64_tr_b16 a[92:93], v191 offset:0
  v_accvgpr_write_b32 a131, v6
  v_mfma_f32_16x16x32_bf16 v[76:79], a[68:71], v[164:167], v[76:79]
  ds_read_b64_tr_b16 a[94:95], v191 offset:4096
  s_barrier
  s_waitcnt lgkmcnt(6)
  v_mfma_f32_16x16x32_bf16 v[80:83], a[72:75], v[160:163], v[80:83]
  v_exp_f32 v222, v144
  v_mfma_f32_16x16x32_bf16 v[88:91], a[72:75], v[164:167], v[88:91]
  ds_read_b128 a[96:99], v208 offset:16384
  ds_read_b128 a[100:103], v208 offset:20480
  v_mfma_f32_16x16x32_bf16 v[84:87], a[76:79], v[160:163], v[84:87]
  v_exp_f32 v223, v145
  v_mfma_f32_16x16x32_bf16 v[92:95], a[76:79], v[164:167], v[92:95]
  s_waitcnt vmcnt(8)
  buffer_load_dwordx4 v217, s[16:19], s55 offen offset:1024 nt lds
  s_add_u32 m0, s45, 114688
  s_add_u32 s54, s56, 196608
  v_cvt_pk_bf16_f32 v168, v222, v223
  v_mfma_f32_16x16x32_bf16 v[96:99], a[80:83], v[160:163], v[96:99]
  v_exp_f32 v224, v146
  v_add_f32 v236, v222, v223
  v_mfma_f32_16x16x32_bf16 v[104:107], a[80:83], v[164:167], v[104:107]
  buffer_load_dwordx4 v218, s[24:27], s54 offen offset:0 lds
  ds_read_b128 a[104:107], v209 offset:16384
  v_exp_f32 v225, v147
  s_waitcnt lgkmcnt(3)
  v_mfma_f32_16x16x32_bf16 v[100:103], a[84:87], v[160:163], v[100:103]
  v_cvt_pk_bf16_f32 v169, v224, v225
  v_add_f32 v236, v236, v224
  v_mul_f32 v8, v8, v244
  v_mfma_f32_16x16x32_bf16 v[108:111], a[84:87], v[164:167], v[108:111]
  ds_read_b128 a[108:111], v209 offset:20480
  v_add_f32 v236, v236, v225
  v_exp_f32 v226, v148
  v_mfma_f32_16x16x32_bf16 v[112:115], a[88:91], v[160:163], v[112:115]
  v_exp_f32 v227, v149
  v_mfma_f32_16x16x32_bf16 v[120:123], a[88:91], v[164:167], v[120:123]
  ds_read_b128 a[112:115], v210 offset:16384
  v_cvt_pk_bf16_f32 v170, v226, v227
  v_add_f32 v236, v236, v226
  v_mfma_f32_16x16x32_bf16 v[116:119], a[92:95], v[160:163], v[116:119]
  v_add_f32 v236, v236, v227
  v_mul_f32 v9, v9, v244
  v_mfma_f32_16x16x32_bf16 v[124:127], a[92:95], v[164:167], v[124:127]
  s_add_u32 m0, s45, 32768
  s_waitcnt vmcnt(8)
  buffer_load_dwordx4 v216, s[16:19], s55 offen offset:2048 nt lds
  ds_read_b128 a[116:119], v210 offset:20480
  v_exp_f32 v228, v150
  s_waitcnt lgkmcnt(3)
  v_mfma_f32_16x16x32_bf16 v[128:131], a[96:99], a[32:35], v[176:179]
  v_exp_f32 v229, v151
  v_mfma_f32_16x16x32_bf16 v[136:139], a[96:99], a[36:39], v[180:183]
  ds_read_b128 a[120:123], v211 offset:16384
  v_cvt_pk_bf16_f32 v171, v228, v229
  v_add_f32 v236, v236, v228
  v_add_f32 v236, v236, v229
  v_mfma_f32_16x16x32_bf16 v[132:135], a[100:103], a[32:35], v[176:179]
  v_exp_f32 v222, v152
  v_mfma_f32_16x16x32_bf16 v[140:143], a[100:103], a[36:39], v[180:183]
  ds_read_b128 a[124:127], v211 offset:20480
  ds_read_b64_tr_b16 a[64:65], v184 offset:8192
  v_mfma_f32_16x16x32_bf16 v[128:131], a[104:107], a[40:43], v[128:131]
  v_exp_f32 v223, v153
  v_mfma_f32_16x16x32_bf16 v[136:139], a[104:107], a[44:47], v[136:139]
  ds_read_b64_tr_b16 a[66:67], v184 offset:12288
  v_cvt_pk_bf16_f32 v172, v222, v223
  v_add_f32 v237, v222, v223
  s_waitcnt lgkmcnt(4)
  v_mfma_f32_16x16x32_bf16 v[132:135], a[108:111], a[40:43], v[132:135]
  v_exp_f32 v224, v154
  v_mfma_f32_16x16x32_bf16 v[140:143], a[108:111], a[44:47], v[140:143]
  s_waitcnt vmcnt(8)
  buffer_load_dwordx4 v217, s[16:19], s55 offen offset:3072 nt lds
  ds_read_b64_tr_b16 a[68:69], v185 offset:8192
  ds_read_b64_tr_b16 a[70:71], v185 offset:12288
  v_exp_f32 v225, v155
  v_mfma_f32_16x16x32_bf16 v[128:131], a[112:115], a[48:51], v[128:131]
  v_cvt_pk_bf16_f32 v173, v224, v225
  v_add_f32 v237, v237, v224
  v_add_f32 v237, v237, v225
  v_cvt_pk_bf16_f32 v8, v8, v9
  v_mfma_f32_16x16x32_bf16 v[136:139], a[112:115], a[52:55], v[136:139]
  s_add_u32 m0, s45, 114688
  s_nop 0
  buffer_load_dwordx4 v219, s[24:27], s54 offen offset:1024 lds
  ds_read_b64_tr_b16 a[72:73], v186 offset:8192
  ds_read_b64_tr_b16 a[74:75], v186 offset:12288
  v_exp_f32 v226, v156
  v_mfma_f32_16x16x32_bf16 v[132:135], a[116:119], a[48:51], v[132:135]
  v_exp_f32 v227, v157
  v_mfma_f32_16x16x32_bf16 v[140:143], a[116:119], a[52:55], v[140:143]
  ds_read_b64_tr_b16 a[76:77], v187 offset:8192
  ds_read_b64_tr_b16 a[78:79], v187 offset:12288
  v_cvt_pk_bf16_f32 v174, v226, v227
  v_add_f32 v237, v237, v226
  v_add_f32 v237, v237, v227
  s_waitcnt lgkmcnt(6)
  v_mfma_f32_16x16x32_bf16 v[128:131], a[120:123], a[56:59], v[128:131]
  v_exp_f32 v228, v158
  v_mfma_f32_16x16x32_bf16 v[136:139], a[120:123], a[60:63], v[136:139]
  ds_read_b64_tr_b16 a[80:81], v188 offset:8192
  ds_read_b64_tr_b16 a[82:83], v188 offset:12288
  v_exp_f32 v229, v159
  v_mfma_f32_16x16x32_bf16 v[132:135], a[124:127], a[56:59], v[132:135]
  v_cvt_pk_bf16_f32 v175, v228, v229
  v_add_f32 v237, v237, v228
  v_add_f32 v237, v237, v229
  v_max_f32 v240, v236, v237
  v_cmp_lt_f32 vcc, s63, v240
  v_accvgpr_write_b32 a132, v8
  v_mfma_f32_16x16x32_bf16 v[140:143], a[124:127], a[60:63], v[140:143]
  s_add_u32 m0, s45, 65536
  s_mov_b32 s55, 196608
  ds_read_b64_tr_b16 a[84:85], v189 offset:8192
  ds_read_b64_tr_b16 a[86:87], v189 offset:12288
  s_cbranch_vccnz L_nors_56_r
L_nors_56:
  v_mfma_f32_16x16x32_bf16 v[64:67], a[64:67], v[168:171], v[64:67]
  v_add_f32 v234, v234, v236
  v_mul_f32 v10, v10, v244
  v_mfma_f32_16x16x32_bf16 v[72:75], a[64:67], v[172:175], v[72:75]
  s_waitcnt vmcnt(8)
  buffer_load_dwordx4 v212, s[12:15], s55 offen offset:0 nt lds
  ds_read_b64_tr_b16 a[88:89], v190 offset:8192
  ds_read_b64_tr_b16 a[90:91], v190 offset:12288
  v_add_f32 v235, v235, v237
  s_waitcnt lgkmcnt(6)
  v_mfma_f32_16x16x32_bf16 v[68:71], a[68:71], v[168:171], v[68:71]
  ds_read_b64_tr_b16 a[92:93], v191 offset:8192
  v_mul_f32 v11, v11, v244
  v_mfma_f32_16x16x32_bf16 v[76:79], a[68:71], v[172:175], v[76:79]
  ds_read_b64_tr_b16 a[94:95], v191 offset:12288
  ds_read_b128 a[96:99], v208 offset:24576
  v_mfma_f32_16x16x32_bf16 v[80:83], a[72:75], v[168:171], v[80:83]
  v_exp_f32 v222, v128
  v_mfma_f32_16x16x32_bf16 v[88:91], a[72:75], v[172:175], v[88:91]
  v_exp_f32 v223, v129
  v_mfma_f32_16x16x32_bf16 v[84:87], a[76:79], v[168:171], v[84:87]
  v_cvt_pk_bf16_f32 v160, v222, v223
  v_cvt_pk_bf16_f32 v10, v10, v11
  v_mfma_f32_16x16x32_bf16 v[92:95], a[76:79], v[172:175], v[92:95]
  ds_read_b128 a[100:103], v208 offset:28672
  v_add_f32 v236, v222, v223
  s_waitcnt lgkmcnt(4)
  v_mfma_f32_16x16x32_bf16 v[96:99], a[80:83], v[168:171], v[96:99]
  v_exp_f32 v224, v130
  v_mfma_f32_16x16x32_bf16 v[104:107], a[80:83], v[172:175], v[104:107]
  s_waitcnt vmcnt(8)
  buffer_load_dwordx4 v213, s[12:15], s55 offen offset:1024 nt lds
  s_add_u32 m0, s45, 114688
  s_nop 0
  buffer_load_dwordx4 v220, s[24:27], s54 offen offset:2048 lds
  ds_read_b128 a[104:107], v209 offset:24576
  v_exp_f32 v225, v131
  v_mfma_f32_16x16x32_bf16 v[100:103], a[84:87], v[168:171], v[100:103]
  v_cvt_pk_bf16_f32 v161, v224, v225
  v_add_f32 v236, v236, v224
  v_accvgpr_write_b32 a133, v10
  v_mfma_f32_16x16x32_bf16 v[108:111], a[84:87], v[172:175], v[108:111]
  ds_read_b128 a[108:111], v209 offset:28672
  v_add_f32 v236, v236, v225
  v_exp_f32 v226, v132
  v_mfma_f32_16x16x32_bf16 v[112:115], a[88:91], v[168:171], v[112:115]
  v_exp_f32 v227, v133
  v_mfma_f32_16x16x32_bf16 v[120:123], a[88:91], v[172:175], v[120:123]
  ds_read_b128 a[112:115], v210 offset:24576
  v_cvt_pk_bf16_f32 v162, v226, v227
  v_add_f32 v236, v236, v226
  s_waitcnt lgkmcnt(3)
  v_mfma_f32_16x16x32_bf16 v[116:119], a[92:95], v[168:171], v[116:119]
  v_add_f32 v236, v236, v227
  v_mul_f32 v12, v12, v244
  v_mfma_f32_16x16x32_bf16 v[124:127], a[92:95], v[172:175], v[124:127]
  ds_read_b128 a[116:119], v210 offset:28672
  v_exp_f32 v228, v134
  s_barrier
  v_mfma_f32_16x16x32_bf16 v[144:147], a[96:99], a[32:35], v[176:179]
  v_exp_f32 v229, v135
  v_mfma_f32_16x16x32_bf16 v[152:155], a[96:99], a[36:39], v[180:183]
  ds_read_b128 a[120:123], v211 offset:24576
  v_cvt_pk_bf16_f32 v163, v228, v229
  v_add_f32 v236, v236, v228
  v_add_f32 v236, v236, v229
  v_mfma_f32_16x16x32_bf16 v[148:151], a[100:103], a[32:35], v[176:179]
  v_exp_f32 v222, v136
  v_mfma_f32_16x16x32_bf16 v[156:159], a[100:103], a[36:39], v[180:183]
  s_add_u32 m0, s45, 65536
  s_waitcnt vmcnt(8)
  buffer_load_dwordx4 v214, s[12:15], s55 offen offset:2048 nt lds
  ds_read_b128 a[124:127], v211 offset:28672
  s_waitcnt lgkmcnt(3)
  v_mfma_f32_16x16x32_bf16 v[144:147], a[104:107], a[40:43], v[144:147]
  v_exp_f32 v223, v137
  v_mfma_f32_16x16x32_bf16 v[152:155], a[104:107], a[44:47], v[152:155]
  ds_read_b64_tr_b16 a[64:65], v184 offset:16384
  ds_read_b64_tr_b16 a[66:67], v184 offset:20480
  v_cvt_pk_bf16_f32 v164, v222, v223
  v_add_f32 v237, v222, v223
  v_mfma_f32_16x16x32_bf16 v[148:151], a[108:111], a[40:43], v[148:151]
  v_exp_f32 v224, v138
  v_mfma_f32_16x16x32_bf16 v[156:159], a[108:111], a[44:47], v[156:159]
  ds_read_b64_tr_b16 a[68:69], v185 offset:16384
  ds_read_b64_tr_b16 a[70:71], v185 offset:20480
  v_exp_f32 v225, v139
  v_mfma_f32_16x16x32_bf16 v[144:147], a[112:115], a[48:51], v[144:147]
  v_cvt_pk_bf16_f32 v165, v224, v225
  v_add_f32 v237, v237, v224
  v_add_f32 v237, v237, v225
  v_mul_f32 v13, v13, v244
  v_mfma_f32_16x16x32_bf16 v[152:155], a[112:115], a[52:55], v[152:155]
  s_add_u32 m0, s45, 114688
  s_nop 0
  buffer_load_dwordx4 v221, s[24:27], s54 offen offset:3072 lds
  ds_read_b64_tr_b16 a[72:73], v186 offset:16384
  ds_read_b64_tr_b16 a[74:75], v186 offset:20480
  v_exp_f32 v226, v140
  s_waitcnt lgkmcnt(6)
  v_mfma_f32_16x16x32_bf16 v[148:151], a[116:119], a[48:51], v[148:151]
  v_exp_f32 v227, v141
  v_mfma_f32_16x16x32_bf16 v[156:159], a[116:119], a[52:55], v[156:159]
  s_add_u32 m0, s45, 65536
  s_waitcnt vmcnt(9)
  buffer_load_dwordx4 v215, s[12:15], s55 offen offset:3072 nt lds
  ds_read_b64_tr_b16 a[76:77], v187 offset:16384
  ds_read_b64_tr_b16 a[78:79], v187 offset:20480
  v_cvt_pk_bf16_f32 v166, v226, v227
  v_add_f32 v237, v237, v226
  v_add_f32 v237, v237, v227
  v_mfma_f32_16x16x32_bf16 v[144:147], a[120:123], a[56:59], v[144:147]
  v_exp_f32 v228, v142
  v_mfma_f32_16x16x32_bf16 v[152:155], a[120:123], a[60:63], v[152:155]
  ds_read_b64_tr_b16 a[80:81], v188 offset:16384
  ds_read_b64_tr_b16 a[82:83], v188 offset:20480
  v_exp_f32 v229, v143
  v_mfma_f32_16x16x32_bf16 v[148:151], a[124:127], a[56:59], v[148:151]
  v_cvt_pk_bf16_f32 v167, v228, v229
  v_add_f32 v237, v237, v228
  v_add_f32 v237, v237, v229
  v_max_f32 v240, v236, v237
  v_cmp_lt_f32 vcc, s63, v240
  v_cvt_pk_bf16_f32 v12, v12, v13
  v_mfma_f32_16x16x32_bf16 v[156:159], a[124:127], a[60:63], v[156:159]
  ds_read_b64_tr_b16 a[84:85], v189 offset:16384
  ds_read_b64_tr_b16 a[86:87], v189 offset:20480
  s_cbranch_vccnz L_nors_57_r
L_nors_57:
  s_waitcnt lgkmcnt(6)
  v_mfma_f32_16x16x32_bf16 v[64:67], a[64:67], v[160:163], v[64:67]
  v_add_f32 v234, v234, v236
  v_accvgpr_write_b32 a134, v12
  v_mfma_f32_16x16x32_bf16 v[72:75], a[64:67], v[164:167], v[72:75]
  ds_read_b64_tr_b16 a[88:89], v190 offset:16384
  ds_read_b64_tr_b16 a[90:91], v190 offset:20480
  v_add_f32 v235, v235, v237
  v_mfma_f32_16x16x32_bf16 v[68:71], a[68:71], v[160:163], v[68:71]
  ds_read_b64_tr_b16 a[92:93], v191 offset:16384
  v_mul_f32 v14, v14, v244
  v_mfma_f32_16x16x32_bf16 v[76:79], a[68:71], v[164:167], v[76:79]
  s_add_u32 m0, s45, 0
  s_mov_b32 s55, 196608
  ds_read_b64_tr_b16 a[94:95], v191 offset:20480
  s_barrier
  v_mfma_f32_16x16x32_bf16 v[80:83], a[72:75], v[160:163], v[80:83]
  v_exp_f32 v222, v144
  v_mfma_f32_16x16x32_bf16 v[88:91], a[72:75], v[164:167], v[88:91]
  s_waitcnt vmcnt(8)
  buffer_load_dwordx4 v216, s[16:19], s55 offen offset:0 nt lds
  ds_read_b128 a[96:99], v208 offset:32768
  s_waitcnt lgkmcnt(5)
  v_mfma_f32_16x16x32_bf16 v[84:87], a[76:79], v[160:163], v[84:87]
  v_exp_f32 v223, v145
  v_mfma_f32_16x16x32_bf16 v[92:95], a[76:79], v[164:167], v[92:95]
  s_add_u32 m0, s45, 49152
  s_add_u32 s54, s56, 0
  ds_read_b128 a[100:103], v208 offset:36864
  v_cvt_pk_bf16_f32 v168, v222, v223
  v_mfma_f32_16x16x32_bf16 v[96:99], a[80:83], v[160:163], v[96:99]
  v_exp_f32 v224, v146
  v_add_f32 v236, v222, v223
  v_mfma_f32_16x16x32_bf16 v[104:107], a[80:83], v[164:167], v[104:107]
  buffer_load_dwordx4 v218, s[24:27], s54 offen offset:0 lds
  ds_read_b128 a[104:107], v209 offset:32768
  v_exp_f32 v225, v147
  v_mfma_f32_16x16x32_bf16 v[100:103], a[84:87], v[160:163], v[100:103]
  v_cvt_pk_bf16_f32 v169, v224, v225
  v_add_f32 v236, v236, v224
  v_mul_f32 v15, v15, v244
  v_mfma_f32_16x16x32_bf16 v[108:111], a[84:87], v[164:167], v[108:111]
  ds_read_b128 a[108:111], v209 offset:36864
  v_add_f32 v236, v236, v225
  v_exp_f32 v226, v148
  s_waitcnt lgkmcnt(3)
  v_mfma_f32_16x16x32_bf16 v[112:115], a[88:91], v[160:163], v[112:115]
  v_exp_f32 v227, v149
  v_mfma_f32_16x16x32_bf16 v[120:123], a[88:91], v[164:167], v[120:123]
  s_add_u32 m0, s45, 0
  s_waitcnt vmcnt(9)
  buffer_load_dwordx4 v217, s[16:19], s55 offen offset:1024 nt lds
  ds_read_b128 a[112:115], v210 offset:32768
  v_cvt_pk_bf16_f32 v170, v226, v227
  v_add_f32 v236, v236, v226
  v_mfma_f32_16x16x32_bf16 v[116:119], a[92:95], v[160:163], v[116:119]
  v_add_f32 v236, v236, v227
  v_cvt_pk_bf16_f32 v14, v14, v15
  v_mfma_f32_16x16x32_bf16 v[124:127], a[92:95], v[164:167], v[124:127]
  ds_read_b128 a[116:119], v210 offset:36864
  ds_read_b128 a[120:123], v211 offset:32768
  v_exp_f32 v228, v150
  v_mfma_f32_16x16x32_bf16 v[128:131], a[96:99], a[32:35], v[176:179]
  v_exp_f32 v229, v151
  v_mfma_f32_16x16x32_bf16 v[136:139], a[96:99], a[36:39], v[180:183]
  v_cvt_pk_bf16_f32 v171, v228, v229
  v_add_f32 v236, v236, v228
  v_add_f32 v236, v236, v229
  v_accvgpr_write_b32 a135, v14
  s_waitcnt lgkmcnt(3)
  v_mfma_f32_16x16x32_bf16 v[132:135], a[100:103], a[32:35], v[176:179]
  v_exp_f32 v222, v152
  v_mfma_f32_16x16x32_bf16 v[140:143], a[100:103], a[36:39], v[180:183]
  ds_read_b128 a[124:127], v211 offset:36864
  ds_read_b64_tr_b16 a[64:65], v184 offset:24576
  v_mfma_f32_16x16x32_bf16 v[128:131], a[104:107], a[40:43], v[128:131]
  v_exp_f32 v223, v153
  v_mfma_f32_16x16x32_bf16 v[136:139], a[104:107], a[44:47], v[136:139]
  s_waitcnt vmcnt(8)
  buffer_load_dwordx4 v216, s[16:19], s55 offen offset:2048 nt lds
  ds_read_b64_tr_b16 a[66:67], v184 offset:28672
  v_cvt_pk_bf16_f32 v172, v222, v223
  v_add_f32 v237, v222, v223
  v_mfma_f32_16x16x32_bf16 v[132:135], a[108:111], a[40:43], v[132:135]
  v_exp_f32 v224, v154
  v_mfma_f32_16x16x32_bf16 v[140:143], a[108:111], a[44:47], v[140:143]
  ds_read_b64_tr_b16 a[68:69], v185 offset:24576
  ds_read_b64_tr_b16 a[70:71], v185 offset:28672
  v_exp_f32 v225, v155
  s_waitcnt lgkmcnt(5)
  v_mfma_f32_16x16x32_bf16 v[128:131], a[112:115], a[48:51], v[128:131]
  v_cvt_pk_bf16_f32 v173, v224, v225
  v_add_f32 v237, v237, v224
  v_add_f32 v237, v237, v225
  v_mul_f32 v16, v16, v242
  v_mfma_f32_16x16x32_bf16 v[136:139], a[112:115], a[52:55], v[136:139]
  s_add_u32 m0, s45, 49152
  s_nop 0
  buffer_load_dwordx4 v219, s[24:27], s54 offen offset:1024 lds
  ds_read_b64_tr_b16 a[72:73], v186 offset:24576
  ds_read_b64_tr_b16 a[74:75], v186 offset:28672
  v_exp_f32 v226, v156
  v_mfma_f32_16x16x32_bf16 v[132:135], a[116:119], a[48:51], v[132:135]
  v_exp_f32 v227, v157
  v_mfma_f32_16x16x32_bf16 v[140:143], a[116:119], a[52:55], v[140:143]
  ds_read_b64_tr_b16 a[76:77], v187 offset:24576
  ds_read_b64_tr_b16 a[78:79], v187 offset:28672
  v_cvt_pk_bf16_f32 v174, v226, v227
  v_add_f32 v237, v237, v226
  v_add_f32 v237, v237, v227
  v_mfma_f32_16x16x32_bf16 v[128:131], a[120:123], a[56:59], v[128:131]
  v_exp_f32 v228, v158
  v_mfma_f32_16x16x32_bf16 v[136:139], a[120:123], a[60:63], v[136:139]
  s_add_u32 m0, s45, 0
  s_waitcnt vmcnt(9)
  buffer_load_dwordx4 v217, s[16:19], s55 offen offset:3072 nt lds
  ds_read_b64_tr_b16 a[80:81], v188 offset:24576
  ds_read_b64_tr_b16 a[82:83], v188 offset:28672
  v_exp_f32 v229, v159
  s_waitcnt lgkmcnt(6)
  v_mfma_f32_16x16x32_bf16 v[132:135], a[124:127], a[56:59], v[132:135]
  v_cvt_pk_bf16_f32 v175, v228, v229
  v_add_f32 v237, v237, v228
  v_add_f32 v237, v237, v229
  v_max_f32 v240, v236, v237
  v_cmp_lt_f32 vcc, s63, v240
  v_mul_f32 v17, v17, v242
  v_mfma_f32_16x16x32_bf16 v[140:143], a[124:127], a[60:63], v[140:143]
  ds_read_b64_tr_b16 a[84:85], v189 offset:24576
  ds_read_b64_tr_b16 a[86:87], v189 offset:28672
  s_cbranch_vccnz L_nors_58_r
L_nors_58:
  v_mfma_f32_16x16x32_bf16 v[64:67], a[64:67], v[168:171], v[64:67]
  v_add_f32 v234, v234, v236
  v_cvt_pk_bf16_f32 v16, v16, v17
  v_mfma_f32_16x16x32_bf16 v[72:75], a[64:67], v[172:175], v[72:75]
  ds_read_b64_tr_b16 a[88:89], v190 offset:24576
  ds_read_b64_tr_b16 a[90:91], v190 offset:28672
  v_add_f32 v235, v235, v237
  v_mfma_f32_16x16x32_bf16 v[68:71], a[68:71], v[168:171], v[68:71]
  ds_read_b64_tr_b16 a[92:93], v191 offset:24576
  v_accvgpr_write_b32 a136, v16
  v_mfma_f32_16x16x32_bf16 v[76:79], a[68:71], v[172:175], v[76:79]
  s_add_u32 m0, s45, 81920
  ds_read_b64_tr_b16 a[94:95], v191 offset:28672
  s_waitcnt lgkmcnt(6)
  v_mfma_f32_16x16x32_bf16 v[80:83], a[72:75], v[168:171], v[80:83]
  v_exp_f32 v222, v128
  v_mfma_f32_16x16x32_bf16 v[88:91], a[72:75], v[172:175], v[88:91]
  s_mov_b32 s55, 212992
  ds_read_b128 a[96:99], v208 offset:40960
  v_mfma_f32_16x16x32_bf16 v[84:87], a[76:79], v[168:171], v[84:87]
  v_exp_f32 v223, v129
  v_mfma_f32_16x16x32_bf16 v[92:95], a[76:79], v[172:175], v[92:95]
  s_waitcnt vmcnt(8)
  buffer_load_dwordx4 v212, s[12:15], s55 offen offset:0 nt lds
  ds_read_b128 a[100:103], v208 offset:45056
  v_cvt_pk_bf16_f32 v160, v222, v223
  v_mfma_f32_16x16x32_bf16 v[96:99], a[80:83], v[168:171], v[96:99]
  v_exp_f32 v224, v130
  v_add_f32 v236, v222, v223
  v_mfma_f32_16x16x32_bf16 v[104:107], a[80:83], v[172:175], v[104:107]
  s_add_u32 m0, s45, 49152
  s_nop 0
  buffer_load_dwordx4 v220, s[24:27], s54 offen offset:2048 lds
  ds_read_b128 a[104:107], v209 offset:40960
  v_exp_f32 v225, v131
  s_waitcnt lgkmcnt(3)
  v_mfma_f32_16x16x32_bf16 v[100:103], a[84:87], v[168:171], v[100:103]
  v_cvt_pk_bf16_f32 v161, v224, v225
  v_add_f32 v236, v236, v224
  v_mul_f32 v18, v18, v242
  v_mfma_f32_16x16x32_bf16 v[108:111], a[84:87], v[172:175], v[108:111]
  ds_read_b128 a[108:111], v209 offset:45056
  v_add_f32 v236, v236, v225
  v_exp_f32 v226, v132
  v_mfma_f32_16x16x32_bf16 v[112:115], a[88:91], v[168:171], v[112:115]
  v_exp_f32 v227, v133
  v_mfma_f32_16x16x32_bf16 v[120:123], a[88:91], v[172:175], v[120:123]
  ds_read_b128 a[112:115], v210 offset:40960
  v_cvt_pk_bf16_f32 v162, v226, v227
  v_add_f32 v236, v236, v226
  v_mfma_f32_16x16x32_bf16 v[116:119], a[92:95], v[168:171], v[116:119]
  v_add_f32 v236, v236, v227
  v_mul_f32 v19, v19, v242
  v_mfma_f32_16x16x32_bf16 v[124:127], a[92:95], v[172:175], v[124:127]
  s_add_u32 m0, s45, 81920
  s_waitcnt vmcnt(8)
  buffer_load_dwordx4 v213, s[12:15], s55 offen offset:1024 nt lds
  ds_read_b128 a[116:119], v210 offset:45056
  v_exp_f32 v228, v134
  s_barrier
  s_waitcnt lgkmcnt(3)
  v_mfma_f32_16x16x32_bf16 v[144:147], a[96:99], a[32:35], v[176:179]
  v_exp_f32 v229, v135
  v_mfma_f32_16x16x32_bf16 v[152:155], a[96:99], a[36:39], v[180:183]
  ds_read_b128 a[120:123], v211 offset:40960
  v_cvt_pk_bf16_f32 v163, v228, v229
  v_add_f32 v236, v236, v228
  v_add_f32 v236, v236, v229
  v_mfma_f32_16x16x32_bf16 v[148:151], a[100:103], a[32:35], v[176:179]
  v_exp_f32 v222, v136
  v_mfma_f32_16x16x32_bf16 v[156:159], a[100:103], a[36:39], v[180:183]
  ds_read_b128 a[124:127], v211 offset:45056
  ds_read_b64_tr_b16 a[64:65], v184 offset:32768
  v_mfma_f32_16x16x32_bf16 v[144:147], a[104:107], a[40:43], v[144:147]
  v_exp_f32 v223, v137
  v_mfma_f32_16x16x32_bf16 v[152:155], a[104:107], a[44:47], v[152:155]
  ds_read_b64_tr_b16 a[66:67], v184 offset:36864
  v_cvt_pk_bf16_f32 v164, v222, v223
  v_add_f32 v237, v222, v223
  s_waitcnt lgkmcnt(4)
  v_mfma_f32_16x16x32_bf16 v[148:151], a[108:111], a[40:43], v[148:151]
  v_exp_f32 v224, v138
  v_mfma_f32_16x16x32_bf16 v[156:159], a[108:111], a[44:47], v[156:159]
  s_waitcnt vmcnt(8)
  buffer_load_dwordx4 v214, s[12:15], s55 offen offset:2048 nt lds
L_pg7:
  s_cbranch_execz L_pg11
  ds_read_b64_tr_b16 a[68:69], v185 offset:32768
  ds_read_b64_tr_b16 a[70:71], v185 offset:36864
  v_exp_f32 v225, v139
  v_mfma_f32_16x16x32_bf16 v[144:147], a[112:115], a[48:51], v[144:147]
  v_cvt_pk_bf16_f32 v165, v224, v225
  v_add_f32 v237, v237, v224
  v_add_f32 v237, v237, v225
  v_cvt_pk_bf16_f32 v18, v18, v19
  v_mfma_f32_16x16x32_bf16 v[152:155], a[112:115], a[52:55], v[152:155]
  s_add_u32 m0, s45, 49152
  s_nop 0
  buffer_load_dwordx4 v221, s[24:27], s54 offen offset:3072 lds
  ds_read_b64_tr_b16 a[72:73], v186 offset:32768
  ds_read_b64_tr_b16 a[74:75], v186 offset:36864
  v_exp_f32 v226, v140
  v_mfma_f32_16x16x32_bf16 v[148:151], a[116:119], a[48:51], v[148:151]
  v_exp_f32 v227, v141
  v_mfma_f32_16x16x32_bf16 v[156:159], a[116:119], a[52:55], v[156:159]
  ds_read_b64_tr_b16 a[76:77], v187 offset:32768
  ds_read_b64_tr_b16 a[78:79], v187 offset:36864
  v_cvt_pk_bf16_f32 v166, v226, v227
  v_add_f32 v237, v237, v226
  v_add_f32 v237, v237, v227
  s_waitcnt lgkmcnt(6)
  v_mfma_f32_16x16x32_bf16 v[144:147], a[120:123], a[56:59], v[144:147]
  v_exp_f32 v228, v142
  v_mfma_f32_16x16x32_bf16 v[152:155], a[120:123], a[60:63], v[152:155]
  ds_read_b64_tr_b16 a[80:81], v188 offset:32768
  ds_read_b64_tr_b16 a[82:83], v188 offset:36864
  v_exp_f32 v229, v143
  v_mfma_f32_16x16x32_bf16 v[148:151], a[124:127], a[56:59], v[148:151]
  v_cvt_pk_bf16_f32 v167, v228, v229
  v_add_f32 v237, v237, v228
  v_add_f32 v237, v237, v229
  v_max_f32 v240, v236, v237
  v_cmp_lt_f32 vcc, s63, v240
  v_accvgpr_write_b32 a137, v18
  v_mfma_f32_16x16x32_bf16 v[156:159], a[124:127], a[60:63], v[156:159]
  s_add_u32 m0, s45, 81920
  s_waitcnt vmcnt(8)
  buffer_load_dwordx4 v215, s[12:15], s55 offen offset:3072 nt lds
  ds_read_b64_tr_b16 a[84:85], v189 offset:32768
  ds_read_b64_tr_b16 a[86:87], v189 offset:36864
  s_cbranch_vccnz L_nors_59_r
L_nors_59:
  v_mfma_f32_16x16x32_bf16 v[64:67], a[64:67], v[160:163], v[64:67]
  v_add_f32 v234, v234, v236
  v_mul_f32 v20, v20, v242
  v_mfma_f32_16x16x32_bf16 v[72:75], a[64:67], v[164:167], v[72:75]
  ds_read_b64_tr_b16 a[88:89], v190 offset:32768
  ds_read_b64_tr_b16 a[90:91], v190 offset:36864
  v_add_f32 v235, v235, v237
  s_waitcnt lgkmcnt(6)
  v_mfma_f32_16x16x32_bf16 v[68:71], a[68:71], v[160:163], v[68:71]
  ds_read_b64_tr_b16 a[92:93], v191 offset:32768
  v_mul_f32 v21, v21, v242
  v_mfma_f32_16x16x32_bf16 v[76:79], a[68:71], v[164:167], v[76:79]
  ds_read_b64_tr_b16 a[94:95], v191 offset:36864
  s_barrier
  v_mfma_f32_16x16x32_bf16 v[80:83], a[72:75], v[160:163], v[80:83]
  v_exp_f32 v222, v144
  v_mfma_f32_16x16x32_bf16 v[88:91], a[72:75], v[164:167], v[88:91]
  s_add_u32 m0, s45, 16384
  ds_read_b128 a[96:99], v208 offset:0
  v_mfma_f32_16x16x32_bf16 v[84:87], a[76:79], v[160:163], v[84:87]
  s_mov_b32 s55, 212992
  v_exp_f32 v223, v145
  v_mfma_f32_16x16x32_bf16 v[92:95], a[76:79], v[164:167], v[92:95]
  s_waitcnt vmcnt(8)
  buffer_load_dwordx4 v216, s[16:19], s55 offen offset:0 nt lds
  s_add_u32 m0, s45, 131072
  s_add_u32 s54, s56, 65536
  ds_read_b128 a[100:103], v208 offset:4096
  v_cvt_pk_bf16_f32 v168, v222, v223
  s_waitcnt lgkmcnt(4)
  v_mfma_f32_16x16x32_bf16 v[96:99], a[80:83], v[160:163], v[96:99]
  v_exp_f32 v224, v146
  v_add_f32 v236, v222, v223
  v_mfma_f32_16x16x32_bf16 v[104:107], a[80:83], v[164:167], v[104:107]
  buffer_load_dwordx4 v218, s[24:27], s54 offen offset:0 lds
  ds_read_b128 a[104:107], v209 offset:0
  v_exp_f32 v225, v147
  v_mfma_f32_16x16x32_bf16 v[100:103], a[84:87], v[160:163], v[100:103]
  v_cvt_pk_bf16_f32 v169, v224, v225
  v_add_f32 v236, v236, v224
  v_cvt_pk_bf16_f32 v20, v20, v21
  v_mfma_f32_16x16x32_bf16 v[108:111], a[84:87], v[164:167], v[108:111]
  ds_read_b128 a[108:111], v209 offset:4096
  v_add_f32 v236, v236, v225
  v_exp_f32 v226, v148
  v_mfma_f32_16x16x32_bf16 v[112:115], a[88:91], v[160:163], v[112:115]
  v_exp_f32 v227, v149
  v_mfma_f32_16x16x32_bf16 v[120:123], a[88:91], v[164:167], v[120:123]
  ds_read_b128 a[112:115], v210 offset:0
  v_cvt_pk_bf16_f32 v170, v226, v227
  v_add_f32 v236, v236, v226
  s_waitcnt lgkmcnt(3)
  v_mfma_f32_16x16x32_bf16 v[116:119], a[92:95], v[160:163], v[116:119]
  v_add_f32 v236, v236, v227
  v_accvgpr_write_b32 a138, v20
  v_mfma_f32_16x16x32_bf16 v[124:127], a[92:95], v[164:167], v[124:127]
  s_add_u32 m0, s45, 16384
  ds_read_b128 a[116:119], v210 offset:4096
  v_exp_f32 v228, v150
  v_mfma_f32_16x16x32_bf16 v[128:131], a[96:99], a[32:35], v[176:179]
  v_exp_f32 v229, v151
  v_mfma_f32_16x16x32_bf16 v[136:139], a[96:99], a[36:39], v[180:183]
  s_waitcnt vmcnt(8)
  buffer_load_dwordx4 v217, s[16:19], s55 offen offset:1024 nt lds
  ds_read_b128 a[120:123], v211 offset:0
  v_cvt_pk_bf16_f32 v171, v228, v229
  v_add_f32 v236, v236, v228
  v_add_f32 v236, v236, v229
  v_mfma_f32_16x16x32_bf16 v[132:135], a[100:103], a[32:35], v[176:179]
  v_exp_f32 v222, v152
  v_mfma_f32_16x16x32_bf16 v[140:143], a[100:103], a[36:39], v[180:183]
  ds_read_b128 a[124:127], v211 offset:4096
  ds_read_b64_tr_b16 a[64:65], v184 offset:40960
  s_waitcnt lgkmcnt(4)
  v_mfma_f32_16x16x32_bf16 v[128:131], a[104:107], a[40:43], v[128:131]
  v_exp_f32 v223, v153
  v_mfma_f32_16x16x32_bf16 v[136:139], a[104:107], a[44:47], v[136:139]
  ds_read_b64_tr_b16 a[66:67], v184 offset:45056
  v_cvt_pk_bf16_f32 v172, v222, v223
  v_add_f32 v237, v222, v223
  v_mfma_f32_16x16x32_bf16 v[132:135], a[108:111], a[40:43], v[132:135]
  v_exp_f32 v224, v154
  v_mfma_f32_16x16x32_bf16 v[140:143], a[108:111], a[44:47], v[140:143]
  ds_read_b64_tr_b16 a[68:69], v185 offset:40960
  ds_read_b64_tr_b16 a[70:71], v185 offset:45056
  v_exp_f32 v225, v155
  v_mfma_f32_16x16x32_bf16 v[128:131], a[112:115], a[48:51], v[128:131]
  v_cvt_pk_bf16_f32 v173, v224, v225
  v_add_f32 v237, v237, v224
  v_add_f32 v237, v237, v225
  v_mul_f32 v22, v22, v242
  v_mfma_f32_16x16x32_bf16 v[136:139], a[112:115], a[52:55], v[136:139]
  s_waitcnt vmcnt(8)
  buffer_load_dwordx4 v216, s[16:19], s55 offen offset:2048 nt lds
  s_add_u32 m0, s45, 131072
  s_nop 0
  buffer_load_dwordx4 v219, s[24:27], s54 offen offset:1024 lds
  ds_read_b64_tr_b16 a[72:73], v186 offset:40960
  ds_read_b64_tr_b16 a[74:75], v186 offset:45056
  v_exp_f32 v226, v156
  s_waitcnt lgkmcnt(5)
  v_mfma_f32_16x16x32_bf16 v[132:135], a[116:119], a[48:51], v[132:135]
  v_exp_f32 v227, v157
  v_mfma_f32_16x16x32_bf16 v[140:143], a[116:119], a[52:55], v[140:143]
  ds_read_b64_tr_b16 a[76:77], v187 offset:40960
  ds_read_b64_tr_b16 a[78:79], v187 offset:45056
  v_cvt_pk_bf16_f32 v174, v226, v227
  v_add_f32 v237, v237, v226
  v_add_f32 v237, v237, v227
  v_mfma_f32_16x16x32_bf16 v[128:131], a[120:123], a[56:59], v[128:131]
  v_exp_f32 v228, v158
  v_mfma_f32_16x16x32_bf16 v[136:139], a[120:123], a[60:63], v[136:139]
  ds_read_b64_tr_b16 a[80:81], v188 offset:40960
  ds_read_b64_tr_b16 a[82:83], v188 offset:45056
  v_exp_f32 v229, v159
  v_mfma_f32_16x16x32_bf16 v[132:135], a[124:127], a[56:59], v[132:135]
  v_cvt_pk_bf16_f32 v175, v228, v229
  v_add_f32 v237, v237, v228
  v_add_f32 v237, v237, v229
  v_max_f32 v240, v236, v237
  v_cmp_lt_f32 vcc, s63, v240
  v_mul_f32 v23, v23, v242
  v_mfma_f32_16x16x32_bf16 v[140:143], a[124:127], a[60:63], v[140:143]
  ds_read_b64_tr_b16 a[84:85], v189 offset:40960
  ds_read_b64_tr_b16 a[86:87], v189 offset:45056
  s_cbranch_vccnz L_nors_60_r
L_nors_60:
  s_waitcnt lgkmcnt(6)
  v_mfma_f32_16x16x32_bf16 v[64:67], a[64:67], v[168:171], v[64:67]
  v_add_f32 v234, v234, v236
  v_cvt_pk_bf16_f32 v22, v22, v23
  v_mfma_f32_16x16x32_bf16 v[72:75], a[64:67], v[172:175], v[72:75]
  s_add_u32 m0, s45, 16384
  s_waitcnt vmcnt(8)
  buffer_load_dwordx4 v217, s[16:19], s55 offen offset:3072 nt lds
  ds_read_b64_tr_b16 a[88:89], v190 offset:40960
  ds_read_b64_tr_b16 a[90:91], v190 offset:45056
  v_add_f32 v235, v235, v237
  v_mfma_f32_16x16x32_bf16 v[68:71], a[68:71], v[168:171], v[68:71]
  ds_read_b64_tr_b16 a[92:93], v191 offset:40960
  v_accvgpr_write_b32 a139, v22
  v_mfma_f32_16x16x32_bf16 v[76:79], a[68:71], v[172:175], v[76:79]
  ds_read_b64_tr_b16 a[94:95], v191 offset:45056
  ds_read_b128 a[96:99], v208 offset:8192
  v_mfma_f32_16x16x32_bf16 v[80:83], a[72:75], v[168:171], v[80:83]
  v_exp_f32 v222, v128
  v_mfma_f32_16x16x32_bf16 v[88:91], a[72:75], v[172:175], v[88:91]
  v_exp_f32 v223, v129
  s_waitcnt lgkmcnt(5)
  v_mfma_f32_16x16x32_bf16 v[84:87], a[76:79], v[168:171], v[84:87]
  v_cvt_pk_bf16_f32 v160, v222, v223
  v_mul_f32 v24, v24, v244
  v_mfma_f32_16x16x32_bf16 v[92:95], a[76:79], v[172:175], v[92:95]
  ds_read_b128 a[100:103], v208 offset:12288
  v_add_f32 v236, v222, v223
  v_mfma_f32_16x16x32_bf16 v[96:99], a[80:83], v[168:171], v[96:99]
  s_add_u32 m0, s45, 131072
  v_exp_f32 v224, v130
  v_mfma_f32_16x16x32_bf16 v[104:107], a[80:83], v[172:175], v[104:107]
  buffer_load_dwordx4 v220, s[24:27], s54 offen offset:2048 lds
  s_add_u32 m0, s45, 98304
  s_mov_b32 s55, 229376
  ds_read_b128 a[104:107], v209 offset:8192
  v_exp_f32 v225, v131
  v_mfma_f32_16x16x32_bf16 v[100:103], a[84:87], v[168:171], v[100:103]
  v_cvt_pk_bf16_f32 v161, v224, v225
  v_add_f32 v236, v236, v224
  v_mul_f32 v25, v25, v244
  v_mfma_f32_16x16x32_bf16 v[108:111], a[84:87], v[172:175], v[108:111]
  s_waitcnt vmcnt(9)
  buffer_load_dwordx4 v212, s[12:15], s55 offen offset:0 nt lds
  ds_read_b128 a[108:111], v209 offset:12288
  v_exp_f32 v226, v132
  v_add_f32 v236, v236, v225
  s_waitcnt lgkmcnt(3)
  v_mfma_f32_16x16x32_bf16 v[112:115], a[88:91], v[168:171], v[112:115]
  v_exp_f32 v227, v133
  v_mfma_f32_16x16x32_bf16 v[120:123], a[88:91], v[172:175], v[120:123]
  ds_read_b128 a[112:115], v210 offset:8192
  v_cvt_pk_bf16_f32 v162, v226, v227
  v_add_f32 v236, v236, v226
  v_mfma_f32_16x16x32_bf16 v[116:119], a[92:95], v[168:171], v[116:119]
  v_add_f32 v236, v236, v227
  v_cvt_pk_bf16_f32 v24, v24, v25
  v_mfma_f32_16x16x32_bf16 v[124:127], a[92:95], v[172:175], v[124:127]
  ds_read_b128 a[116:119], v210 offset:12288
  v_exp_f32 v228, v134
  s_barrier
  v_mfma_f32_16x16x32_bf16 v[144:147], a[96:99], a[32:35], v[176:179]
  v_exp_f32 v229, v135
  v_mfma_f32_16x16x32_bf16 v[152:155], a[96:99], a[36:39], v[180:183]
  ds_read_b128 a[120:123], v211 offset:8192
  v_cvt_pk_bf16_f32 v163, v228, v229
  v_add_f32 v236, v236, v228
  v_add_f32 v236, v236, v229
  s_waitcnt lgkmcnt(3)
  v_mfma_f32_16x16x32_bf16 v[148:151], a[100:103], a[32:35], v[176:179]
  v_exp_f32 v222, v136
  v_mfma_f32_16x16x32_bf16 v[156:159], a[100:103], a[36:39], v[180:183]
  s_waitcnt vmcnt(8)
  buffer_load_dwordx4 v213, s[12:15], s55 offen offset:1024 nt lds
  ds_read_b128 a[124:127], v211 offset:12288
  v_mfma_f32_16x16x32_bf16 v[144:147], a[104:107], a[40:43], v[144:147]
  v_exp_f32 v223, v137
  v_mfma_f32_16x16x32_bf16 v[152:155], a[104:107], a[44:47], v[152:155]
  ds_read_b64_tr_b16 a[64:65], v184 offset:0
  ds_read_b64_tr_b16 a[66:67], v184 offset:4096
  v_cvt_pk_bf16_f32 v164, v222, v223
  v_add_f32 v237, v222, v223
  v_mfma_f32_16x16x32_bf16 v[148:151], a[108:111], a[40:43], v[148:151]
  v_exp_f32 v224, v138
  v_mfma_f32_16x16x32_bf16 v[156:159], a[108:111], a[44:47], v[156:159]
  ds_read_b64_tr_b16 a[68:69], v185 offset:0
  ds_read_b64_tr_b16 a[70:71], v185 offset:4096
  v_exp_f32 v225, v139
  s_waitcnt lgkmcnt(5)
  v_mfma_f32_16x16x32_bf16 v[144:147], a[112:115], a[48:51], v[144:147]
  v_cvt_pk_bf16_f32 v165, v224, v225
  v_add_f32 v237, v237, v224
  v_add_f32 v237, v237, v225
  v_accvgpr_write_b32 a140, v24
  v_mfma_f32_16x16x32_bf16 v[152:155], a[112:115], a[52:55], v[152:155]
  s_add_u32 m0, s45, 131072
  s_nop 0
  buffer_load_dwordx4 v221, s[24:27], s54 offen offset:3072 lds
  ds_read_b64_tr_b16 a[72:73], v186 offset:0
  ds_read_b64_tr_b16 a[74:75], v186 offset:4096
  v_exp_f32 v226, v140
  v_mfma_f32_16x16x32_bf16 v[148:151], a[116:119], a[48:51], v[148:151]
  v_exp_f32 v227, v141
  v_mfma_f32_16x16x32_bf16 v[156:159], a[116:119], a[52:55], v[156:159]
  s_add_u32 m0, s45, 98304
  s_waitcnt vmcnt(9)
  buffer_load_dwordx4 v214, s[12:15], s55 offen offset:2048 nt lds
  ds_read_b64_tr_b16 a[76:77], v187 offset:0
  ds_read_b64_tr_b16 a[78:79], v187 offset:4096
  v_cvt_pk_bf16_f32 v166, v226, v227
  v_add_f32 v237, v237, v226
  v_add_f32 v237, v237, v227
  v_mfma_f32_16x16x32_bf16 v[144:147], a[120:123], a[56:59], v[144:147]
  v_exp_f32 v228, v142
  v_mfma_f32_16x16x32_bf16 v[152:155], a[120:123], a[60:63], v[152:155]
  ds_read_b64_tr_b16 a[80:81], v188 offset:0
  ds_read_b64_tr_b16 a[82:83], v188 offset:4096
  v_exp_f32 v229, v143
  s_waitcnt lgkmcnt(6)
  v_mfma_f32_16x16x32_bf16 v[148:151], a[124:127], a[56:59], v[148:151]
  v_cvt_pk_bf16_f32 v167, v228, v229
  v_add_f32 v237, v237, v228
  v_add_f32 v237, v237, v229
  v_max_f32 v240, v236, v237
  v_cmp_lt_f32 vcc, s63, v240
  v_mul_f32 v26, v26, v244
  v_mfma_f32_16x16x32_bf16 v[156:159], a[124:127], a[60:63], v[156:159]
  ds_read_b64_tr_b16 a[84:85], v189 offset:0
  ds_read_b64_tr_b16 a[86:87], v189 offset:4096
  s_cbranch_vccnz L_nors_61_r
L_nors_61:
  v_mfma_f32_16x16x32_bf16 v[64:67], a[64:67], v[160:163], v[64:67]
  v_add_f32 v234, v234, v236
  v_mul_f32 v27, v27, v244
  v_mfma_f32_16x16x32_bf16 v[72:75], a[64:67], v[164:167], v[72:75]
  ds_read_b64_tr_b16 a[88:89], v190 offset:0
  ds_read_b64_tr_b16 a[90:91], v190 offset:4096
  v_add_f32 v235, v235, v237
  v_mfma_f32_16x16x32_bf16 v[68:71], a[68:71], v[160:163], v[68:71]
  ds_read_b64_tr_b16 a[92:93], v191 offset:0
  v_cvt_pk_bf16_f32 v26, v26, v27
  v_mfma_f32_16x16x32_bf16 v[76:79], a[68:71], v[164:167], v[76:79]
  s_waitcnt vmcnt(8)
  buffer_load_dwordx4 v215, s[12:15], s55 offen offset:3072 nt lds
  ds_read_b64_tr_b16 a[94:95], v191 offset:4096
  s_barrier
  s_waitcnt lgkmcnt(6)
  v_mfma_f32_16x16x32_bf16 v[80:83], a[72:75], v[160:163], v[80:83]
  v_exp_f32 v222, v144
  v_mfma_f32_16x16x32_bf16 v[88:91], a[72:75], v[164:167], v[88:91]
  ds_read_b128 a[96:99], v208 offset:16384
  ds_read_b128 a[100:103], v208 offset:20480
  v_mfma_f32_16x16x32_bf16 v[84:87], a[76:79], v[160:163], v[84:87]
  v_exp_f32 v223, v145
  v_mfma_f32_16x16x32_bf16 v[92:95], a[76:79], v[164:167], v[92:95]
  v_cvt_pk_bf16_f32 v168, v222, v223
  v_add_f32 v236, v222, v223
  v_accvgpr_write_b32 a141, v26
  v_mfma_f32_16x16x32_bf16 v[96:99], a[80:83], v[160:163], v[96:99]
  v_exp_f32 v224, v146
  v_mfma_f32_16x16x32_bf16 v[104:107], a[80:83], v[164:167], v[104:107]
  s_add_u32 m0, s45, 32768
  ds_read_b128 a[104:107], v209 offset:16384
  v_exp_f32 v225, v147
  s_waitcnt lgkmcnt(3)
  v_mfma_f32_16x16x32_bf16 v[100:103], a[84:87], v[160:163], v[100:103]
  v_cvt_pk_bf16_f32 v169, v224, v225
  v_add_f32 v236, v236, v224
  v_add_f32 v236, v236, v225
  v_mul_f32 v28, v28, v244
  v_mfma_f32_16x16x32_bf16 v[108:111], a[84:87], v[164:167], v[108:111]
  s_mov_b32 s55, 229376
  ds_read_b128 a[108:111], v209 offset:20480
  v_exp_f32 v226, v148
  v_mfma_f32_16x16x32_bf16 v[112:115], a[88:91], v[160:163], v[112:115]
  v_exp_f32 v227, v149
  v_mfma_f32_16x16x32_bf16 v[120:123], a[88:91], v[164:167], v[120:123]
  s_waitcnt vmcnt(8)
  buffer_load_dwordx4 v216, s[16:19], s55 offen offset:0 nt lds
  ds_read_b128 a[112:115], v210 offset:16384
  v_cvt_pk_bf16_f32 v170, v226, v227
  v_add_f32 v236, v236, v226
  v_add_f32 v236, v236, v227
  v_mfma_f32_16x16x32_bf16 v[116:119], a[92:95], v[160:163], v[116:119]
  v_exp_f32 v228, v150
  v_mfma_f32_16x16x32_bf16 v[124:127], a[92:95], v[164:167], v[124:127]
  ds_read_b128 a[116:119], v210 offset:20480
  ds_read_b128 a[120:123], v211 offset:16384
  s_waitcnt lgkmcnt(4)
  v_mfma_f32_16x16x32_bf16 v[128:131], a[96:99], a[32:35], v[176:179]
  v_exp_f32 v229, v151
  v_mfma_f32_16x16x32_bf16 v[136:139], a[96:99], a[36:39], v[180:183]
  v_cvt_pk_bf16_f32 v171, v228, v229
  v_add_f32 v236, v236, v228
  v_add_f32 v236, v236, v229
  v_mul_f32 v29, v29, v244
  v_mfma_f32_16x16x32_bf16 v[132:135], a[100:103], a[32:35], v[176:179]
  v_exp_f32 v222, v152
  v_mfma_f32_16x16x32_bf16 v[140:143], a[100:103], a[36:39], v[180:183]
  ds_read_b128 a[124:127], v211 offset:20480
  ds_read_b64_tr_b16 a[64:65], v184 offset:8192
  v_mfma_f32_16x16x32_bf16 v[128:131], a[104:107], a[40:43], v[128:131]
  v_exp_f32 v223, v153
  v_mfma_f32_16x16x32_bf16 v[136:139], a[104:107], a[44:47], v[136:139]
  s_waitcnt vmcnt(7)
  buffer_load_dwordx4 v217, s[16:19], s55 offen offset:1024 nt lds
  ds_read_b64_tr_b16 a[66:67], v184 offset:12288
  v_cvt_pk_bf16_f32 v172, v222, v223
  v_add_f32 v237, v222, v223
  s_waitcnt lgkmcnt(3)
  v_mfma_f32_16x16x32_bf16 v[132:135], a[108:111], a[40:43], v[132:135]
  v_exp_f32 v224, v154
  v_mfma_f32_16x16x32_bf16 v[140:143], a[108:111], a[44:47], v[140:143]
  ds_read_b64_tr_b16 a[68:69], v185 offset:8192
  ds_read_b64_tr_b16 a[70:71], v185 offset:12288
  v_exp_f32 v225, v155
  v_mfma_f32_16x16x32_bf16 v[128:131], a[112:115], a[48:51], v[128:131]
  v_cvt_pk_bf16_f32 v173, v224, v225
  v_add_f32 v237, v237, v224
  v_add_f32 v237, v237, v225
  v_cvt_pk_bf16_f32 v28, v28, v29
  v_mfma_f32_16x16x32_bf16 v[136:139], a[112:115], a[52:55], v[136:139]
  ds_read_b64_tr_b16 a[72:73], v186 offset:8192
  ds_read_b64_tr_b16 a[74:75], v186 offset:12288
  v_exp_f32 v226, v156
  v_mfma_f32_16x16x32_bf16 v[132:135], a[116:119], a[48:51], v[132:135]
  v_exp_f32 v227, v157
  v_mfma_f32_16x16x32_bf16 v[140:143], a[116:119], a[52:55], v[140:143]
  ds_read_b64_tr_b16 a[76:77], v187 offset:8192
  ds_read_b64_tr_b16 a[78:79], v187 offset:12288
  v_cvt_pk_bf16_f32 v174, v226, v227
  v_add_f32 v237, v237, v226
  v_add_f32 v237, v237, v227
  v_mfma_f32_16x16x32_bf16 v[128:131], a[120:123], a[56:59], v[128:131]
  v_exp_f32 v228, v158
  v_mfma_f32_16x16x32_bf16 v[136:139], a[120:123], a[60:63], v[136:139]
  s_waitcnt vmcnt(6)
  buffer_load_dwordx4 v216, s[16:19], s55 offen offset:2048 nt lds
  ds_read_b64_tr_b16 a[80:81], v188 offset:8192
  ds_read_b64_tr_b16 a[82:83], v188 offset:12288
  v_exp_f32 v229, v159
  s_waitcnt lgkmcnt(6)
  v_mfma_f32_16x16x32_bf16 v[132:135], a[124:127], a[56:59], v[132:135]
  v_cvt_pk_bf16_f32 v175, v228, v229
  v_add_f32 v237, v237, v228
  v_add_f32 v237, v237, v229
  v_max_f32 v240, v236, v237
  v_cmp_lt_f32 vcc, s63, v240
  s_nop 0
  s_cbranch_vccnz L_nors_62_r
L_nors_62:
  v_accvgpr_write_b32 a142, v28
  v_mfma_f32_16x16x32_bf16 v[140:143], a[124:127], a[60:63], v[140:143]
  ds_read_b64_tr_b16 a[84:85], v189 offset:8192
  ds_read_b64_tr_b16 a[86:87], v189 offset:12288
  v_add_f32 v234, v234, v236
  v_mfma_f32_16x16x32_bf16 v[64:67], a[64:67], v[168:171], v[64:67]
  v_add_f32 v235, v235, v237
  v_mul_f32 v30, v30, v244
  v_mfma_f32_16x16x32_bf16 v[72:75], a[64:67], v[172:175], v[72:75]
  ds_read_b64_tr_b16 a[88:89], v190 offset:8192
  ds_read_b64_tr_b16 a[90:91], v190 offset:12288
  v_mfma_f32_16x16x32_bf16 v[68:71], a[68:71], v[168:171], v[68:71]
  ds_read_b64_tr_b16 a[92:93], v191 offset:8192
  v_mul_f32 v31, v31, v244
  v_mfma_f32_16x16x32_bf16 v[76:79], a[68:71], v[172:175], v[76:79]
  ds_read_b64_tr_b16 a[94:95], v191 offset:12288
  ds_read_b128 a[96:99], v208 offset:24576
  s_waitcnt lgkmcnt(7)
  v_mfma_f32_16x16x32_bf16 v[80:83], a[72:75], v[168:171], v[80:83]
  v_exp_f32 v222, v128
  v_mfma_f32_16x16x32_bf16 v[88:91], a[72:75], v[172:175], v[88:91]
  s_waitcnt vmcnt(6)
  buffer_load_dwordx4 v217, s[16:19], s55 offen offset:3072 nt lds
  v_mfma_f32_16x16x32_bf16 v[84:87], a[76:79], v[168:171], v[84:87]
  v_exp_f32 v223, v129
  v_mfma_f32_16x16x32_bf16 v[92:95], a[76:79], v[172:175], v[92:95]
  ds_read_b128 a[100:103], v208 offset:28672
  v_cvt_pk_bf16_f32 v160, v222, v223
  v_add_f32 v236, v222, v223
  v_mfma_f32_16x16x32_bf16 v[96:99], a[80:83], v[168:171], v[96:99]
  v_exp_f32 v224, v130
  v_mfma_f32_16x16x32_bf16 v[104:107], a[80:83], v[172:175], v[104:107]
  ds_read_b128 a[104:107], v209 offset:24576
  ds_read_b128 a[108:111], v209 offset:28672
  v_exp_f32 v225, v131
  s_waitcnt lgkmcnt(3)
  v_mfma_f32_16x16x32_bf16 v[100:103], a[84:87], v[168:171], v[100:103]
  v_cvt_pk_bf16_f32 v161, v224, v225
  v_add_f32 v236, v236, v224
  v_add_f32 v236, v236, v225
  v_cvt_pk_bf16_f32 v30, v30, v31
  v_mfma_f32_16x16x32_bf16 v[108:111], a[84:87], v[172:175], v[108:111]
  v_exp_f32 v226, v132
  v_mfma_f32_16x16x32_bf16 v[112:115], a[88:91], v[168:171], v[112:115]
  v_exp_f32 v227, v133
  v_mfma_f32_16x16x32_bf16 v[120:123], a[88:91], v[172:175], v[120:123]
  s_add_u32 m0, s45, 65536
  s_mov_b32 s55, 245760
  ds_read_b128 a[112:115], v210 offset:24576
  v_cvt_pk_bf16_f32 v162, v226, v227
  v_add_f32 v236, v236, v226
  v_add_f32 v236, v236, v227
  v_mfma_f32_16x16x32_bf16 v[116:119], a[92:95], v[168:171], v[116:119]
  v_exp_f32 v228, v134
  v_mfma_f32_16x16x32_bf16 v[124:127], a[92:95], v[172:175], v[124:127]
  s_waitcnt vmcnt(5)
  buffer_load_dwordx4 v212, s[12:15], s55 offen offset:0 nt lds
  ds_read_b128 a[116:119], v210 offset:28672
  s_barrier
  v_mfma_f32_16x16x32_bf16 v[144:147], a[96:99], a[32:35], v[176:179]
  v_exp_f32 v229, v135
  v_mfma_f32_16x16x32_bf16 v[152:155], a[96:99], a[36:39], v[180:183]
  ds_read_b128 a[120:123], v211 offset:24576
  v_cvt_pk_bf16_f32 v163, v228, v229
  v_add_f32 v236, v236, v228
  v_add_f32 v236, v236, v229
  s_waitcnt lgkmcnt(3)
  v_mfma_f32_16x16x32_bf16 v[148:151], a[100:103], a[32:35], v[176:179]
  v_exp_f32 v222, v136
  v_mfma_f32_16x16x32_bf16 v[156:159], a[100:103], a[36:39], v[180:183]
  ds_read_b128 a[124:127], v211 offset:28672
  ds_read_b64_tr_b16 a[64:65], v184 offset:16384
  v_mfma_f32_16x16x32_bf16 v[144:147], a[104:107], a[40:43], v[144:147]
  v_exp_f32 v223, v137
  v_mfma_f32_16x16x32_bf16 v[152:155], a[104:107], a[44:47], v[152:155]
  ds_read_b64_tr_b16 a[66:67], v184 offset:20480
  v_cvt_pk_bf16_f32 v164, v222, v223
  v_add_f32 v237, v222, v223
  v_mfma_f32_16x16x32_bf16 v[148:151], a[108:111], a[40:43], v[148:151]
  v_exp_f32 v224, v138
  v_mfma_f32_16x16x32_bf16 v[156:159], a[108:111], a[44:47], v[156:159]
  s_waitcnt vmcnt(5)
  buffer_load_dwordx4 v213, s[12:15], s55 offen offset:1024 nt lds
  ds_read_b64_tr_b16 a[68:69], v185 offset:16384
  ds_read_b64_tr_b16 a[70:71], v185 offset:20480
  v_exp_f32 v225, v139
  s_waitcnt lgkmcnt(5)
  v_mfma_f32_16x16x32_bf16 v[144:147], a[112:115], a[48:51], v[144:147]
  v_cvt_pk_bf16_f32 v165, v224, v225
  v_add_f32 v237, v237, v224
  v_add_f32 v237, v237, v225
  v_accvgpr_write_b32 a143, v30
  v_mfma_f32_16x16x32_bf16 v[152:155], a[112:115], a[52:55], v[152:155]
  ds_read_b64_tr_b16 a[72:73], v186 offset:16384
  ds_read_b64_tr_b16 a[74:75], v186 offset:20480
  v_exp_f32 v226, v140
  v_mfma_f32_16x16x32_bf16 v[148:151], a[116:119], a[48:51], v[148:151]
  v_exp_f32 v227, v141
  v_mfma_f32_16x16x32_bf16 v[156:159], a[116:119], a[52:55], v[156:159]
  ds_read_b64_tr_b16 a[76:77], v187 offset:16384
  ds_read_b64_tr_b16 a[78:79], v187 offset:20480
  v_cvt_pk_bf16_f32 v166, v226, v227
  v_add_f32 v237, v237, v226
  v_add_f32 v237, v237, v227
  v_mfma_f32_16x16x32_bf16 v[144:147], a[120:123], a[56:59], v[144:147]
  v_exp_f32 v228, v142
  v_mfma_f32_16x16x32_bf16 v[152:155], a[120:123], a[60:63], v[152:155]
  ds_read_b64_tr_b16 a[80:81], v188 offset:16384
  ds_read_b64_tr_b16 a[82:83], v188 offset:20480
  v_exp_f32 v229, v143
  s_waitcnt lgkmcnt(6)
  v_mfma_f32_16x16x32_bf16 v[148:151], a[124:127], a[56:59], v[148:151]
  v_cvt_pk_bf16_f32 v167, v228, v229
  v_add_f32 v237, v237, v228
  v_add_f32 v237, v237, v229
  v_max_f32 v240, v236, v237
  v_cmp_lt_f32 vcc, s63, v240
  v_mul_f32 v32, v32, v242
  v_mfma_f32_16x16x32_bf16 v[156:159], a[124:127], a[60:63], v[156:159]
  s_waitcnt vmcnt(5)
  buffer_load_dwordx4 v214, s[12:15], s55 offen offset:2048 nt lds
  ds_read_b64_tr_b16 a[84:85], v189 offset:16384
  ds_read_b64_tr_b16 a[86:87], v189 offset:20480
  s_cbranch_vccnz L_nors_63_r
L_nors_63:
  v_add_f32 v234, v234, v236
  v_add_f32 v235, v235, v237
  v_mfma_f32_16x16x32_bf16 v[64:67], a[64:67], v[160:163], v[64:67]
  ds_read_b64_tr_b16 a[88:89], v190 offset:16384
  v_mul_f32 v33, v33, v242
  v_mfma_f32_16x16x32_bf16 v[72:75], a[64:67], v[164:167], v[72:75]
  ds_read_b64_tr_b16 a[90:91], v190 offset:20480
  ds_read_b64_tr_b16 a[92:93], v191 offset:16384
  v_mfma_f32_16x16x32_bf16 v[68:71], a[68:71], v[160:163], v[68:71]
  v_exp_f32 v222, v144
  v_mfma_f32_16x16x32_bf16 v[76:79], a[68:71], v[164:167], v[76:79]
  ds_read_b64_tr_b16 a[94:95], v191 offset:20480
  s_barrier
  s_waitcnt lgkmcnt(6)
  v_mfma_f32_16x16x32_bf16 v[80:83], a[72:75], v[160:163], v[80:83]
  v_exp_f32 v223, v145
  v_mfma_f32_16x16x32_bf16 v[88:91], a[72:75], v[164:167], v[88:91]
  ds_read_b128 a[96:99], v208 offset:32768
  v_cvt_pk_bf16_f32 v168, v222, v223
  v_add_f32 v236, v222, v223
  v_mfma_f32_16x16x32_bf16 v[84:87], a[76:79], v[160:163], v[84:87]
  v_exp_f32 v224, v146
  v_mfma_f32_16x16x32_bf16 v[92:95], a[76:79], v[164:167], v[92:95]
  s_waitcnt vmcnt(5)
  buffer_load_dwordx4 v215, s[12:15], s55 offen offset:3072 nt lds
  ds_read_b128 a[100:103], v208 offset:36864
  v_mfma_f32_16x16x32_bf16 v[96:99], a[80:83], v[160:163], v[96:99]
  v_exp_f32 v225, v147
  v_mfma_f32_16x16x32_bf16 v[104:107], a[80:83], v[164:167], v[104:107]
  ds_read_b128 a[104:107], v209 offset:32768
  v_cvt_pk_bf16_f32 v169, v224, v225
  v_add_f32 v236, v236, v224
  v_add_f32 v236, v236, v225
  v_cvt_pk_bf16_f32 v32, v32, v33
  s_waitcnt lgkmcnt(3)
  v_mfma_f32_16x16x32_bf16 v[100:103], a[84:87], v[160:163], v[100:103]
  ds_read_b128 a[108:111], v209 offset:36864
  v_accvgpr_write_b32 a144, v32
  v_mfma_f32_16x16x32_bf16 v[108:111], a[84:87], v[164:167], v[108:111]
  v_exp_f32 v226, v148
  v_mul_f32 v34, v34, v242
  v_mfma_f32_16x16x32_bf16 v[112:115], a[88:91], v[160:163], v[112:115]
  ds_read_b128 a[112:115], v210 offset:32768
  v_mul_f32 v35, v35, v242
  v_mfma_f32_16x16x32_bf16 v[120:123], a[88:91], v[164:167], v[120:123]
  v_exp_f32 v227, v149
  v_cvt_pk_bf16_f32 v34, v34, v35
  v_mfma_f32_16x16x32_bf16 v[116:119], a[92:95], v[160:163], v[116:119]
  v_cvt_pk_bf16_f32 v170, v226, v227
  v_add_f32 v236, v236, v226
  v_add_f32 v236, v236, v227
  v_accvgpr_write_b32 a145, v34
  v_mfma_f32_16x16x32_bf16 v[124:127], a[92:95], v[164:167], v[124:127]
  s_add_u32 m0, s45, 0
  s_mov_b32 s55, 245760
  ds_read_b128 a[116:119], v210 offset:36864
  v_exp_f32 v228, v150
  v_mul_f32 v36, v36, v242
  s_waitcnt lgkmcnt(3)
  v_mfma_f32_16x16x32_bf16 v[128:131], a[96:99], a[32:35], v[176:179]
  v_exp_f32 v229, v151
  v_mul_f32 v37, v37, v242
  v_mfma_f32_16x16x32_bf16 v[136:139], a[96:99], a[36:39], v[180:183]
  s_waitcnt vmcnt(5)
  buffer_load_dwordx4 v216, s[16:19], s55 offen offset:0 nt lds
  ds_read_b128 a[120:123], v211 offset:32768
  v_cvt_pk_bf16_f32 v171, v228, v229
  v_add_f32 v236, v236, v228
  v_add_f32 v236, v236, v229
  v_cvt_pk_bf16_f32 v36, v36, v37
  v_mfma_f32_16x16x32_bf16 v[132:135], a[100:103], a[32:35], v[176:179]
  v_exp_f32 v222, v152
  v_accvgpr_write_b32 a146, v36
  v_mfma_f32_16x16x32_bf16 v[140:143], a[100:103], a[36:39], v[180:183]
  ds_read_b128 a[124:127], v211 offset:36864
  v_mul_f32 v38, v38, v242
  v_mfma_f32_16x16x32_bf16 v[128:131], a[104:107], a[40:43], v[128:131]
  v_exp_f32 v223, v153
  v_mul_f32 v39, v39, v242
  v_mfma_f32_16x16x32_bf16 v[136:139], a[104:107], a[44:47], v[136:139]
  ds_read_b64_tr_b16 a[64:65], v184 offset:24576
  ds_read_b64_tr_b16 a[66:67], v184 offset:28672
  v_cvt_pk_bf16_f32 v172, v222, v223
  v_add_f32 v237, v222, v223
  v_cvt_pk_bf16_f32 v38, v38, v39
  s_waitcnt lgkmcnt(4)
  v_mfma_f32_16x16x32_bf16 v[132:135], a[108:111], a[40:43], v[132:135]
  v_exp_f32 v224, v154
  v_accvgpr_write_b32 a147, v38
  v_mfma_f32_16x16x32_bf16 v[140:143], a[108:111], a[44:47], v[140:143]
  ds_read_b64_tr_b16 a[68:69], v185 offset:24576
  ds_read_b64_tr_b16 a[70:71], v185 offset:28672
  v_exp_f32 v225, v155
L_pg8:
  s_cbranch_execz L_pgback
  v_mul_f32 v40, v40, v244
  v_mfma_f32_16x16x32_bf16 v[128:131], a[112:115], a[48:51], v[128:131]
  v_cvt_pk_bf16_f32 v173, v224, v225
  v_add_f32 v237, v237, v224
  v_add_f32 v237, v237, v225
  v_mul_f32 v41, v41, v244
  v_mfma_f32_16x16x32_bf16 v[136:139], a[112:115], a[52:55], v[136:139]
  s_waitcnt vmcnt(5)
  buffer_load_dwordx4 v217, s[16:19], s55 offen offset:1024 nt lds
  ds_read_b64_tr_b16 a[72:73], v186 offset:24576
  ds_read_b64_tr_b16 a[74:75], v186 offset:28672
  v_exp_f32 v226, v156
  v_cvt_pk_bf16_f32 v40, v40, v41
  v_mfma_f32_16x16x32_bf16 v[132:135], a[116:119], a[48:51], v[132:135]
  ds_read_b64_tr_b16 a[76:77], v187 offset:24576
  v_accvgpr_write_b32 a148, v40
  v_mfma_f32_16x16x32_bf16 v[140:143], a[116:119], a[52:55], v[140:143]
  ds_read_b64_tr_b16 a[78:79], v187 offset:28672
  v_exp_f32 v227, v157
  v_mul_f32 v42, v42, v244
  s_waitcnt lgkmcnt(6)
  v_mfma_f32_16x16x32_bf16 v[128:131], a[120:123], a[56:59], v[128:131]
  v_cvt_pk_bf16_f32 v174, v226, v227
  v_add_f32 v237, v237, v226
  v_add_f32 v237, v237, v227
  v_mul_f32 v43, v43, v244
  v_mfma_f32_16x16x32_bf16 v[136:139], a[120:123], a[60:63], v[136:139]
  ds_read_b64_tr_b16 a[80:81], v188 offset:24576
  ds_read_b64_tr_b16 a[82:83], v188 offset:28672
  v_exp_f32 v228, v158
  v_exp_f32 v229, v159
  v_cvt_pk_bf16_f32 v42, v42, v43
  v_mfma_f32_16x16x32_bf16 v[132:135], a[124:127], a[56:59], v[132:135]
  v_cvt_pk_bf16_f32 v175, v228, v229
  v_add_f32 v237, v237, v228
  v_add_f32 v237, v237, v229
  v_max_f32 v240, v236, v237
  v_cmp_lt_f32 vcc, s63, v240
  v_accvgpr_write_b32 a149, v42
  v_mfma_f32_16x16x32_bf16 v[140:143], a[124:127], a[60:63], v[140:143]
  ds_read_b64_tr_b16 a[84:85], v189 offset:24576
  ds_read_b64_tr_b16 a[86:87], v189 offset:28672
  s_cbranch_vccnz L_nors_64_r
L_nors_64:
  v_add_f32 v234, v234, v236
  v_add_f32 v235, v235, v237
  v_mul_f32 v44, v44, v244
  v_mfma_f32_16x16x32_bf16 v[64:67], a[64:67], v[168:171], v[64:67]
  ds_read_b64_tr_b16 a[88:89], v190 offset:24576
  v_mul_f32 v45, v45, v244
  v_mfma_f32_16x16x32_bf16 v[72:75], a[64:67], v[172:175], v[72:75]
  ds_read_b64_tr_b16 a[90:91], v190 offset:28672
  v_cvt_pk_bf16_f32 v44, v44, v45
  s_waitcnt lgkmcnt(6)
  v_mfma_f32_16x16x32_bf16 v[68:71], a[68:71], v[168:171], v[68:71]
  ds_read_b64_tr_b16 a[92:93], v191 offset:24576
  v_accvgpr_write_b32 a150, v44
  v_mfma_f32_16x16x32_bf16 v[76:79], a[68:71], v[172:175], v[76:79]
  s_waitcnt vmcnt(5)
  buffer_load_dwordx4 v216, s[16:19], s55 offen offset:2048 nt lds
  ds_read_b64_tr_b16 a[94:95], v191 offset:28672
  v_mul_f32 v46, v46, v244
  v_mfma_f32_16x16x32_bf16 v[80:83], a[72:75], v[168:171], v[80:83]
  v_exp_f32 v222, v128
  v_mul_f32 v47, v47, v244
  v_mfma_f32_16x16x32_bf16 v[88:91], a[72:75], v[172:175], v[88:91]
  ds_read_b128 a[96:99], v208 offset:40960
  v_cvt_pk_bf16_f32 v46, v46, v47
  v_mfma_f32_16x16x32_bf16 v[84:87], a[76:79], v[168:171], v[84:87]
  v_exp_f32 v223, v129
  v_accvgpr_write_b32 a151, v46
  v_mfma_f32_16x16x32_bf16 v[92:95], a[76:79], v[172:175], v[92:95]
  ds_read_b128 a[100:103], v208 offset:45056
  v_cvt_pk_bf16_f32 v160, v222, v223
  v_add_f32 v236, v222, v223
  v_mul_f32 v48, v48, v242
  s_waitcnt lgkmcnt(4)
  v_mfma_f32_16x16x32_bf16 v[96:99], a[80:83], v[168:171], v[96:99]
  v_exp_f32 v224, v130
  v_mul_f32 v49, v49, v242
  v_mfma_f32_16x16x32_bf16 v[104:107], a[80:83], v[172:175], v[104:107]
  ds_read_b128 a[104:107], v209 offset:40960
  v_exp_f32 v225, v131
  v_cvt_pk_bf16_f32 v48, v48, v49
  v_mfma_f32_16x16x32_bf16 v[100:103], a[84:87], v[168:171], v[100:103]
  v_cvt_pk_bf16_f32 v161, v224, v225
  v_add_f32 v236, v236, v224
  v_add_f32 v236, v236, v225
  v_accvgpr_write_b32 a152, v48
  v_mfma_f32_16x16x32_bf16 v[108:111], a[84:87], v[172:175], v[108:111]
  s_waitcnt vmcnt(5)
  buffer_load_dwordx4 v217, s[16:19], s55 offen offset:3072 nt lds
  ds_read_b128 a[108:111], v209 offset:45056
  v_exp_f32 v226, v132
  v_mul_f32 v50, v50, v242
  v_mfma_f32_16x16x32_bf16 v[112:115], a[88:91], v[168:171], v[112:115]
  ds_read_b128 a[112:115], v210 offset:40960
  v_mul_f32 v51, v51, v242
  v_mfma_f32_16x16x32_bf16 v[120:123], a[88:91], v[172:175], v[120:123]
  v_exp_f32 v227, v133
  v_cvt_pk_bf16_f32 v50, v50, v51
  s_waitcnt lgkmcnt(3)
  v_mfma_f32_16x16x32_bf16 v[116:119], a[92:95], v[168:171], v[116:119]
  v_cvt_pk_bf16_f32 v162, v226, v227
  v_add_f32 v236, v236, v226
  v_add_f32 v236, v236, v227
  v_accvgpr_write_b32 a153, v50
  v_mfma_f32_16x16x32_bf16 v[124:127], a[92:95], v[172:175], v[124:127]
  ds_read_b128 a[116:119], v210 offset:45056
  v_exp_f32 v228, v134
  v_mul_f32 v52, v52, v242
  s_barrier
  v_mfma_f32_16x16x32_bf16 v[144:147], a[96:99], a[32:35], v[176:179]
  v_exp_f32 v229, v135
  v_mul_f32 v53, v53, v242
  v_mfma_f32_16x16x32_bf16 v[152:155], a[96:99], a[36:39], v[180:183]
  ds_read_b128 a[120:123], v211 offset:40960
  v_cvt_pk_bf16_f32 v163, v228, v229
  v_add_f32 v236, v236, v228
  v_add_f32 v236, v236, v229
  v_cvt_pk_bf16_f32 v52, v52, v53
  v_mfma_f32_16x16x32_bf16 v[148:151], a[100:103], a[32:35], v[176:179]
  v_exp_f32 v222, v136
  v_accvgpr_write_b32 a154, v52
  v_mfma_f32_16x16x32_bf16 v[156:159], a[100:103], a[36:39], v[180:183]
  ds_read_b128 a[124:127], v211 offset:45056
  v_mul_f32 v54, v54, v242
  s_waitcnt lgkmcnt(3)
  v_mfma_f32_16x16x32_bf16 v[144:147], a[104:107], a[40:43], v[144:147]
  v_exp_f32 v223, v137
  v_mul_f32 v55, v55, v242
  v_mfma_f32_16x16x32_bf16 v[152:155], a[104:107], a[44:47], v[152:155]
  ds_read_b64_tr_b16 a[64:65], v184 offset:32768
  ds_read_b64_tr_b16 a[66:67], v184 offset:36864
  v_cvt_pk_bf16_f32 v164, v222, v223
  v_add_f32 v237, v222, v223
  v_cvt_pk_bf16_f32 v54, v54, v55
  v_mfma_f32_16x16x32_bf16 v[148:151], a[108:111], a[40:43], v[148:151]
  v_exp_f32 v224, v138
  v_accvgpr_write_b32 a155, v54
  v_mfma_f32_16x16x32_bf16 v[156:159], a[108:111], a[44:47], v[156:159]
  ds_read_b64_tr_b16 a[68:69], v185 offset:32768
  ds_read_b64_tr_b16 a[70:71], v185 offset:36864
  v_exp_f32 v225, v139
  v_mul_f32 v56, v56, v244
  v_mfma_f32_16x16x32_bf16 v[144:147], a[112:115], a[48:51], v[144:147]
  v_cvt_pk_bf16_f32 v165, v224, v225
  v_add_f32 v237, v237, v224
  v_add_f32 v237, v237, v225
  v_mul_f32 v57, v57, v244
  v_mfma_f32_16x16x32_bf16 v[152:155], a[112:115], a[52:55], v[152:155]
  ds_read_b64_tr_b16 a[72:73], v186 offset:32768
  ds_read_b64_tr_b16 a[74:75], v186 offset:36864
  v_exp_f32 v226, v140
  v_cvt_pk_bf16_f32 v56, v56, v57
  s_waitcnt lgkmcnt(6)
  v_mfma_f32_16x16x32_bf16 v[148:151], a[116:119], a[48:51], v[148:151]
  ds_read_b64_tr_b16 a[76:77], v187 offset:32768
  v_accvgpr_write_b32 a156, v56
  v_mfma_f32_16x16x32_bf16 v[156:159], a[116:119], a[52:55], v[156:159]
  ds_read_b64_tr_b16 a[78:79], v187 offset:36864
  v_exp_f32 v227, v141
  v_mul_f32 v58, v58, v244
  v_mfma_f32_16x16x32_bf16 v[144:147], a[120:123], a[56:59], v[144:147]
  v_cvt_pk_bf16_f32 v166, v226, v227
  v_add_f32 v237, v237, v226
  v_add_f32 v237, v237, v227
  v_mul_f32 v59, v59, v244
  v_mfma_f32_16x16x32_bf16 v[152:155], a[120:123], a[60:63], v[152:155]
  ds_read_b64_tr_b16 a[80:81], v188 offset:32768
  ds_read_b64_tr_b16 a[82:83], v188 offset:36864
  v_exp_f32 v228, v142
  v_exp_f32 v229, v143
  v_cvt_pk_bf16_f32 v58, v58, v59
  v_mfma_f32_16x16x32_bf16 v[148:151], a[124:127], a[56:59], v[148:151]
  v_cvt_pk_bf16_f32 v167, v228, v229
  v_add_f32 v237, v237, v228
  v_add_f32 v237, v237, v229
  v_max_f32 v240, v236, v237
  v_cmp_lt_f32 vcc, s63, v240
  v_accvgpr_write_b32 a157, v58
  v_mfma_f32_16x16x32_bf16 v[156:159], a[124:127], a[60:63], v[156:159]
  ds_read_b64_tr_b16 a[84:85], v189 offset:32768
  ds_read_b64_tr_b16 a[86:87], v189 offset:36864
  s_cbranch_vccnz L_nors_65_r
L_nors_65:
  v_mul_f32 v60, v60, v244
  s_waitcnt lgkmcnt(6)
  v_mfma_f32_16x16x32_bf16 v[64:67], a[64:67], v[160:163], v[64:67]
  v_add_f32 v234, v234, v236
  v_mul_f32 v61, v61, v244
  v_mfma_f32_16x16x32_bf16 v[72:75], a[64:67], v[164:167], v[72:75]
  ds_read_b64_tr_b16 a[88:89], v190 offset:32768
  ds_read_b64_tr_b16 a[90:91], v190 offset:36864
  v_add_f32 v235, v235, v237
  v_cvt_pk_bf16_f32 v60, v60, v61
  v_mfma_f32_16x16x32_bf16 v[68:71], a[68:71], v[160:163], v[68:71]
  ds_read_b64_tr_b16 a[92:93], v191 offset:32768
  v_accvgpr_write_b32 a158, v60
  v_mfma_f32_16x16x32_bf16 v[76:79], a[68:71], v[164:167], v[76:79]
  ds_read_b64_tr_b16 a[94:95], v191 offset:36864
  v_mul_f32 v62, v62, v244
  s_waitcnt vmcnt(4)
  s_barrier
  v_mfma_f32_16x16x32_bf16 v[80:83], a[72:75], v[160:163], v[80:83]
  v_exp_f32 v222, v144
  v_mul_f32 v63, v63, v244
  v_mfma_f32_16x16x32_bf16 v[88:91], a[72:75], v[164:167], v[88:91]
  ds_read_b128 a[96:99], v208 offset:0
  v_cvt_pk_bf16_f32 v62, v62, v63
  v_accvgpr_write_b32 a159, v62
  s_waitcnt lgkmcnt(5)
  v_mfma_f32_16x16x32_bf16 v[84:87], a[76:79], v[160:163], v[84:87]
  v_exp_f32 v223, v145
  v_mfma_f32_16x16x32_bf16 v[92:95], a[76:79], v[164:167], v[92:95]
  ds_read_b128 a[100:103], v208 offset:4096
  v_cvt_pk_bf16_f32 v168, v222, v223
  v_add_f32 v236, v222, v223
  v_mfma_f32_16x16x32_bf16 v[96:99], a[80:83], v[160:163], v[96:99]
  s_add_u32 s51, s68, 0
  v_exp_f32 v224, v146
  v_mfma_f32_16x16x32_bf16 v[104:107], a[80:83], v[164:167], v[104:107]
  ds_read_b128 a[104:107], v209 offset:0
  ds_read_b128 a[108:111], v209 offset:4096
  v_exp_f32 v225, v147
  v_mfma_f32_16x16x32_bf16 v[100:103], a[84:87], v[160:163], v[100:103]
  ds_read_b128 a[112:115], v210 offset:0
  v_cvt_pk_bf16_f32 v169, v224, v225
  v_add_f32 v236, v236, v224
  v_add_f32 v236, v236, v225
  v_mfma_f32_16x16x32_bf16 v[108:111], a[84:87], v[164:167], v[108:111]
  buffer_store_dwordx4 a[128:131], v230, s[36:39], s51 offen offset:0 sc1
  v_exp_f32 v226, v148
  s_waitcnt lgkmcnt(4)
  v_mfma_f32_16x16x32_bf16 v[112:115], a[88:91], v[160:163], v[112:115]
  v_exp_f32 v227, v149
  v_mfma_f32_16x16x32_bf16 v[120:123], a[88:91], v[164:167], v[120:123]
  ds_read_b128 a[116:119], v210 offset:4096
  v_cvt_pk_bf16_f32 v170, v226, v227
  v_add_f32 v236, v236, v226
  v_add_f32 v236, v236, v227
  v_mfma_f32_16x16x32_bf16 v[116:119], a[92:95], v[160:163], v[116:119]
  v_exp_f32 v228, v150
  v_mfma_f32_16x16x32_bf16 v[124:127], a[92:95], v[164:167], v[124:127]
  v_exp_f32 v229, v151
  v_mfma_f32_16x16x32_bf16 v[128:131], a[96:99], a[32:35], v[176:179]
  ds_read_b128 a[120:123], v211 offset:0
  v_cvt_pk_bf16_f32 v171, v228, v229
  v_add_f32 v236, v236, v228
  v_add_f32 v236, v236, v229
  v_mfma_f32_16x16x32_bf16 v[136:139], a[96:99], a[36:39], v[180:183]
  v_exp_f32 v222, v152
  s_waitcnt lgkmcnt(2)
  v_mfma_f32_16x16x32_bf16 v[132:135], a[100:103], a[32:35], v[176:179]
  v_exp_f32 v223, v153
  v_mfma_f32_16x16x32_bf16 v[140:143], a[100:103], a[36:39], v[180:183]
  buffer_store_dwordx4 a[132:135], v230, s[36:39], s51 offen offset:896 sc1
  ds_read_b128 a[124:127], v211 offset:4096
  v_cvt_pk_bf16_f32 v172, v222, v223
  v_add_f32 v237, v222, v223
  v_mfma_f32_16x16x32_bf16 v[128:131], a[104:107], a[40:43], v[128:131]
  v_exp_f32 v224, v154
  v_mfma_f32_16x16x32_bf16 v[136:139], a[104:107], a[44:47], v[136:139]
  ds_read_b64_tr_b16 a[64:65], v184 offset:40960
  ds_read_b64_tr_b16 a[66:67], v184 offset:45056
  v_mfma_f32_16x16x32_bf16 v[132:135], a[108:111], a[40:43], v[132:135]
  v_exp_f32 v225, v155
  v_mfma_f32_16x16x32_bf16 v[140:143], a[108:111], a[44:47], v[140:143]
  ds_read_b64_tr_b16 a[68:69], v185 offset:40960
  ds_read_b64_tr_b16 a[70:71], v185 offset:45056
  v_cvt_pk_bf16_f32 v173, v224, v225
  v_add_f32 v237, v237, v224
  v_add_f32 v237, v237, v225
  v_mfma_f32_16x16x32_bf16 v[128:131], a[112:115], a[48:51], v[128:131]
  v_exp_f32 v226, v156
  v_mfma_f32_16x16x32_bf16 v[136:139], a[112:115], a[52:55], v[136:139]
  ds_read_b64_tr_b16 a[72:73], v186 offset:40960
  ds_read_b64_tr_b16 a[74:75], v186 offset:45056
  s_waitcnt lgkmcnt(6)
  v_mfma_f32_16x16x32_bf16 v[132:135], a[116:119], a[48:51], v[132:135]
  v_exp_f32 v227, v157
  v_mfma_f32_16x16x32_bf16 v[140:143], a[116:119], a[52:55], v[140:143]
  ds_read_b64_tr_b16 a[76:77], v187 offset:40960
  ds_read_b64_tr_b16 a[78:79], v187 offset:45056
  v_cvt_pk_bf16_f32 v174, v226, v227
  v_add_f32 v237, v237, v226
  v_add_f32 v237, v237, v227
  v_mfma_f32_16x16x32_bf16 v[128:131], a[120:123], a[56:59], v[128:131]
  v_exp_f32 v228, v158
  v_mfma_f32_16x16x32_bf16 v[136:139], a[120:123], a[60:63], v[136:139]
  buffer_store_dwordx4 a[136:139], v230, s[36:39], s51 offen offset:1792 sc1
  ds_read_b64_tr_b16 a[80:81], v188 offset:40960
  ds_read_b64_tr_b16 a[82:83], v188 offset:45056
  v_exp_f32 v229, v159
  v_mfma_f32_16x16x32_bf16 v[132:135], a[124:127], a[56:59], v[132:135]
  ds_read_b64_tr_b16 a[84:85], v189 offset:40960
  v_cvt_pk_bf16_f32 v175, v228, v229
  v_add_f32 v237, v237, v228
  v_add_f32 v237, v237, v229
  v_max_f32 v240, v236, v237
  v_cmp_lt_f32 vcc, s63, v240
  v_mfma_f32_16x16x32_bf16 v[140:143], a[124:127], a[60:63], v[140:143]
  ds_read_b64_tr_b16 a[86:87], v189 offset:45056
  s_cbranch_vccnz L_nors_66_r
L_nors_66:
  s_waitcnt lgkmcnt(6)
  v_mfma_f32_16x16x32_bf16 v[64:67], a[64:67], v[168:171], v[64:67]
  ds_read_b64_tr_b16 a[88:89], v190 offset:40960
  v_add_f32 v234, v234, v236
  v_mfma_f32_16x16x32_bf16 v[72:75], a[64:67], v[172:175], v[72:75]
  ds_read_b64_tr_b16 a[90:91], v190 offset:45056
  v_add_f32 v235, v235, v237
  v_mfma_f32_16x16x32_bf16 v[68:71], a[68:71], v[168:171], v[68:71]
  ds_read_b64_tr_b16 a[92:93], v191 offset:40960
  ds_read_b64_tr_b16 a[94:95], v191 offset:45056
  v_mfma_f32_16x16x32_bf16 v[76:79], a[68:71], v[172:175], v[76:79]
  v_exp_f32 v222, v128
  v_mfma_f32_16x16x32_bf16 v[80:83], a[72:75], v[168:171], v[80:83]
  v_exp_f32 v223, v129
  v_mfma_f32_16x16x32_bf16 v[88:91], a[72:75], v[172:175], v[88:91]
  ds_read_b128 a[96:99], v208 offset:8192
  v_cvt_pk_bf16_f32 v160, v222, v223
  v_add_f32 v236, v222, v223
  s_waitcnt lgkmcnt(5)
  v_mfma_f32_16x16x32_bf16 v[84:87], a[76:79], v[168:171], v[84:87]
  v_exp_f32 v224, v130
  v_mfma_f32_16x16x32_bf16 v[92:95], a[76:79], v[172:175], v[92:95]
  buffer_store_dwordx4 a[140:143], v230, s[36:39], s51 offen offset:2688 sc1
  ds_read_b128 a[100:103], v208 offset:12288
  v_mfma_f32_16x16x32_bf16 v[96:99], a[80:83], v[168:171], v[96:99]
  v_exp_f32 v225, v131
  v_mfma_f32_16x16x32_bf16 v[104:107], a[80:83], v[172:175], v[104:107]
  ds_read_b128 a[104:107], v209 offset:8192
  v_cvt_pk_bf16_f32 v161, v224, v225
  v_add_f32 v236, v236, v224
  v_add_f32 v236, v236, v225
  v_mfma_f32_16x16x32_bf16 v[100:103], a[84:87], v[168:171], v[100:103]
  v_exp_f32 v226, v132
  v_mfma_f32_16x16x32_bf16 v[108:111], a[84:87], v[172:175], v[108:111]
  ds_read_b128 a[108:111], v209 offset:12288
  ds_read_b128 a[112:115], v210 offset:8192
  s_waitcnt lgkmcnt(4)
  v_mfma_f32_16x16x32_bf16 v[112:115], a[88:91], v[168:171], v[112:115]
  v_exp_f32 v227, v133
  v_mfma_f32_16x16x32_bf16 v[120:123], a[88:91], v[172:175], v[120:123]
  ds_read_b128 a[116:119], v210 offset:12288
  v_cvt_pk_bf16_f32 v162, v226, v227
  v_add_f32 v236, v236, v226
  v_add_f32 v236, v236, v227
  v_mfma_f32_16x16x32_bf16 v[116:119], a[92:95], v[168:171], v[116:119]
  s_add_u32 s51, s68, 3584
  ds_read_b128 a[120:123], v211 offset:8192
  v_mfma_f32_16x16x32_bf16 v[124:127], a[92:95], v[172:175], v[124:127]
  v_exp_f32 v228, v134
  v_mfma_f32_16x16x32_bf16 v[144:147], a[96:99], a[32:35], v[176:179]
  v_exp_f32 v229, v135
  v_mfma_f32_16x16x32_bf16 v[152:155], a[96:99], a[36:39], v[180:183]
  buffer_store_dwordx4 a[144:147], v230, s[36:39], s51 offen offset:0 sc1
  v_cvt_pk_bf16_f32 v163, v228, v229
  v_add_f32 v236, v236, v228
  v_add_f32 v236, v236, v229
  s_waitcnt lgkmcnt(2)
  v_mfma_f32_16x16x32_bf16 v[148:151], a[100:103], a[32:35], v[176:179]
  v_exp_f32 v222, v136
  v_mfma_f32_16x16x32_bf16 v[156:159], a[100:103], a[36:39], v[180:183]
  ds_read_b128 a[124:127], v211 offset:12288
  s_waitcnt vmcnt(5)
  s_barrier
  v_mfma_f32_16x16x32_bf16 v[144:147], a[104:107], a[40:43], v[144:147]
  v_exp_f32 v223, v137
  v_mfma_f32_16x16x32_bf16 v[152:155], a[104:107], a[44:47], v[152:155]
  ds_read_b64_tr_b16 a[64:65], v184 offset:0
  ds_read_b64_tr_b16 a[66:67], v184 offset:4096
  v_cvt_pk_bf16_f32 v164, v222, v223
  v_add_f32 v237, v222, v223
  v_mfma_f32_16x16x32_bf16 v[148:151], a[108:111], a[40:43], v[148:151]
  v_exp_f32 v224, v138
  v_mfma_f32_16x16x32_bf16 v[156:159], a[108:111], a[44:47], v[156:159]
  ds_read_b64_tr_b16 a[68:69], v185 offset:0
  ds_read_b64_tr_b16 a[70:71], v185 offset:4096
  v_exp_f32 v225, v139
  v_mfma_f32_16x16x32_bf16 v[144:147], a[112:115], a[48:51], v[144:147]
  ds_read_b64_tr_b16 a[72:73], v186 offset:0
  v_cvt_pk_bf16_f32 v165, v224, v225
  v_add_f32 v237, v237, v224
  v_add_f32 v237, v237, v225
  v_mfma_f32_16x16x32_bf16 v[152:155], a[112:115], a[52:55], v[152:155]
  ds_read_b64_tr_b16 a[74:75], v186 offset:4096
  ds_read_b64_tr_b16 a[76:77], v187 offset:0
  v_exp_f32 v226, v140
  s_waitcnt lgkmcnt(7)
  v_mfma_f32_16x16x32_bf16 v[148:151], a[116:119], a[48:51], v[148:151]
  v_exp_f32 v227, v141
  v_mfma_f32_16x16x32_bf16 v[156:159], a[116:119], a[52:55], v[156:159]
  buffer_store_dwordx4 a[148:151], v230, s[36:39], s51 offen offset:896 sc1
  ds_read_b64_tr_b16 a[78:79], v187 offset:4096
  v_cvt_pk_bf16_f32 v166, v226, v227
  v_add_f32 v237, v237, v226
  v_add_f32 v237, v237, v227
  v_mfma_f32_16x16x32_bf16 v[144:147], a[120:123], a[56:59], v[144:147]
  v_exp_f32 v228, v142
  v_mfma_f32_16x16x32_bf16 v[152:155], a[120:123], a[60:63], v[152:155]
  ds_read_b64_tr_b16 a[80:81], v188 offset:0
  ds_read_b64_tr_b16 a[82:83], v188 offset:4096
  v_exp_f32 v229, v143
  v_mfma_f32_16x16x32_bf16 v[148:151], a[124:127], a[56:59], v[148:151]
  ds_read_b64_tr_b16 a[84:85], v189 offset:0
  v_cvt_pk_bf16_f32 v167, v228, v229
  v_add_f32 v237, v237, v228
  v_add_f32 v237, v237, v229
  v_max_f32 v240, v236, v237
  v_cmp_lt_f32 vcc, s63, v240
  v_mfma_f32_16x16x32_bf16 v[156:159], a[124:127], a[60:63], v[156:159]
  ds_read_b64_tr_b16 a[86:87], v189 offset:4096
  s_cbranch_vccnz L_nors_67_r
L_nors_67:
  s_waitcnt lgkmcnt(5)
  v_mfma_f32_16x16x32_bf16 v[64:67], a[64:67], v[160:163], v[64:67]
  ds_read_b64_tr_b16 a[88:89], v190 offset:0
  v_add_f32 v234, v234, v236
  v_mfma_f32_16x16x32_bf16 v[72:75], a[64:67], v[164:167], v[72:75]
  ds_read_b64_tr_b16 a[90:91], v190 offset:4096
  v_add_f32 v235, v235, v237
  v_mfma_f32_16x16x32_bf16 v[68:71], a[68:71], v[160:163], v[68:71]
  v_exp_f32 v222, v144
  v_mfma_f32_16x16x32_bf16 v[76:79], a[68:71], v[164:167], v[76:79]
  ds_read_b64_tr_b16 a[92:93], v191 offset:0
  ds_read_b64_tr_b16 a[94:95], v191 offset:4096
  v_mfma_f32_16x16x32_bf16 v[80:83], a[72:75], v[160:163], v[80:83]
  v_exp_f32 v223, v145
  v_mfma_f32_16x16x32_bf16 v[88:91], a[72:75], v[164:167], v[88:91]
  buffer_store_dwordx4 a[152:155], v230, s[36:39], s51 offen offset:1792 sc1
  ds_read_b64_tr_b16 a[96:97], v184 offset:8192
  ds_read_b64_tr_b16 a[98:99], v184 offset:12288
  v_cvt_pk_bf16_f32 v168, v222, v223
  v_add_f32 v236, v222, v223
  v_exp_f32 v224, v146
  v_exp_f32 v225, v147
  s_waitcnt lgkmcnt(6)
  v_mfma_f32_16x16x32_bf16 v[84:87], a[76:79], v[160:163], v[84:87]
  ds_read_b64_tr_b16 a[100:101], v185 offset:8192
  v_cvt_pk_bf16_f32 v169, v224, v225
  v_add_f32 v236, v236, v224
  v_add_f32 v236, v236, v225
  v_exp_f32 v226, v148
  v_mfma_f32_16x16x32_bf16 v[92:95], a[76:79], v[164:167], v[92:95]
  ds_read_b64_tr_b16 a[102:103], v185 offset:12288
  ds_read_b64_tr_b16 a[104:105], v186 offset:8192
  v_exp_f32 v227, v149
  v_mfma_f32_16x16x32_bf16 v[96:99], a[80:83], v[160:163], v[96:99]
  ds_read_b64_tr_b16 a[106:107], v186 offset:12288
  v_cvt_pk_bf16_f32 v170, v226, v227
  v_add_f32 v236, v236, v226
  v_add_f32 v236, v236, v227
  v_exp_f32 v228, v150
  v_exp_f32 v229, v151
  v_mfma_f32_16x16x32_bf16 v[104:107], a[80:83], v[164:167], v[104:107]
  ds_read_b64_tr_b16 a[108:109], v187 offset:8192
  v_cvt_pk_bf16_f32 v171, v228, v229
  v_add_f32 v236, v236, v228
  v_add_f32 v236, v236, v229
  v_exp_f32 v222, v152
  v_mfma_f32_16x16x32_bf16 v[100:103], a[84:87], v[160:163], v[100:103]
  v_exp_f32 v223, v153
  v_mfma_f32_16x16x32_bf16 v[108:111], a[84:87], v[164:167], v[108:111]
  ds_read_b64_tr_b16 a[110:111], v187 offset:12288
  v_cvt_pk_bf16_f32 v172, v222, v223
  v_add_f32 v237, v222, v223
  v_exp_f32 v224, v154
  v_exp_f32 v225, v155
  s_waitcnt lgkmcnt(6)
  v_mfma_f32_16x16x32_bf16 v[112:115], a[88:91], v[160:163], v[112:115]
  ds_read_b64_tr_b16 a[112:113], v188 offset:8192
  v_cvt_pk_bf16_f32 v173, v224, v225
  v_add_f32 v237, v237, v224
  v_add_f32 v237, v237, v225
  v_exp_f32 v226, v156
  v_mfma_f32_16x16x32_bf16 v[120:123], a[88:91], v[164:167], v[120:123]
  ds_read_b64_tr_b16 a[114:115], v188 offset:12288
  v_exp_f32 v227, v157
  v_exp_f32 v228, v158
  v_exp_f32 v229, v159
  v_mfma_f32_16x16x32_bf16 v[116:119], a[92:95], v[160:163], v[116:119]
  ds_read_b64_tr_b16 a[116:117], v189 offset:8192
  v_cvt_pk_bf16_f32 v174, v226, v227
  v_add_f32 v237, v237, v226
  v_add_f32 v237, v237, v227
  v_cvt_pk_bf16_f32 v175, v228, v229
  v_add_f32 v237, v237, v228
  v_add_f32 v237, v237, v229
  v_mfma_f32_16x16x32_bf16 v[124:127], a[92:95], v[164:167], v[124:127]
  buffer_store_dwordx4 a[156:159], v230, s[36:39], s51 offen offset:2688 sc1
  ds_read_b64_tr_b16 a[118:119], v189 offset:12288
  v_max_f32 v240, v236, v237
  v_cmp_lt_f32 vcc, s63, v240
  s_nop 0
  s_cbranch_vccnz L_nors_68_r
L_nors_68:
  v_mfma_f32_16x16x32_bf16 v[64:67], a[96:99], v[168:171], v[64:67]
  ds_read_b64_tr_b16 a[120:121], v190 offset:8192
  v_add_f32 v234, v234, v236
  v_mfma_f32_16x16x32_bf16 v[72:75], a[96:99], v[172:175], v[72:75]
  ds_read_b64_tr_b16 a[122:123], v190 offset:12288
  v_add_f32 v235, v235, v237
  s_waitcnt lgkmcnt(6)
  v_mfma_f32_16x16x32_bf16 v[68:71], a[100:103], v[168:171], v[68:71]
  ds_read_b64_tr_b16 a[124:125], v191 offset:8192
  v_mov_b32 v240, v234
  v_mfma_f32_16x16x32_bf16 v[76:79], a[100:103], v[172:175], v[76:79]
  ds_read_b64_tr_b16 a[126:127], v191 offset:12288
  s_waitcnt lgkmcnt(0)
  s_barrier
  v_mfma_f32_16x16x32_bf16 v[80:83], a[104:107], v[168:171], v[80:83]
  v_mov_b32 v241, v235
  v_mfma_f32_16x16x32_bf16 v[88:91], a[104:107], v[172:175], v[88:91]
  ds_read_b64_tr_b16 a[64:65], v200 offset:16384
  ds_read_b64_tr_b16 a[66:67], v200 offset:20480
  v_permlane32_swap_b32 v234, v240
  v_mfma_f32_16x16x32_bf16 v[84:87], a[108:111], v[168:171], v[84:87]
  v_permlane32_swap_b32 v235, v241
  v_add_f32 v234, v234, v240
  v_mfma_f32_16x16x32_bf16 v[92:95], a[108:111], v[172:175], v[92:95]
  ds_read_b64_tr_b16 a[68:69], v201 offset:16384
  ds_read_b64_tr_b16 a[70:71], v201 offset:20480
  v_add_f32 v235, v235, v241
  v_mov_b32 v240, v234
  v_mfma_f32_16x16x32_bf16 v[96:99], a[112:115], v[168:171], v[96:99]
  ds_read_b64_tr_b16 a[72:73], v202 offset:16384
  v_mov_b32 v241, v235
  v_mfma_f32_16x16x32_bf16 v[104:107], a[112:115], v[172:175], v[104:107]
  ds_read_b64_tr_b16 a[74:75], v202 offset:20480
  ds_read_b64_tr_b16 a[76:77], v203 offset:16384
  v_permlane16_swap_b32 v234, v240
  v_mfma_f32_16x16x32_bf16 v[100:103], a[116:119], v[168:171], v[100:103]
  v_permlane16_swap_b32 v235, v241
  v_mfma_f32_16x16x32_bf16 v[108:111], a[116:119], v[172:175], v[108:111]
  ds_read_b64_tr_b16 a[78:79], v203 offset:20480
  v_add_f32 v234, v234, v240
  v_add_f32 v235, v235, v241
  v_mfma_f32_16x16x32_bf16 v[112:115], a[120:123], v[168:171], v[112:115]
  ds_read_b64_tr_b16 a[80:81], v204 offset:16384
  v_max_f32 v242, v234, v247
  v_max_f32 v244, v235, v247
  v_mfma_f32_16x16x32_bf16 v[120:123], a[120:123], v[172:175], v[120:123]
  ds_read_b64_tr_b16 a[82:83], v204 offset:20480
  v_rcp_f32 v242, v242
  v_rcp_f32 v244, v244
  v_mfma_f32_16x16x32_bf16 v[116:119], a[124:127], v[168:171], v[116:119]
  ds_read_b64_tr_b16 a[84:85], v205 offset:16384
  ds_read_b64_tr_b16 a[86:87], v205 offset:20480
  v_mfma_f32_16x16x32_bf16 v[124:127], a[124:127], v[172:175], v[124:127]
  v_pk_mul_f32 v[64:65], v[64:65], v[242:243] op_sel_hi:[1,0]
  v_cvt_pk_bf16_f32 v128, v64, v65
  v_pk_mul_f32 v[66:67], v[66:67], v[242:243] op_sel_hi:[1,0]
  v_cvt_pk_bf16_f32 v129, v66, v67
  v_pk_mul_f32 v[68:69], v[68:69], v[242:243] op_sel_hi:[1,0]
  v_cvt_pk_bf16_f32 v130, v68, v69
  v_pk_mul_f32 v[70:71], v[70:71], v[242:243] op_sel_hi:[1,0]
  v_cvt_pk_bf16_f32 v131, v70, v71
  s_add_u32 s51, s68, 7340032
  buffer_store_dwordx4 v[128:131], v230, s[36:39], s51 offen offset:0 sc1
  v_pk_mul_f32 v[72:73], v[72:73], v[244:245] op_sel_hi:[1,0]
  v_cvt_pk_bf16_f32 v132, v72, v73
  v_pk_mul_f32 v[74:75], v[74:75], v[244:245] op_sel_hi:[1,0]
  v_cvt_pk_bf16_f32 v133, v74, v75
  v_pk_mul_f32 v[76:77], v[76:77], v[244:245] op_sel_hi:[1,0]
  v_cvt_pk_bf16_f32 v134, v76, v77
  v_pk_mul_f32 v[78:79], v[78:79], v[244:245] op_sel_hi:[1,0]
  v_cvt_pk_bf16_f32 v135, v78, v79
  buffer_store_dwordx4 v[132:135], v230, s[36:39], s51 offen offset:896 sc1
  v_pk_mul_f32 v[80:81], v[80:81], v[242:243] op_sel_hi:[1,0]
  v_cvt_pk_bf16_f32 v136, v80, v81
  v_pk_mul_f32 v[82:83], v[82:83], v[242:243] op_sel_hi:[1,0]
  v_cvt_pk_bf16_f32 v137, v82, v83
  v_pk_mul_f32 v[84:85], v[84:85], v[242:243] op_sel_hi:[1,0]
  v_cvt_pk_bf16_f32 v138, v84, v85
  v_pk_mul_f32 v[86:87], v[86:87], v[242:243] op_sel_hi:[1,0]
  v_cvt_pk_bf16_f32 v139, v86, v87
  buffer_store_dwordx4 v[136:139], v230, s[36:39], s51 offen offset:1792 sc1
  v_pk_mul_f32 v[88:89], v[88:89], v[244:245] op_sel_hi:[1,0]
  v_cvt_pk_bf16_f32 v140, v88, v89
  v_pk_mul_f32 v[90:91], v[90:91], v[244:245] op_sel_hi:[1,0]
  v_cvt_pk_bf16_f32 v141, v90, v91
  v_pk_mul_f32 v[92:93], v[92:93], v[244:245] op_sel_hi:[1,0]
  v_cvt_pk_bf16_f32 v142, v92, v93
  v_pk_mul_f32 v[94:95], v[94:95], v[244:245] op_sel_hi:[1,0]
  v_cvt_pk_bf16_f32 v143, v94, v95
  buffer_store_dwordx4 v[140:143], v230, s[36:39], s51 offen offset:2688 sc1
  v_pk_mul_f32 v[96:97], v[96:97], v[242:243] op_sel_hi:[1,0]
  v_cvt_pk_bf16_f32 v144, v96, v97
  v_pk_mul_f32 v[98:99], v[98:99], v[242:243] op_sel_hi:[1,0]
  v_cvt_pk_bf16_f32 v145, v98, v99
  v_pk_mul_f32 v[100:101], v[100:101], v[242:243] op_sel_hi:[1,0]
  v_cvt_pk_bf16_f32 v146, v100, v101
  v_pk_mul_f32 v[102:103], v[102:103], v[242:243] op_sel_hi:[1,0]
  v_cvt_pk_bf16_f32 v147, v102, v103
  s_add_u32 s51, s68, 7343616
  buffer_store_dwordx4 v[144:147], v230, s[36:39], s51 offen offset:0 sc1
  v_pk_mul_f32 v[104:105], v[104:105], v[244:245] op_sel_hi:[1,0]
  v_cvt_pk_bf16_f32 v148, v104, v105
  v_pk_mul_f32 v[106:107], v[106:107], v[244:245] op_sel_hi:[1,0]
  v_cvt_pk_bf16_f32 v149, v106, v107
  v_pk_mul_f32 v[108:109], v[108:109], v[244:245] op_sel_hi:[1,0]
  v_cvt_pk_bf16_f32 v150, v108, v109
  v_pk_mul_f32 v[110:111], v[110:111], v[244:245] op_sel_hi:[1,0]
  v_cvt_pk_bf16_f32 v151, v110, v111
  buffer_store_dwordx4 v[148:151], v230, s[36:39], s51 offen offset:896 sc1
  v_pk_mul_f32 v[112:113], v[112:113], v[242:243] op_sel_hi:[1,0]
  v_cvt_pk_bf16_f32 v152, v112, v113
  v_pk_mul_f32 v[114:115], v[114:115], v[242:243] op_sel_hi:[1,0]
  v_cvt_pk_bf16_f32 v153, v114, v115
  v_pk_mul_f32 v[116:117], v[116:117], v[242:243] op_sel_hi:[1,0]
  v_cvt_pk_bf16_f32 v154, v116, v117
  v_pk_mul_f32 v[118:119], v[118:119], v[242:243] op_sel_hi:[1,0]
  v_cvt_pk_bf16_f32 v155, v118, v119
  buffer_store_dwordx4 v[152:155], v230, s[36:39], s51 offen offset:1792 sc1
  v_pk_mul_f32 v[120:121], v[120:121], v[244:245] op_sel_hi:[1,0]
  v_cvt_pk_bf16_f32 v156, v120, v121
  v_pk_mul_f32 v[122:123], v[122:123], v[244:245] op_sel_hi:[1,0]
  v_cvt_pk_bf16_f32 v157, v122, v123
  v_pk_mul_f32 v[124:125], v[124:125], v[244:245] op_sel_hi:[1,0]
  v_cvt_pk_bf16_f32 v158, v124, v125
  v_pk_mul_f32 v[126:127], v[126:127], v[244:245] op_sel_hi:[1,0]
  v_cvt_pk_bf16_f32 v159, v126, v127
  buffer_store_dwordx4 v[156:159], v230, s[36:39], s51 offen offset:2688 sc1
  s_waitcnt lgkmcnt(5)
  v_mfma_f32_16x16x32_bf16 v[0:3], a[64:67], v[128:131], 0
  ds_read_b64_tr_b16 a[88:89], v206 offset:16384
  ds_read_b64_tr_b16 a[90:91], v206 offset:20480
  v_mfma_f32_16x16x32_bf16 v[8:11], a[64:67], v[132:135], 0
  ds_read_b64_tr_b16 a[92:93], v207 offset:16384
L_pg9:
  s_cbranch_execz L_pgback
  ds_read_b64_tr_b16 a[94:95], v207 offset:20480
  v_mfma_f32_16x16x32_bf16 v[4:7], a[68:71], v[128:131], 0
  ds_read_b64_tr_b16 a[96:97], v200 offset:24576
  ds_read_b64_tr_b16 a[98:99], v200 offset:28672
  v_mfma_f32_16x16x32_bf16 v[12:15], a[68:71], v[132:135], 0
  buffer_load_dword v254, v250, s[24:27], 0 offen
  v_mfma_f32_16x16x32_bf16 v[16:19], a[72:75], v[128:131], 0
  ds_read_b64_tr_b16 a[100:101], v201 offset:24576
  ds_read_b64_tr_b16 a[102:103], v201 offset:28672
  v_mfma_f32_16x16x32_bf16 v[24:27], a[72:75], v[132:135], 0
  ds_read_b64_tr_b16 a[104:105], v202 offset:24576
  ds_read_b64_tr_b16 a[106:107], v202 offset:28672
  s_waitcnt lgkmcnt(10)
  v_mfma_f32_16x16x32_bf16 v[20:23], a[76:79], v[128:131], 0
  v_mfma_f32_16x16x32_bf16 v[28:31], a[76:79], v[132:135], 0
  ds_read_b64_tr_b16 a[108:109], v203 offset:24576
  ds_read_b64_tr_b16 a[110:111], v203 offset:28672
  v_mfma_f32_16x16x32_bf16 v[32:35], a[80:83], v[128:131], 0
  v_mfma_f32_16x16x32_bf16 v[40:43], a[80:83], v[132:135], 0
  ds_read_b64_tr_b16 a[112:113], v204 offset:24576
  ds_read_b64_tr_b16 a[114:115], v204 offset:28672
  v_mfma_f32_16x16x32_bf16 v[36:39], a[84:87], v[128:131], 0
  v_mfma_f32_16x16x32_bf16 v[44:47], a[84:87], v[132:135], 0
  ds_read_b64_tr_b16 a[116:117], v205 offset:24576
  s_waitcnt lgkmcnt(5)
  ds_read_b64_tr_b16 a[118:119], v205 offset:28672
  v_mfma_f32_16x16x32_bf16 v[48:51], a[88:91], v[128:131], 0
  v_mfma_f32_16x16x32_bf16 v[56:59], a[88:91], v[132:135], 0
  ds_read_b64_tr_b16 a[120:121], v206 offset:24576
  ds_read_b64_tr_b16 a[122:123], v206 offset:28672
  v_mfma_f32_16x16x32_bf16 v[52:55], a[92:95], v[128:131], 0
  v_mfma_f32_16x16x32_bf16 v[60:63], a[92:95], v[132:135], 0
  ds_read_b64_tr_b16 a[124:125], v207 offset:24576
  ds_read_b64_tr_b16 a[126:127], v207 offset:28672
  v_mfma_f32_16x16x32_bf16 v[0:3], a[96:99], v[136:139], v[0:3]
  v_mfma_f32_16x16x32_bf16 v[8:11], a[96:99], v[140:143], v[8:11]
  v_mfma_f32_16x16x32_bf16 v[4:7], a[100:103], v[136:139], v[4:7]
  v_mfma_f32_16x16x32_bf16 v[12:15], a[100:103], v[140:143], v[12:15]
  s_barrier
  v_mfma_f32_16x16x32_bf16 v[16:19], a[104:107], v[136:139], v[16:19]
  v_mfma_f32_16x16x32_bf16 v[24:27], a[104:107], v[140:143], v[24:27]
  ds_read_b64_tr_b16 a[64:65], v192 offset:49152
  ds_read_b64_tr_b16 a[66:67], v192 offset:53248
  s_waitcnt lgkmcnt(2)
  v_mfma_f32_16x16x32_bf16 v[20:23], a[108:111], v[136:139], v[20:23]
  ds_read_b64_tr_b16 a[68:69], v193 offset:49152
  ds_read_b64_tr_b16 a[70:71], v193 offset:53248
  v_mfma_f32_16x16x32_bf16 v[28:31], a[108:111], v[140:143], v[28:31]
  ds_read_b64_tr_b16 a[72:73], v194 offset:49152
  ds_read_b64_tr_b16 a[74:75], v194 offset:53248
  v_mfma_f32_16x16x32_bf16 v[32:35], a[112:115], v[136:139], v[32:35]
  ds_read_b64_tr_b16 a[76:77], v195 offset:49152
  ds_read_b64_tr_b16 a[78:79], v195 offset:53248
  v_mfma_f32_16x16x32_bf16 v[40:43], a[112:115], v[140:143], v[40:43]
  ds_read_b64_tr_b16 a[80:81], v196 offset:49152
  ds_read_b64_tr_b16 a[82:83], v196 offset:53248
  v_mfma_f32_16x16x32_bf16 v[36:39], a[116:119], v[136:139], v[36:39]
  v_mfma_f32_16x16x32_bf16 v[44:47], a[116:119], v[140:143], v[44:47]
  ds_read_b64_tr_b16 a[84:85], v197 offset:49152
  ds_read_b64_tr_b16 a[86:87], v197 offset:53248
  v_mfma_f32_16x16x32_bf16 v[48:51], a[120:123], v[136:139], v[48:51]
  v_mfma_f32_16x16x32_bf16 v[56:59], a[120:123], v[140:143], v[56:59]
  ds_read_b64_tr_b16 a[88:89], v198 offset:49152
  ds_read_b64_tr_b16 a[90:91], v198 offset:53248
  v_mfma_f32_16x16x32_bf16 v[52:55], a[124:127], v[136:139], v[52:55]
  v_mfma_f32_16x16x32_bf16 v[60:63], a[124:127], v[140:143], v[60:63]
  ds_read_b64_tr_b16 a[92:93], v199 offset:49152
  s_waitcnt lgkmcnt(5)
  ds_read_b64_tr_b16 a[94:95], v199 offset:53248
  v_mfma_f32_16x16x32_bf16 v[0:3], a[64:67], v[144:147], v[0:3]
  v_mfma_f32_16x16x32_bf16 v[8:11], a[64:67], v[148:151], v[8:11]
  ds_read_b64_tr_b16 a[96:97], v192 offset:57344
  ds_read_b64_tr_b16 a[98:99], v192 offset:61440
  v_mfma_f32_16x16x32_bf16 v[4:7], a[68:71], v[144:147], v[4:7]
  v_mfma_f32_16x16x32_bf16 v[12:15], a[68:71], v[148:151], v[12:15]
  ds_read_b64_tr_b16 a[100:101], v193 offset:57344
  ds_read_b64_tr_b16 a[102:103], v193 offset:61440
  v_mfma_f32_16x16x32_bf16 v[16:19], a[72:75], v[144:147], v[16:19]
  v_mfma_f32_16x16x32_bf16 v[24:27], a[72:75], v[148:151], v[24:27]
  ds_read_b64_tr_b16 a[104:105], v194 offset:57344
  ds_read_b64_tr_b16 a[106:107], v194 offset:61440
  v_mfma_f32_16x16x32_bf16 v[20:23], a[76:79], v[144:147], v[20:23]
  v_mfma_f32_16x16x32_bf16 v[28:31], a[76:79], v[148:151], v[28:31]
  ds_read_b64_tr_b16 a[108:109], v195 offset:57344
  ds_read_b64_tr_b16 a[110:111], v195 offset:61440
  v_mfma_f32_16x16x32_bf16 v[32:35], a[80:83], v[144:147], v[32:35]
  v_mfma_f32_16x16x32_bf16 v[40:43], a[80:83], v[148:151], v[40:43]
  ds_read_b64_tr_b16 a[112:113], v196 offset:57344
  s_waitcnt lgkmcnt(5)
  ds_read_b64_tr_b16 a[114:115], v196 offset:61440
  v_mfma_f32_16x16x32_bf16 v[36:39], a[84:87], v[144:147], v[36:39]
  v_mfma_f32_16x16x32_bf16 v[44:47], a[84:87], v[148:151], v[44:47]
  ds_read_b64_tr_b16 a[116:117], v197 offset:57344
  ds_read_b64_tr_b16 a[118:119], v197 offset:61440
  v_mfma_f32_16x16x32_bf16 v[48:51], a[88:91], v[144:147], v[48:51]
  v_mfma_f32_16x16x32_bf16 v[56:59], a[88:91], v[148:151], v[56:59]
  ds_read_b64_tr_b16 a[120:121], v198 offset:57344
  ds_read_b64_tr_b16 a[122:123], v198 offset:61440
  v_mfma_f32_16x16x32_bf16 v[52:55], a[92:95], v[144:147], v[52:55]
  v_mfma_f32_16x16x32_bf16 v[60:63], a[92:95], v[148:151], v[60:63]
  ds_read_b64_tr_b16 a[124:125], v199 offset:57344
  ds_read_b64_tr_b16 a[126:127], v199 offset:61440
  v_mfma_f32_16x16x32_bf16 v[0:3], a[96:99], v[152:155], v[0:3]
  v_mfma_f32_16x16x32_bf16 v[8:11], a[96:99], v[156:159], v[8:11]
  s_waitcnt vmcnt(1)
  s_barrier
  v_mov_b32 v252, 2
  s_mov_b64 exec, 1
  buffer_store_dword v252, v255, s[36:39], s66 offen sc1
  s_mov_b64 exec, -1
  v_mfma_f32_16x16x32_bf16 v[4:7], a[100:103], v[152:155], v[4:7]
  s_add_u32 m0, s45, 81920
  s_add_u32 s54, s57, 0
  v_mfma_f32_16x16x32_bf16 v[12:15], a[100:103], v[156:159], v[12:15]
  s_barrier
  s_waitcnt lgkmcnt(2)
  v_mfma_f32_16x16x32_bf16 v[16:19], a[104:107], v[152:155], v[16:19]
  buffer_load_dwordx4 v218, s[24:27], s54 offen offset:0 lds
  v_mfma_f32_16x16x32_bf16 v[24:27], a[104:107], v[156:159], v[24:27]
  ds_read_b64_tr_b16 a[64:65], v184 offset:49152
  ds_read_b64_tr_b16 a[66:67], v184 offset:53248
  v_mfma_f32_16x16x32_bf16 v[20:23], a[108:111], v[152:155], v[20:23]
  ds_read_b64_tr_b16 a[68:69], v185 offset:49152
  ds_read_b64_tr_b16 a[70:71], v185 offset:53248
  v_mfma_f32_16x16x32_bf16 v[28:31], a[108:111], v[156:159], v[28:31]
  ds_read_b64_tr_b16 a[72:73], v186 offset:49152
  ds_read_b64_tr_b16 a[74:75], v186 offset:53248
  v_mfma_f32_16x16x32_bf16 v[32:35], a[112:115], v[152:155], v[32:35]
  buffer_load_dwordx4 v219, s[24:27], s54 offen offset:1024 lds
  v_mfma_f32_16x16x32_bf16 v[40:43], a[112:115], v[156:159], v[40:43]
  ds_read_b64_tr_b16 a[76:77], v187 offset:49152
  ds_read_b64_tr_b16 a[78:79], v187 offset:53248
  v_mfma_f32_16x16x32_bf16 v[36:39], a[116:119], v[152:155], v[36:39]
  buffer_load_dwordx4 v220, s[24:27], s54 offen offset:2048 lds
  v_mfma_f32_16x16x32_bf16 v[44:47], a[116:119], v[156:159], v[44:47]
  ds_read_b64_tr_b16 a[80:81], v188 offset:49152
  ds_read_b64_tr_b16 a[82:83], v188 offset:53248
  v_mfma_f32_16x16x32_bf16 v[48:51], a[120:123], v[152:155], v[48:51]
  buffer_load_dwordx4 v221, s[24:27], s54 offen offset:3072 lds
  v_mfma_f32_16x16x32_bf16 v[56:59], a[120:123], v[156:159], v[56:59]
  s_add_u32 m0, s45, 16384
  ds_read_b64_tr_b16 a[84:85], v189 offset:49152
  s_waitcnt lgkmcnt(5)
  v_mfma_f32_16x16x32_bf16 v[52:55], a[124:127], v[152:155], v[52:55]
  s_add_u32 s54, s57, 65536
  ds_read_b64_tr_b16 a[86:87], v189 offset:53248
  v_mfma_f32_16x16x32_bf16 v[60:63], a[124:127], v[156:159], v[60:63]
  ds_read_b64_tr_b16 a[88:89], v190 offset:49152
  ds_read_b64_tr_b16 a[90:91], v190 offset:53248
  v_mfma_f32_16x16x32_bf16 v[0:3], a[64:67], a[128:131], v[0:3]
  buffer_load_dwordx4 v218, s[24:27], s54 offen offset:0 lds
  v_mfma_f32_16x16x32_bf16 v[8:11], a[64:67], a[132:135], v[8:11]
  ds_read_b64_tr_b16 a[92:93], v191 offset:49152
  ds_read_b64_tr_b16 a[94:95], v191 offset:53248
  v_mfma_f32_16x16x32_bf16 v[4:7], a[68:71], a[128:131], v[4:7]
  buffer_load_dwordx4 v219, s[24:27], s54 offen offset:1024 lds
  v_mfma_f32_16x16x32_bf16 v[12:15], a[68:71], a[132:135], v[12:15]
  ds_read_b64_tr_b16 a[96:97], v184 offset:57344
  ds_read_b64_tr_b16 a[98:99], v184 offset:61440
  v_mfma_f32_16x16x32_bf16 v[16:19], a[72:75], a[128:131], v[16:19]
  buffer_load_dwordx4 v220, s[24:27], s54 offen offset:2048 lds
  v_mfma_f32_16x16x32_bf16 v[24:27], a[72:75], a[132:135], v[24:27]
  ds_read_b64_tr_b16 a[100:101], v185 offset:57344
  ds_read_b64_tr_b16 a[102:103], v185 offset:61440
  s_waitcnt lgkmcnt(6)
  v_mfma_f32_16x16x32_bf16 v[20:23], a[76:79], a[128:131], v[20:23]
  buffer_load_dwordx4 v221, s[24:27], s54 offen offset:3072 lds
  v_mfma_f32_16x16x32_bf16 v[28:31], a[76:79], a[132:135], v[28:31]
  s_add_u32 m0, s45, 98304
  ds_read_b64_tr_b16 a[104:105], v186 offset:57344
  v_mfma_f32_16x16x32_bf16 v[32:35], a[80:83], a[128:131], v[32:35]
  s_add_u32 s54, s58, 0
  ds_read_b64_tr_b16 a[106:107], v186 offset:61440
  v_mfma_f32_16x16x32_bf16 v[40:43], a[80:83], a[132:135], v[40:43]
  ds_read_b64_tr_b16 a[108:109], v187 offset:57344
  ds_read_b64_tr_b16 a[110:111], v187 offset:61440
  v_mfma_f32_16x16x32_bf16 v[36:39], a[84:87], a[128:131], v[36:39]
  buffer_load_dwordx4 v218, s[24:27], s54 offen offset:0 lds
  v_mfma_f32_16x16x32_bf16 v[44:47], a[84:87], a[132:135], v[44:47]
  ds_read_b64_tr_b16 a[112:113], v188 offset:57344
  ds_read_b64_tr_b16 a[114:115], v188 offset:61440
  v_mfma_f32_16x16x32_bf16 v[48:51], a[88:91], a[128:131], v[48:51]
  buffer_load_dwordx4 v219, s[24:27], s54 offen offset:1024 lds
  v_mfma_f32_16x16x32_bf16 v[56:59], a[88:91], a[132:135], v[56:59]
  ds_read_b64_tr_b16 a[116:117], v189 offset:57344
  ds_read_b64_tr_b16 a[118:119], v189 offset:61440
  s_waitcnt lgkmcnt(7)
  v_mfma_f32_16x16x32_bf16 v[52:55], a[92:95], a[128:131], v[52:55]
  ds_read_b64_tr_b16 a[120:121], v190 offset:57344
  ds_read_b64_tr_b16 a[122:123], v190 offset:61440
  v_mfma_f32_16x16x32_bf16 v[60:63], a[92:95], a[132:135], v[60:63]
  buffer_load_dwordx4 v220, s[24:27], s54 offen offset:2048 lds
  v_mfma_f32_16x16x32_bf16 v[0:3], a[96:99], a[136:139], v[0:3]
  buffer_load_dwordx4 v221, s[24:27], s54 offen offset:3072 lds
  v_mfma_f32_16x16x32_bf16 v[8:11], a[96:99], a[140:143], v[8:11]
  s_add_u32 m0, s45, 32768
  ds_read_b64_tr_b16 a[124:125], v191 offset:57344
  v_mfma_f32_16x16x32_bf16 v[4:7], a[100:103], a[136:139], v[4:7]
  s_add_u32 s54, s58, 65536
  ds_read_b64_tr_b16 a[126:127], v191 offset:61440
  v_mfma_f32_16x16x32_bf16 v[12:15], a[100:103], a[140:143], v[12:15]
  s_barrier
  s_waitcnt lgkmcnt(4)
  v_mfma_f32_16x16x32_bf16 v[16:19], a[104:107], a[136:139], v[16:19]
  buffer_load_dwordx4 v218, s[24:27], s54 offen offset:0 lds
  v_mfma_f32_16x16x32_bf16 v[24:27], a[104:107], a[140:143], v[24:27]
  ds_read_b64_tr_b16 a[64:65], v200 offset:0
  ds_read_b64_tr_b16 a[66:67], v200 offset:4096
  v_mfma_f32_16x16x32_bf16 v[20:23], a[108:111], a[136:139], v[20:23]
  ds_read_b64_tr_b16 a[68:69], v201 offset:0
  ds_read_b64_tr_b16 a[70:71], v201 offset:4096
  v_mfma_f32_16x16x32_bf16 v[28:31], a[108:111], a[140:143], v[28:31]
  ds_read_b64_tr_b16 a[72:73], v202 offset:0
  ds_read_b64_tr_b16 a[74:75], v202 offset:4096
  v_mfma_f32_16x16x32_bf16 v[32:35], a[112:115], a[136:139], v[32:35]
  buffer_load_dwordx4 v219, s[24:27], s54 offen offset:1024 lds
  v_mfma_f32_16x16x32_bf16 v[40:43], a[112:115], a[140:143], v[40:43]
  buffer_load_dwordx4 v220, s[24:27], s54 offen offset:2048 lds
  v_mfma_f32_16x16x32_bf16 v[36:39], a[116:119], a[136:139], v[36:39]
  ds_read_b64_tr_b16 a[76:77], v203 offset:0
  ds_read_b64_tr_b16 a[78:79], v203 offset:4096
  v_mfma_f32_16x16x32_bf16 v[44:47], a[116:119], a[140:143], v[44:47]
  buffer_load_dwordx4 v221, s[24:27], s54 offen offset:3072 lds
  s_waitcnt lgkmcnt(6)
  v_mfma_f32_16x16x32_bf16 v[48:51], a[120:123], a[136:139], v[48:51]
  ds_read_b64_tr_b16 a[80:81], v204 offset:0
  ds_read_b64_tr_b16 a[82:83], v204 offset:4096
  v_mfma_f32_16x16x32_bf16 v[56:59], a[120:123], a[140:143], v[56:59]
  buffer_load_dword v233, v232, s[36:39], s66 offen sc1
  v_mfma_f32_16x16x32_bf16 v[52:55], a[124:127], a[136:139], v[52:55]
  s_add_u32 m0, s45, 65536
  ds_read_b64_tr_b16 a[84:85], v205 offset:0
  v_mfma_f32_16x16x32_bf16 v[60:63], a[124:127], a[140:143], v[60:63]
  s_add_u32 s54, s59, 0
  ds_read_b64_tr_b16 a[86:87], v205 offset:4096
  v_mfma_f32_16x16x32_bf16 v[0:3], a[64:67], a[144:147], v[0:3]
  ds_read_b64_tr_b16 a[88:89], v206 offset:0
  ds_read_b64_tr_b16 a[90:91], v206 offset:4096
  v_mfma_f32_16x16x32_bf16 v[8:11], a[64:67], a[148:151], v[8:11]
  buffer_load_dwordx4 v218, s[24:27], s54 offen offset:0 lds
  s_waitcnt lgkmcnt(6)
  v_mfma_f32_16x16x32_bf16 v[4:7], a[68:71], a[144:147], v[4:7]
  buffer_load_dwordx4 v219, s[24:27], s54 offen offset:1024 lds
  v_mfma_f32_16x16x32_bf16 v[12:15], a[68:71], a[148:151], v[12:15]
  ds_read_b64_tr_b16 a[92:93], v207 offset:0
  ds_read_b64_tr_b16 a[94:95], v207 offset:4096
  v_mfma_f32_16x16x32_bf16 v[16:19], a[72:75], a[144:147], v[16:19]
  buffer_load_dwordx4 v220, s[24:27], s54 offen offset:2048 lds
  v_mfma_f32_16x16x32_bf16 v[24:27], a[72:75], a[148:151], v[24:27]
  ds_read_b64_tr_b16 a[96:97], v200 offset:8192
  ds_read_b64_tr_b16 a[98:99], v200 offset:12288
  v_mfma_f32_16x16x32_bf16 v[20:23], a[76:79], a[144:147], v[20:23]
  ds_read_b64_tr_b16 a[100:101], v201 offset:8192
  ds_read_b64_tr_b16 a[102:103], v201 offset:12288
  v_mfma_f32_16x16x32_bf16 v[28:31], a[76:79], a[148:151], v[28:31]
  buffer_load_dwordx4 v221, s[24:27], s54 offen offset:3072 lds
  s_waitcnt lgkmcnt(6)
  v_mfma_f32_16x16x32_bf16 v[32:35], a[80:83], a[144:147], v[32:35]
  s_add_u32 m0, s45, 0
  ds_read_b64_tr_b16 a[104:105], v202 offset:8192
  v_mfma_f32_16x16x32_bf16 v[40:43], a[80:83], a[148:151], v[40:43]
  s_add_u32 s54, s59, 65536
  ds_read_b64_tr_b16 a[106:107], v202 offset:12288
  v_mfma_f32_16x16x32_bf16 v[36:39], a[84:87], a[144:147], v[36:39]
  ds_read_b64_tr_b16 a[108:109], v203 offset:8192
  ds_read_b64_tr_b16 a[110:111], v203 offset:12288
  v_mfma_f32_16x16x32_bf16 v[44:47], a[84:87], a[148:151], v[44:47]
  buffer_load_dwordx4 v218, s[24:27], s54 offen offset:0 lds
  v_mfma_f32_16x16x32_bf16 v[48:51], a[88:91], a[144:147], v[48:51]
  ds_read_b64_tr_b16 a[112:113], v204 offset:8192
  ds_read_b64_tr_b16 a[114:115], v204 offset:12288
  v_mfma_f32_16x16x32_bf16 v[56:59], a[88:91], a[148:151], v[56:59]
  buffer_load_dwordx4 v219, s[24:27], s54 offen offset:1024 lds
  s_waitcnt lgkmcnt(6)
  v_mfma_f32_16x16x32_bf16 v[52:55], a[92:95], a[144:147], v[52:55]
  ds_read_b64_tr_b16 a[116:117], v205 offset:8192
  ds_read_b64_tr_b16 a[118:119], v205 offset:12288
  v_mfma_f32_16x16x32_bf16 v[60:63], a[92:95], a[148:151], v[60:63]
  buffer_load_dwordx4 v220, s[24:27], s54 offen offset:2048 lds
  v_mfma_f32_16x16x32_bf16 v[0:3], a[96:99], a[152:155], v[0:3]
  buffer_load_dwordx4 v221, s[24:27], s54 offen offset:3072 lds
  v_mfma_f32_16x16x32_bf16 v[8:11], a[96:99], a[156:159], v[8:11]
  s_add_u32 m0, s45, 147456
  s_add_u32 s54, s57, 131072
  ds_read_b64_tr_b16 a[120:121], v206 offset:8192
  ds_read_b64_tr_b16 a[122:123], v206 offset:12288
  v_mfma_f32_16x16x32_bf16 v[4:7], a[100:103], a[152:155], v[4:7]
  ds_read_b64_tr_b16 a[124:125], v207 offset:8192
  ds_read_b64_tr_b16 a[126:127], v207 offset:12288
  v_mfma_f32_16x16x32_bf16 v[12:15], a[100:103], a[156:159], v[12:15]
  buffer_load_dwordx4 v218, s[24:27], s54 offen offset:0 lds
  s_waitcnt vmcnt(22)
  s_barrier
  s_waitcnt lgkmcnt(6)
  v_mfma_f32_16x16x32_bf16 v[16:19], a[104:107], a[152:155], v[16:19]
  buffer_load_dwordx4 v219, s[24:27], s54 offen offset:1024 lds
  v_mfma_f32_16x16x32_bf16 v[24:27], a[104:107], a[156:159], v[24:27]
  ds_read_b64_tr_b16 a[64:65], v192 offset:16384
  ds_read_b64_tr_b16 a[66:67], v192 offset:20480
  v_mfma_f32_16x16x32_bf16 v[20:23], a[108:111], a[152:155], v[20:23]
  buffer_load_dwordx4 v220, s[24:27], s54 offen offset:2048 lds
  v_mfma_f32_16x16x32_bf16 v[28:31], a[108:111], a[156:159], v[28:31]
  buffer_load_dwordx4 v221, s[24:27], s54 offen offset:3072 lds
  ds_read_b64_tr_b16 a[68:69], v193 offset:16384
  ds_read_b64_tr_b16 a[70:71], v193 offset:20480
  v_mfma_f32_16x16x32_bf16 v[32:35], a[112:115], a[152:155], v[32:35]
  ds_read_b64_tr_b16 a[72:73], v194 offset:16384
  ds_read_b64_tr_b16 a[74:75], v194 offset:20480
  v_mfma_f32_16x16x32_bf16 v[40:43], a[112:115], a[156:159], v[40:43]
  s_waitcnt vmcnt(12)
  v_cmp_gt_u32 s[100:101], 2, v233
  s_nop 0
  s_cmp_eq_u64 s[100:101], 0
  s_cbranch_scc1 L_ok_126
  s_mov_b32 s62, 0x40000
L_spin_127:
  buffer_load_dword v233, v232, s[36:39], s66 offen sc1
  s_waitcnt vmcnt(0)
  v_cmp_gt_u32 s[100:101], 2, v233
  s_sub_u32 s62, s62, 1
  s_cmp_eq_u32 s62, 0
  s_cbranch_scc1 L_ok_126
  s_cmp_lg_u64 s[100:101], 0
  s_cbranch_scc1 L_spin_127
L_ok_126:
  s_add_u32 s51, s69, 0
  buffer_load_dwordx4 a[160:163], v230, s[36:39], s51 offen offset:0 sc1
  buffer_load_dwordx4 a[164:167], v230, s[36:39], s51 offen offset:896 sc1
  buffer_load_dwordx4 a[168:171], v230, s[36:39], s51 offen offset:1792 sc1
  buffer_load_dwordx4 a[172:175], v230, s[36:39], s51 offen offset:2688 sc1
  s_add_u32 s51, s69, 3584
  buffer_load_dwordx4 a[176:179], v230, s[36:39], s51 offen offset:0 sc1
  buffer_load_dwordx4 a[180:183], v230, s[36:39], s51 offen offset:896 sc1
  buffer_load_dwordx4 a[184:187], v230, s[36:39], s51 offen offset:1792 sc1
  buffer_load_dwordx4 a[188:191], v230, s[36:39], s51 offen offset:2688 sc1
  s_waitcnt lgkmcnt(6)
  v_mfma_f32_16x16x32_bf16 v[36:39], a[116:119], a[152:155], v[36:39]
  s_add_u32 s51, s70, 0
  ds_read_b64_tr_b16 a[76:77], v195 offset:16384
  v_mfma_f32_16x16x32_bf16 v[44:47], a[116:119], a[156:159], v[44:47]
  ds_read_b64_tr_b16 a[78:79], v195 offset:20480
  ds_read_b64_tr_b16 a[80:81], v196 offset:16384
  v_mfma_f32_16x16x32_bf16 v[48:51], a[120:123], a[152:155], v[48:51]
  ds_read_b64_tr_b16 a[82:83], v196 offset:20480
  ds_read_b64_tr_b16 a[84:85], v197 offset:16384
  v_mfma_f32_16x16x32_bf16 v[56:59], a[120:123], a[156:159], v[56:59]
  buffer_load_dwordx4 a[192:195], v230, s[36:39], s51 offen offset:0 sc1
  v_mfma_f32_16x16x32_bf16 v[52:55], a[124:127], a[152:155], v[52:55]
  ds_read_b64_tr_b16 a[86:87], v197 offset:20480
  ds_read_b64_tr_b16 a[88:89], v198 offset:16384
  v_mfma_f32_16x16x32_bf16 v[60:63], a[124:127], a[156:159], v[60:63]
  buffer_load_dwordx4 a[196:199], v230, s[36:39], s51 offen offset:896 sc1
  s_waitcnt vmcnt(9) lgkmcnt(7)
  v_mfma_f32_16x16x32_bf16 v[0:3], a[64:67], a[160:163], v[0:3]
  ds_read_b64_tr_b16 a[90:91], v198 offset:20480
  ds_read_b64_tr_b16 a[92:93], v199 offset:16384
  s_waitcnt vmcnt(8)
  v_mfma_f32_16x16x32_bf16 v[8:11], a[64:67], a[164:167], v[8:11]
  ds_read_b64_tr_b16 a[94:95], v199 offset:20480
  ds_read_b64_tr_b16 a[96:97], v192 offset:24576
  v_mfma_f32_16x16x32_bf16 v[4:7], a[68:71], a[160:163], v[4:7]
  buffer_load_dwordx4 a[200:203], v230, s[36:39], s51 offen offset:1792 sc1
  v_mfma_f32_16x16x32_bf16 v[12:15], a[68:71], a[164:167], v[12:15]
  ds_read_b64_tr_b16 a[98:99], v192 offset:28672
  ds_read_b64_tr_b16 a[100:101], v193 offset:24576
  v_mfma_f32_16x16x32_bf16 v[16:19], a[72:75], a[160:163], v[16:19]
  buffer_load_dwordx4 a[204:207], v230, s[36:39], s51 offen offset:2688 sc1
  v_mfma_f32_16x16x32_bf16 v[24:27], a[72:75], a[164:167], v[24:27]
  s_add_u32 s51, s70, 3584
  ds_read_b64_tr_b16 a[102:103], v193 offset:28672
  s_waitcnt lgkmcnt(7)
  v_mfma_f32_16x16x32_bf16 v[20:23], a[76:79], a[160:163], v[20:23]
  ds_read_b64_tr_b16 a[104:105], v194 offset:24576
  ds_read_b64_tr_b16 a[106:107], v194 offset:28672
  v_mfma_f32_16x16x32_bf16 v[28:31], a[76:79], a[164:167], v[28:31]
  ds_read_b64_tr_b16 a[108:109], v195 offset:24576
  ds_read_b64_tr_b16 a[110:111], v195 offset:28672
  v_mfma_f32_16x16x32_bf16 v[32:35], a[80:83], a[160:163], v[32:35]
  buffer_load_dwordx4 a[208:211], v230, s[36:39], s51 offen offset:0 sc1
  v_mfma_f32_16x16x32_bf16 v[40:43], a[80:83], a[164:167], v[40:43]
  ds_read_b64_tr_b16 a[112:113], v196 offset:24576
  ds_read_b64_tr_b16 a[114:115], v196 offset:28672
  v_mfma_f32_16x16x32_bf16 v[36:39], a[84:87], a[160:163], v[36:39]
  v_mfma_f32_16x16x32_bf16 v[44:47], a[84:87], a[164:167], v[44:47]
  ds_read_b64_tr_b16 a[116:117], v197 offset:24576
  ds_read_b64_tr_b16 a[118:119], v197 offset:28672
  s_waitcnt lgkmcnt(8)
  v_mfma_f32_16x16x32_bf16 v[48:51], a[88:91], a[160:163], v[48:51]
  buffer_load_dwordx4 a[212:215], v230, s[36:39], s51 offen offset:896 sc1
  v_mfma_f32_16x16x32_bf16 v[56:59], a[88:91], a[164:167], v[56:59]
  ds_read_b64_tr_b16 a[120:121], v198 offset:24576
  ds_read_b64_tr_b16 a[122:123], v198 offset:28672
  v_mfma_f32_16x16x32_bf16 v[52:55], a[92:95], a[160:163], v[52:55]
  buffer_load_dwordx4 a[216:219], v230, s[36:39], s51 offen offset:1792 sc1
  v_mfma_f32_16x16x32_bf16 v[60:63], a[92:95], a[164:167], v[60:63]
  ds_read_b64_tr_b16 a[124:125], v199 offset:24576
  ds_read_b64_tr_b16 a[126:127], v199 offset:28672
  s_waitcnt vmcnt(12)
  v_mfma_f32_16x16x32_bf16 v[0:3], a[96:99], a[168:171], v[0:3]
  s_waitcnt vmcnt(11)
  v_mfma_f32_16x16x32_bf16 v[8:11], a[96:99], a[172:175], v[8:11]
  buffer_load_dwordx4 a[220:223], v230, s[36:39], s51 offen offset:2688 sc1
  v_mfma_f32_16x16x32_bf16 v[4:7], a[100:103], a[168:171], v[4:7]
  v_mfma_f32_16x16x32_bf16 v[12:15], a[100:103], a[172:175], v[12:15]
  s_barrier
  s_waitcnt lgkmcnt(2)
  v_mfma_f32_16x16x32_bf16 v[16:19], a[104:107], a[168:171], v[16:19]
  s_add_u32 s51, s71, 0
  v_mfma_f32_16x16x32_bf16 v[24:27], a[104:107], a[172:175], v[24:27]
  ds_read_b64_tr_b16 a[64:65], v184 offset:16384
  ds_read_b64_tr_b16 a[66:67], v184 offset:20480
  v_mfma_f32_16x16x32_bf16 v[20:23], a[108:111], a[168:171], v[20:23]
  ds_read_b64_tr_b16 a[68:69], v185 offset:16384
  ds_read_b64_tr_b16 a[70:71], v185 offset:20480
  v_mfma_f32_16x16x32_bf16 v[28:31], a[108:111], a[172:175], v[28:31]
  ds_read_b64_tr_b16 a[72:73], v186 offset:16384
  ds_read_b64_tr_b16 a[74:75], v186 offset:20480
  v_mfma_f32_16x16x32_bf16 v[32:35], a[112:115], a[168:171], v[32:35]
  buffer_load_dwordx4 a[224:227], v230, s[36:39], s51 offen offset:0 sc1
  v_mfma_f32_16x16x32_bf16 v[40:43], a[112:115], a[172:175], v[40:43]
  ds_read_b64_tr_b16 a[76:77], v187 offset:16384
  ds_read_b64_tr_b16 a[78:79], v187 offset:20480
  v_mfma_f32_16x16x32_bf16 v[36:39], a[116:119], a[168:171], v[36:39]
  buffer_load_dwordx4 a[228:231], v230, s[36:39], s51 offen offset:896 sc1
  v_mfma_f32_16x16x32_bf16 v[44:47], a[116:119], a[172:175], v[44:47]
  ds_read_b64_tr_b16 a[80:81], v188 offset:16384
  ds_read_b64_tr_b16 a[82:83], v188 offset:20480
  v_mfma_f32_16x16x32_bf16 v[48:51], a[120:123], a[168:171], v[48:51]
  ds_read_b64_tr_b16 a[84:85], v189 offset:16384
  ds_read_b64_tr_b16 a[86:87], v189 offset:20480
  v_mfma_f32_16x16x32_bf16 v[56:59], a[120:123], a[172:175], v[56:59]
  buffer_load_dwordx4 a[232:235], v230, s[36:39], s51 offen offset:1792 sc1
  s_waitcnt lgkmcnt(6)
  v_mfma_f32_16x16x32_bf16 v[52:55], a[124:127], a[168:171], v[52:55]
  ds_read_b64_tr_b16 a[88:89], v190 offset:16384
  ds_read_b64_tr_b16 a[90:91], v190 offset:20480
  v_mfma_f32_16x16x32_bf16 v[60:63], a[124:127], a[172:175], v[60:63]
  ds_read_b64_tr_b16 a[92:93], v191 offset:16384
  ds_read_b64_tr_b16 a[94:95], v191 offset:20480
  s_waitcnt vmcnt(14)
  v_mfma_f32_16x16x32_bf16 v[0:3], a[64:67], a[176:179], v[0:3]
  buffer_load_dwordx4 a[236:239], v230, s[36:39], s51 offen offset:2688 sc1
  s_waitcnt vmcnt(14)
  v_mfma_f32_16x16x32_bf16 v[8:11], a[64:67], a[180:183], v[8:11]
  s_add_u32 s51, s71, 3584
  ds_read_b64_tr_b16 a[96:97], v184 offset:24576
  v_mfma_f32_16x16x32_bf16 v[4:7], a[68:71], a[176:179], v[4:7]
  buffer_load_dwordx4 a[240:243], v230, s[36:39], s51 offen offset:0 sc1
  v_mfma_f32_16x16x32_bf16 v[12:15], a[68:71], a[180:183], v[12:15]
  ds_read_b64_tr_b16 a[98:99], v184 offset:28672
  ds_read_b64_tr_b16 a[100:101], v185 offset:24576
  v_mfma_f32_16x16x32_bf16 v[16:19], a[72:75], a[176:179], v[16:19]
  ds_read_b64_tr_b16 a[102:103], v185 offset:28672
  v_mfma_f32_16x16x32_bf16 v[24:27], a[72:75], a[180:183], v[24:27]
  ds_read_b64_tr_b16 a[104:105], v186 offset:24576
  s_waitcnt lgkmcnt(5)
  ds_read_b64_tr_b16 a[106:107], v186 offset:28672
  v_mfma_f32_16x16x32_bf16 v[20:23], a[76:79], a[176:179], v[20:23]
  buffer_load_dwordx4 a[244:247], v230, s[36:39], s51 offen offset:896 sc1
  v_mfma_f32_16x16x32_bf16 v[28:31], a[76:79], a[180:183], v[28:31]
  ds_read_b64_tr_b16 a[108:109], v187 offset:24576
  ds_read_b64_tr_b16 a[110:111], v187 offset:28672
  v_mfma_f32_16x16x32_bf16 v[32:35], a[80:83], a[176:179], v[32:35]
  v_mfma_f32_16x16x32_bf16 v[40:43], a[80:83], a[180:183], v[40:43]
  ds_read_b64_tr_b16 a[112:113], v188 offset:24576
  ds_read_b64_tr_b16 a[114:115], v188 offset:28672
  v_mfma_f32_16x16x32_bf16 v[36:39], a[84:87], a[176:179], v[36:39]
  buffer_load_dwordx4 a[248:251], v230, s[36:39], s51 offen offset:1792 sc1
  v_mfma_f32_16x16x32_bf16 v[44:47], a[84:87], a[180:183], v[44:47]
  ds_read_b64_tr_b16 a[116:117], v189 offset:24576
  ds_read_b64_tr_b16 a[118:119], v189 offset:28672
  v_mfma_f32_16x16x32_bf16 v[48:51], a[88:91], a[176:179], v[48:51]
  buffer_load_dwordx4 a[252:255], v230, s[36:39], s51 offen offset:2688 sc1
  v_mfma_f32_16x16x32_bf16 v[56:59], a[88:91], a[180:183], v[56:59]
  s_add_u32 m0, s45, 114688
  ds_read_b64_tr_b16 a[120:121], v190 offset:24576
  v_mfma_f32_16x16x32_bf16 v[52:55], a[92:95], a[176:179], v[52:55]
  s_add_u32 s54, s57, 196608
  ds_read_b64_tr_b16 a[122:123], v190 offset:28672
  v_mfma_f32_16x16x32_bf16 v[60:63], a[92:95], a[180:183], v[60:63]
  ds_read_b64_tr_b16 a[124:125], v191 offset:24576
  s_waitcnt lgkmcnt(5)
  ds_read_b64_tr_b16 a[126:127], v191 offset:28672
  s_waitcnt vmcnt(17)
  v_mfma_f32_16x16x32_bf16 v[0:3], a[96:99], a[184:187], v[0:3]
  buffer_load_dwordx4 v218, s[24:27], s54 offen offset:0 lds
  s_waitcnt vmcnt(17)
  v_mfma_f32_16x16x32_bf16 v[8:11], a[96:99], a[188:191], v[8:11]
  v_mfma_f32_16x16x32_bf16 v[4:7], a[100:103], a[184:187], v[4:7]
  v_mfma_f32_16x16x32_bf16 v[12:15], a[100:103], a[188:191], v[12:15]
  s_barrier
  v_mfma_f32_16x16x32_bf16 v[16:19], a[104:107], a[184:187], v[16:19]
  buffer_load_dwordx4 v219, s[24:27], s54 offen offset:1024 lds
  v_mfma_f32_16x16x32_bf16 v[24:27], a[104:107], a[188:191], v[24:27]
  ds_read_b64_tr_b16 a[64:65], v192 offset:32768
  ds_read_b64_tr_b16 a[66:67], v192 offset:36864
  v_mfma_f32_16x16x32_bf16 v[20:23], a[108:111], a[184:187], v[20:23]
  ds_read_b64_tr_b16 a[68:69], v193 offset:32768
  ds_read_b64_tr_b16 a[70:71], v193 offset:36864
  v_mfma_f32_16x16x32_bf16 v[28:31], a[108:111], a[188:191], v[28:31]
  ds_read_b64_tr_b16 a[72:73], v194 offset:32768
  ds_read_b64_tr_b16 a[74:75], v194 offset:36864
  v_mfma_f32_16x16x32_bf16 v[32:35], a[112:115], a[184:187], v[32:35]
  buffer_load_dwordx4 v220, s[24:27], s54 offen offset:2048 lds
  v_mfma_f32_16x16x32_bf16 v[40:43], a[112:115], a[188:191], v[40:43]
  ds_read_b64_tr_b16 a[76:77], v195 offset:32768
  ds_read_b64_tr_b16 a[78:79], v195 offset:36864
  s_waitcnt lgkmcnt(8)
  v_mfma_f32_16x16x32_bf16 v[36:39], a[116:119], a[184:187], v[36:39]
  ds_read_b64_tr_b16 a[80:81], v196 offset:32768
  ds_read_b64_tr_b16 a[82:83], v196 offset:36864
  v_mfma_f32_16x16x32_bf16 v[44:47], a[116:119], a[188:191], v[44:47]
  buffer_load_dwordx4 v221, s[24:27], s54 offen offset:3072 lds
  v_mfma_f32_16x16x32_bf16 v[48:51], a[120:123], a[184:187], v[48:51]
  s_add_u32 m0, s45, 49152
  ds_read_b64_tr_b16 a[84:85], v197 offset:32768
  v_mfma_f32_16x16x32_bf16 v[56:59], a[120:123], a[188:191], v[56:59]
  s_add_u32 s54, s58, 131072
  ds_read_b64_tr_b16 a[86:87], v197 offset:36864
  v_mfma_f32_16x16x32_bf16 v[52:55], a[124:127], a[184:187], v[52:55]
  ds_read_b64_tr_b16 a[88:89], v192 offset:40960
  ds_read_b64_tr_b16 a[90:91], v192 offset:45056
  v_mfma_f32_16x16x32_bf16 v[60:63], a[124:127], a[188:191], v[60:63]
  buffer_load_dwordx4 v218, s[24:27], s54 offen offset:0 lds
  s_waitcnt vmcnt(20) lgkmcnt(6)
  v_mfma_f32_16x16x32_bf16 v[0:3], a[64:67], a[192:195], v[0:3]
  ds_read_b64_tr_b16 a[92:93], v193 offset:40960
  ds_read_b64_tr_b16 a[94:95], v193 offset:45056
  s_waitcnt vmcnt(19)
  v_mfma_f32_16x16x32_bf16 v[8:11], a[64:67], a[196:199], v[8:11]
  buffer_load_dwordx4 v219, s[24:27], s54 offen offset:1024 lds
  v_mfma_f32_16x16x32_bf16 v[4:7], a[68:71], a[192:195], v[4:7]
  ds_read_b64_tr_b16 a[96:97], v194 offset:40960
  ds_read_b64_tr_b16 a[98:99], v194 offset:45056
  v_mfma_f32_16x16x32_bf16 v[12:15], a[68:71], a[196:199], v[12:15]
  ds_read_b64_tr_b16 a[100:101], v195 offset:40960
  ds_read_b64_tr_b16 a[102:103], v195 offset:45056
  v_mfma_f32_16x16x32_bf16 v[16:19], a[72:75], a[192:195], v[16:19]
  buffer_load_dwordx4 v220, s[24:27], s54 offen offset:2048 lds
  v_mfma_f32_16x16x32_bf16 v[24:27], a[72:75], a[196:199], v[24:27]
  ds_read_b64_tr_b16 a[104:105], v196 offset:40960
  ds_read_b64_tr_b16 a[106:107], v196 offset:45056
  v_mfma_f32_16x16x32_bf16 v[20:23], a[76:79], a[192:195], v[20:23]
  buffer_load_dwordx4 v221, s[24:27], s54 offen offset:3072 lds
L_pg10:
  s_cbranch_execz L_pgback
  v_mfma_f32_16x16x32_bf16 v[28:31], a[76:79], a[196:199], v[28:31]
  s_add_u32 s51, s69, 7340032
  ds_read_b64_tr_b16 a[108:109], v197 offset:40960
  s_waitcnt lgkmcnt(7)
  v_mfma_f32_16x16x32_bf16 v[32:35], a[80:83], a[192:195], v[32:35]
  ds_read_b64_tr_b16 a[110:111], v197 offset:45056
  v_mfma_f32_16x16x32_bf16 v[40:43], a[80:83], a[196:199], v[40:43]
  buffer_load_dwordx4 a[0:3], v230, s[36:39], s51 offen offset:0 sc1
  v_mfma_f32_16x16x32_bf16 v[36:39], a[84:87], a[192:195], v[36:39]
  v_mfma_f32_16x16x32_bf16 v[44:47], a[84:87], a[196:199], v[44:47]
  s_barrier
  s_waitcnt vmcnt(22)
  v_mfma_f32_16x16x32_bf16 v[0:3], a[88:91], a[200:203], v[0:3]
  s_waitcnt vmcnt(21)
  v_mfma_f32_16x16x32_bf16 v[8:11], a[88:91], a[204:207], v[8:11]
  ds_read_b64_tr_b16 a[112:113], v184 offset:32768
  ds_read_b64_tr_b16 a[114:115], v184 offset:36864
  v_mfma_f32_16x16x32_bf16 v[4:7], a[92:95], a[200:203], v[4:7]
  ds_read_b64_tr_b16 a[116:117], v185 offset:32768
  ds_read_b64_tr_b16 a[118:119], v185 offset:36864
  v_mfma_f32_16x16x32_bf16 v[12:15], a[92:95], a[204:207], v[12:15]
  ds_read_b64_tr_b16 a[120:121], v186 offset:32768
  ds_read_b64_tr_b16 a[122:123], v186 offset:36864
  s_waitcnt lgkmcnt(6)
  v_mfma_f32_16x16x32_bf16 v[16:19], a[96:99], a[200:203], v[16:19]
  buffer_load_dwordx4 a[4:7], v230, s[36:39], s51 offen offset:896 sc1
  v_mfma_f32_16x16x32_bf16 v[24:27], a[96:99], a[204:207], v[24:27]
  ds_read_b64_tr_b16 a[124:125], v187 offset:32768
  ds_read_b64_tr_b16 a[126:127], v187 offset:36864
  v_mfma_f32_16x16x32_bf16 v[20:23], a[100:103], a[200:203], v[20:23]
  buffer_load_dwordx4 a[8:11], v230, s[36:39], s51 offen offset:1792 sc1
  v_mfma_f32_16x16x32_bf16 v[28:31], a[100:103], a[204:207], v[28:31]
  ds_read_b64_tr_b16 a[64:65], v188 offset:32768
  ds_read_b64_tr_b16 a[66:67], v188 offset:36864
  v_mfma_f32_16x16x32_bf16 v[32:35], a[104:107], a[200:203], v[32:35]
  ds_read_b64_tr_b16 a[68:69], v189 offset:32768
  ds_read_b64_tr_b16 a[70:71], v189 offset:36864
  v_mfma_f32_16x16x32_bf16 v[40:43], a[104:107], a[204:207], v[40:43]
  buffer_load_dwordx4 a[12:15], v230, s[36:39], s51 offen offset:2688 sc1
  v_mfma_f32_16x16x32_bf16 v[36:39], a[108:111], a[200:203], v[36:39]
  s_add_u32 s51, s69, 7343616
  ds_read_b64_tr_b16 a[72:73], v184 offset:40960
  v_mfma_f32_16x16x32_bf16 v[44:47], a[108:111], a[204:207], v[44:47]
  ds_read_b64_tr_b16 a[74:75], v184 offset:45056
  ds_read_b64_tr_b16 a[76:77], v185 offset:40960
  s_waitcnt vmcnt(23) lgkmcnt(7)
  v_mfma_f32_16x16x32_bf16 v[0:3], a[112:115], a[208:211], v[0:3]
  buffer_load_dwordx4 a[16:19], v230, s[36:39], s51 offen offset:0 sc1
  s_waitcnt vmcnt(23)
  v_mfma_f32_16x16x32_bf16 v[8:11], a[112:115], a[212:215], v[8:11]
  ds_read_b64_tr_b16 a[78:79], v185 offset:45056
  ds_read_b64_tr_b16 a[80:81], v186 offset:40960
  v_mfma_f32_16x16x32_bf16 v[4:7], a[116:119], a[208:211], v[4:7]
  buffer_load_dwordx4 a[20:23], v230, s[36:39], s51 offen offset:896 sc1
  v_mfma_f32_16x16x32_bf16 v[12:15], a[116:119], a[212:215], v[12:15]
  ds_read_b64_tr_b16 a[82:83], v186 offset:45056
  ds_read_b64_tr_b16 a[84:85], v187 offset:40960
  v_mfma_f32_16x16x32_bf16 v[16:19], a[120:123], a[208:211], v[16:19]
  ds_read_b64_tr_b16 a[86:87], v187 offset:45056
  v_mfma_f32_16x16x32_bf16 v[24:27], a[120:123], a[212:215], v[24:27]
  ds_read_b64_tr_b16 a[88:89], v188 offset:40960
  ds_read_b64_tr_b16 a[90:91], v188 offset:45056
  v_mfma_f32_16x16x32_bf16 v[20:23], a[124:127], a[208:211], v[20:23]
  buffer_load_dwordx4 a[24:27], v230, s[36:39], s51 offen offset:1792 sc1
  v_mfma_f32_16x16x32_bf16 v[28:31], a[124:127], a[212:215], v[28:31]
  ds_read_b64_tr_b16 a[92:93], v189 offset:40960
  s_waitcnt lgkmcnt(6)
  ds_read_b64_tr_b16 a[94:95], v189 offset:45056
  v_mfma_f32_16x16x32_bf16 v[32:35], a[64:67], a[208:211], v[32:35]
  v_mfma_f32_16x16x32_bf16 v[40:43], a[64:67], a[212:215], v[40:43]
  buffer_load_dwordx4 a[28:31], v230, s[36:39], s51 offen offset:2688 sc1
  v_mfma_f32_16x16x32_bf16 v[36:39], a[68:71], a[208:211], v[36:39]
  s_add_u32 m0, s45, 131072
  s_add_u32 s54, s58, 196608
  v_mfma_f32_16x16x32_bf16 v[44:47], a[68:71], a[212:215], v[44:47]
  s_barrier
  s_waitcnt vmcnt(25)
  v_mfma_f32_16x16x32_bf16 v[0:3], a[72:75], a[216:219], v[0:3]
  buffer_load_dwordx4 v218, s[24:27], s54 offen offset:0 lds
  s_waitcnt vmcnt(25)
  v_mfma_f32_16x16x32_bf16 v[8:11], a[72:75], a[220:223], v[8:11]
  ds_read_b64_tr_b16 a[96:97], v192 offset:0
  ds_read_b64_tr_b16 a[98:99], v192 offset:4096
  v_mfma_f32_16x16x32_bf16 v[4:7], a[76:79], a[216:219], v[4:7]
  ds_read_b64_tr_b16 a[100:101], v193 offset:0
  ds_read_b64_tr_b16 a[102:103], v193 offset:4096
  v_mfma_f32_16x16x32_bf16 v[12:15], a[76:79], a[220:223], v[12:15]
  ds_read_b64_tr_b16 a[104:105], v194 offset:0
  ds_read_b64_tr_b16 a[106:107], v194 offset:4096
  s_waitcnt lgkmcnt(6)
  v_mfma_f32_16x16x32_bf16 v[16:19], a[80:83], a[216:219], v[16:19]
  ds_read_b64_tr_b16 a[108:109], v195 offset:0
  ds_read_b64_tr_b16 a[110:111], v195 offset:4096
  v_mfma_f32_16x16x32_bf16 v[24:27], a[80:83], a[220:223], v[24:27]
  buffer_load_dwordx4 v219, s[24:27], s54 offen offset:1024 lds
  v_mfma_f32_16x16x32_bf16 v[20:23], a[84:87], a[216:219], v[20:23]
  ds_read_b64_tr_b16 a[112:113], v196 offset:0
  ds_read_b64_tr_b16 a[114:115], v196 offset:4096
  v_mfma_f32_16x16x32_bf16 v[28:31], a[84:87], a[220:223], v[28:31]
  ds_read_b64_tr_b16 a[116:117], v197 offset:0
  ds_read_b64_tr_b16 a[118:119], v197 offset:4096
  v_mfma_f32_16x16x32_bf16 v[32:35], a[88:91], a[216:219], v[32:35]
  buffer_load_dwordx4 v220, s[24:27], s54 offen offset:2048 lds
  v_mfma_f32_16x16x32_bf16 v[40:43], a[88:91], a[220:223], v[40:43]
  ds_read_b64_tr_b16 a[120:121], v192 offset:8192
  ds_read_b64_tr_b16 a[122:123], v192 offset:12288
  v_mfma_f32_16x16x32_bf16 v[36:39], a[92:95], a[216:219], v[36:39]
  buffer_load_dwordx4 v221, s[24:27], s54 offen offset:3072 lds
  v_mfma_f32_16x16x32_bf16 v[44:47], a[92:95], a[220:223], v[44:47]
  s_add_u32 s51, s70, 7340032
  ds_read_b64_tr_b16 a[124:125], v193 offset:8192
  s_waitcnt vmcnt(27) lgkmcnt(7)
  v_mfma_f32_16x16x32_bf16 v[0:3], a[96:99], a[224:227], v[0:3]
  ds_read_b64_tr_b16 a[126:127], v193 offset:12288
  s_waitcnt vmcnt(26)
  v_mfma_f32_16x16x32_bf16 v[8:11], a[96:99], a[228:231], v[8:11]
  ds_read_b64_tr_b16 a[64:65], v194 offset:8192
  ds_read_b64_tr_b16 a[66:67], v194 offset:12288
  v_mfma_f32_16x16x32_bf16 v[4:7], a[100:103], a[224:227], v[4:7]
  buffer_load_dwordx4 a[32:35], v230, s[36:39], s51 offen offset:0 sc1
  v_mfma_f32_16x16x32_bf16 v[12:15], a[100:103], a[228:231], v[12:15]
  ds_read_b64_tr_b16 a[68:69], v195 offset:8192
  ds_read_b64_tr_b16 a[70:71], v195 offset:12288
  v_mfma_f32_16x16x32_bf16 v[16:19], a[104:107], a[224:227], v[16:19]
  v_mfma_f32_16x16x32_bf16 v[24:27], a[104:107], a[228:231], v[24:27]
  ds_read_b64_tr_b16 a[72:73], v196 offset:8192
  ds_read_b64_tr_b16 a[74:75], v196 offset:12288
  v_mfma_f32_16x16x32_bf16 v[20:23], a[108:111], a[224:227], v[20:23]
  buffer_load_dwordx4 a[36:39], v230, s[36:39], s51 offen offset:896 sc1
  v_mfma_f32_16x16x32_bf16 v[28:31], a[108:111], a[228:231], v[28:31]
  ds_read_b64_tr_b16 a[76:77], v197 offset:8192
  s_waitcnt lgkmcnt(5)
  ds_read_b64_tr_b16 a[78:79], v197 offset:12288
  v_mfma_f32_16x16x32_bf16 v[32:35], a[112:115], a[224:227], v[32:35]
  buffer_load_dwordx4 a[40:43], v230, s[36:39], s51 offen offset:1792 sc1
  v_mfma_f32_16x16x32_bf16 v[40:43], a[112:115], a[228:231], v[40:43]
  v_mfma_f32_16x16x32_bf16 v[36:39], a[116:119], a[224:227], v[36:39]
  v_mfma_f32_16x16x32_bf16 v[44:47], a[116:119], a[228:231], v[44:47]
  s_barrier
  s_waitcnt vmcnt(28)
  v_mfma_f32_16x16x32_bf16 v[0:3], a[120:123], a[232:235], v[0:3]
  buffer_load_dwordx4 a[44:47], v230, s[36:39], s51 offen offset:2688 sc1
  s_waitcnt vmcnt(28)
  v_mfma_f32_16x16x32_bf16 v[8:11], a[120:123], a[236:239], v[8:11]
  ds_read_b64_tr_b16 a[80:81], v184 offset:0
  ds_read_b64_tr_b16 a[82:83], v184 offset:4096
  v_mfma_f32_16x16x32_bf16 v[4:7], a[124:127], a[232:235], v[4:7]
  s_add_u32 s51, s70, 7343616
  ds_read_b64_tr_b16 a[84:85], v185 offset:0
  v_mfma_f32_16x16x32_bf16 v[12:15], a[124:127], a[236:239], v[12:15]
  ds_read_b64_tr_b16 a[86:87], v185 offset:4096
  ds_read_b64_tr_b16 a[88:89], v186 offset:0
  v_mfma_f32_16x16x32_bf16 v[16:19], a[64:67], a[232:235], v[16:19]
  ds_read_b64_tr_b16 a[90:91], v186 offset:4096
  ds_read_b64_tr_b16 a[92:93], v187 offset:0
  v_mfma_f32_16x16x32_bf16 v[24:27], a[64:67], a[236:239], v[24:27]
  buffer_load_dwordx4 a[48:51], v230, s[36:39], s51 offen offset:0 sc1
  s_waitcnt lgkmcnt(7)
  v_mfma_f32_16x16x32_bf16 v[20:23], a[68:71], a[232:235], v[20:23]
  ds_read_b64_tr_b16 a[94:95], v187 offset:4096
  ds_read_b64_tr_b16 a[96:97], v188 offset:0
  v_mfma_f32_16x16x32_bf16 v[28:31], a[68:71], a[236:239], v[28:31]
  buffer_load_dwordx4 a[52:55], v230, s[36:39], s51 offen offset:896 sc1
  v_mfma_f32_16x16x32_bf16 v[32:35], a[72:75], a[232:235], v[32:35]
  ds_read_b64_tr_b16 a[98:99], v188 offset:4096
  ds_read_b64_tr_b16 a[100:101], v189 offset:0
  v_mfma_f32_16x16x32_bf16 v[40:43], a[72:75], a[236:239], v[40:43]
  ds_read_b64_tr_b16 a[102:103], v189 offset:4096
  ds_read_b64_tr_b16 a[104:105], v184 offset:8192
  v_mfma_f32_16x16x32_bf16 v[36:39], a[76:79], a[232:235], v[36:39]
  buffer_load_dwordx4 a[56:59], v230, s[36:39], s51 offen offset:1792 sc1
  v_mfma_f32_16x16x32_bf16 v[44:47], a[76:79], a[236:239], v[44:47]
  ds_read_b64_tr_b16 a[106:107], v184 offset:12288
  ds_read_b64_tr_b16 a[108:109], v185 offset:8192
  s_waitcnt vmcnt(30) lgkmcnt(8)
  v_mfma_f32_16x16x32_bf16 v[0:3], a[80:83], a[240:243], v[0:3]
  buffer_load_dwordx4 a[60:63], v230, s[36:39], s51 offen offset:2688 sc1
  s_waitcnt vmcnt(30)
  v_mfma_f32_16x16x32_bf16 v[8:11], a[80:83], a[244:247], v[8:11]
  s_add_u32 m0, s45, 81920
  ds_read_b64_tr_b16 a[110:111], v185 offset:12288
  v_mfma_f32_16x16x32_bf16 v[4:7], a[84:87], a[240:243], v[4:7]
  s_add_u32 s54, s59, 131072
  ds_read_b64_tr_b16 a[112:113], v186 offset:8192
  v_mfma_f32_16x16x32_bf16 v[12:15], a[84:87], a[244:247], v[12:15]
  ds_read_b64_tr_b16 a[114:115], v186 offset:12288
  ds_read_b64_tr_b16 a[116:117], v187 offset:8192
  v_mfma_f32_16x16x32_bf16 v[16:19], a[88:91], a[240:243], v[16:19]
  buffer_load_dwordx4 v218, s[24:27], s54 offen offset:0 lds
  v_mfma_f32_16x16x32_bf16 v[24:27], a[88:91], a[244:247], v[24:27]
  ds_read_b64_tr_b16 a[118:119], v187 offset:12288
  ds_read_b64_tr_b16 a[120:121], v188 offset:8192
  s_waitcnt lgkmcnt(6)
  v_mfma_f32_16x16x32_bf16 v[20:23], a[92:95], a[240:243], v[20:23]
  ds_read_b64_tr_b16 a[122:123], v188 offset:12288
  v_mfma_f32_16x16x32_bf16 v[28:31], a[92:95], a[244:247], v[28:31]
  ds_read_b64_tr_b16 a[124:125], v189 offset:8192
  ds_read_b64_tr_b16 a[126:127], v189 offset:12288
  v_mfma_f32_16x16x32_bf16 v[32:35], a[96:99], a[240:243], v[32:35]
  buffer_load_dwordx4 v219, s[24:27], s54 offen offset:1024 lds
  v_mfma_f32_16x16x32_bf16 v[40:43], a[96:99], a[244:247], v[40:43]
  buffer_load_dwordx4 v220, s[24:27], s54 offen offset:2048 lds
  v_mfma_f32_16x16x32_bf16 v[36:39], a[100:103], a[240:243], v[36:39]
  v_mfma_f32_16x16x32_bf16 v[44:47], a[100:103], a[244:247], v[44:47]
  s_barrier
  s_waitcnt vmcnt(32)
  v_mfma_f32_16x16x32_bf16 v[0:3], a[104:107], a[248:251], v[0:3]
  s_waitcnt vmcnt(31)
  v_mfma_f32_16x16x32_bf16 v[8:11], a[104:107], a[252:255], v[8:11]
  ds_read_b64_tr_b16 a[64:65], v200 offset:16384
  ds_read_b64_tr_b16 a[66:67], v200 offset:20480
  s_waitcnt lgkmcnt(2)
  v_mfma_f32_16x16x32_bf16 v[4:7], a[108:111], a[248:251], v[4:7]
  ds_read_b64_tr_b16 a[68:69], v201 offset:16384
  ds_read_b64_tr_b16 a[70:71], v201 offset:20480
  v_mfma_f32_16x16x32_bf16 v[12:15], a[108:111], a[252:255], v[12:15]
  ds_read_b64_tr_b16 a[72:73], v202 offset:16384
  ds_read_b64_tr_b16 a[74:75], v202 offset:20480
  v_mfma_f32_16x16x32_bf16 v[16:19], a[112:115], a[248:251], v[16:19]
  buffer_load_dwordx4 v221, s[24:27], s54 offen offset:3072 lds
  v_mfma_f32_16x16x32_bf16 v[24:27], a[112:115], a[252:255], v[24:27]
  s_add_u32 m0, s45, 16384
  ds_read_b64_tr_b16 a[76:77], v203 offset:16384
  v_mfma_f32_16x16x32_bf16 v[20:23], a[116:119], a[248:251], v[20:23]
  s_add_u32 s54, s59, 196608
  ds_read_b64_tr_b16 a[78:79], v203 offset:20480
  v_mfma_f32_16x16x32_bf16 v[28:31], a[116:119], a[252:255], v[28:31]
  ds_read_b64_tr_b16 a[80:81], v204 offset:16384
  ds_read_b64_tr_b16 a[82:83], v204 offset:20480
  v_mfma_f32_16x16x32_bf16 v[32:35], a[120:123], a[248:251], v[32:35]
  buffer_load_dwordx4 v218, s[24:27], s54 offen offset:0 lds
  v_mfma_f32_16x16x32_bf16 v[40:43], a[120:123], a[252:255], v[40:43]
  ds_read_b64_tr_b16 a[84:85], v205 offset:16384
  ds_read_b64_tr_b16 a[86:87], v205 offset:20480
  v_mfma_f32_16x16x32_bf16 v[36:39], a[124:127], a[248:251], v[36:39]
  buffer_load_dwordx4 v219, s[24:27], s54 offen offset:1024 lds
  v_mfma_f32_16x16x32_bf16 v[44:47], a[124:127], a[252:255], v[44:47]
  ds_read_b64_tr_b16 a[88:89], v200 offset:24576
  ds_read_b64_tr_b16 a[90:91], v200 offset:28672
  s_waitcnt vmcnt(25) lgkmcnt(7)
  v_mfma_f32_16x16x32_bf16 v[0:3], a[64:67], a[0:3], v[0:3]
  ds_read_b64_tr_b16 a[92:93], v201 offset:24576
  ds_read_b64_tr_b16 a[94:95], v201 offset:28672
  s_waitcnt vmcnt(24)
  v_mfma_f32_16x16x32_bf16 v[8:11], a[64:67], a[4:7], v[8:11]
  buffer_load_dwordx4 v220, s[24:27], s54 offen offset:2048 lds
  v_mfma_f32_16x16x32_bf16 v[4:7], a[68:71], a[0:3], v[4:7]
  ds_read_b64_tr_b16 a[96:97], v202 offset:24576
  ds_read_b64_tr_b16 a[98:99], v202 offset:28672
  v_mfma_f32_16x16x32_bf16 v[12:15], a[68:71], a[4:7], v[12:15]
  ds_read_b64_tr_b16 a[100:101], v203 offset:24576
  ds_read_b64_tr_b16 a[102:103], v203 offset:28672
  v_mfma_f32_16x16x32_bf16 v[16:19], a[72:75], a[0:3], v[16:19]
  buffer_load_dwordx4 v221, s[24:27], s54 offen offset:3072 lds
  v_mfma_f32_16x16x32_bf16 v[24:27], a[72:75], a[4:7], v[24:27]
  s_add_u32 s51, s71, 7340032
  ds_read_b64_tr_b16 a[104:105], v204 offset:24576
  s_waitcnt lgkmcnt(7)
  v_mfma_f32_16x16x32_bf16 v[20:23], a[76:79], a[0:3], v[20:23]
  buffer_load_dwordx4 a[128:131], v230, s[36:39], s51 offen offset:0 sc1
  v_mfma_f32_16x16x32_bf16 v[28:31], a[76:79], a[4:7], v[28:31]
  ds_read_b64_tr_b16 a[106:107], v204 offset:28672
  ds_read_b64_tr_b16 a[108:109], v205 offset:24576
  v_mfma_f32_16x16x32_bf16 v[32:35], a[80:83], a[0:3], v[32:35]
  ds_read_b64_tr_b16 a[110:111], v205 offset:28672
  v_mfma_f32_16x16x32_bf16 v[40:43], a[80:83], a[4:7], v[40:43]
  buffer_load_dwordx4 a[132:135], v230, s[36:39], s51 offen offset:896 sc1
  v_mfma_f32_16x16x32_bf16 v[36:39], a[84:87], a[0:3], v[36:39]
  v_mfma_f32_16x16x32_bf16 v[44:47], a[84:87], a[4:7], v[44:47]
  s_barrier
  s_waitcnt vmcnt(27)
  v_mfma_f32_16x16x32_bf16 v[0:3], a[88:91], a[8:11], v[0:3]
  s_waitcnt vmcnt(26)
  v_mfma_f32_16x16x32_bf16 v[8:11], a[88:91], a[12:15], v[8:11]
  ds_read_b64_tr_b16 a[112:113], v192 offset:49152
  ds_read_b64_tr_b16 a[114:115], v192 offset:53248
  s_waitcnt lgkmcnt(3)
  v_mfma_f32_16x16x32_bf16 v[4:7], a[92:95], a[8:11], v[4:7]
  ds_read_b64_tr_b16 a[116:117], v193 offset:49152
  ds_read_b64_tr_b16 a[118:119], v193 offset:53248
  v_mfma_f32_16x16x32_bf16 v[12:15], a[92:95], a[12:15], v[12:15]
  ds_read_b64_tr_b16 a[120:121], v194 offset:49152
  ds_read_b64_tr_b16 a[122:123], v194 offset:53248
  v_mfma_f32_16x16x32_bf16 v[16:19], a[96:99], a[8:11], v[16:19]
  buffer_load_dwordx4 a[136:139], v230, s[36:39], s51 offen offset:1792 sc1
  v_mfma_f32_16x16x32_bf16 v[24:27], a[96:99], a[12:15], v[24:27]
  ds_read_b64_tr_b16 a[124:125], v195 offset:49152
  ds_read_b64_tr_b16 a[126:127], v195 offset:53248
  v_mfma_f32_16x16x32_bf16 v[20:23], a[100:103], a[8:11], v[20:23]
  buffer_load_dwordx4 a[140:143], v230, s[36:39], s51 offen offset:2688 sc1
  v_mfma_f32_16x16x32_bf16 v[28:31], a[100:103], a[12:15], v[28:31]
  s_add_u32 s51, s71, 7343616
  ds_read_b64_tr_b16 a[64:65], v196 offset:49152
  v_mfma_f32_16x16x32_bf16 v[32:35], a[104:107], a[8:11], v[32:35]
  ds_read_b64_tr_b16 a[66:67], v196 offset:53248
  ds_read_b64_tr_b16 a[68:69], v197 offset:49152
  v_mfma_f32_16x16x32_bf16 v[40:43], a[104:107], a[12:15], v[40:43]
  buffer_load_dwordx4 a[144:147], v230, s[36:39], s51 offen offset:0 sc1
  s_waitcnt lgkmcnt(5)
  v_mfma_f32_16x16x32_bf16 v[36:39], a[108:111], a[8:11], v[36:39]
  ds_read_b64_tr_b16 a[70:71], v197 offset:53248
  ds_read_b64_tr_b16 a[72:73], v192 offset:57344
  v_mfma_f32_16x16x32_bf16 v[44:47], a[108:111], a[12:15], v[44:47]
  ds_read_b64_tr_b16 a[74:75], v192 offset:61440
  ds_read_b64_tr_b16 a[76:77], v193 offset:57344
  s_waitcnt vmcnt(28)
  v_mfma_f32_16x16x32_bf16 v[0:3], a[112:115], a[16:19], v[0:3]
  buffer_load_dwordx4 a[148:151], v230, s[36:39], s51 offen offset:896 sc1
  s_waitcnt vmcnt(28)
  v_mfma_f32_16x16x32_bf16 v[8:11], a[112:115], a[20:23], v[8:11]
  ds_read_b64_tr_b16 a[78:79], v193 offset:61440
  ds_read_b64_tr_b16 a[80:81], v194 offset:57344
  v_mfma_f32_16x16x32_bf16 v[4:7], a[116:119], a[16:19], v[4:7]
  buffer_load_dwordx4 a[152:155], v230, s[36:39], s51 offen offset:1792 sc1
  v_mfma_f32_16x16x32_bf16 v[12:15], a[116:119], a[20:23], v[12:15]
  ds_read_b64_tr_b16 a[82:83], v194 offset:61440
  ds_read_b64_tr_b16 a[84:85], v195 offset:57344
  v_mfma_f32_16x16x32_bf16 v[16:19], a[120:123], a[16:19], v[16:19]
  ds_read_b64_tr_b16 a[86:87], v195 offset:61440
  v_mfma_f32_16x16x32_bf16 v[24:27], a[120:123], a[20:23], v[24:27]
  buffer_load_dwordx4 a[156:159], v230, s[36:39], s51 offen offset:2688 sc1
  s_waitcnt lgkmcnt(5)
  v_mfma_f32_16x16x32_bf16 v[20:23], a[124:127], a[16:19], v[20:23]
  ds_read_b64_tr_b16 a[88:89], v196 offset:57344
  ds_read_b64_tr_b16 a[90:91], v196 offset:61440
  v_mfma_f32_16x16x32_bf16 v[28:31], a[124:127], a[20:23], v[28:31]
  ds_read_b64_tr_b16 a[92:93], v197 offset:57344
  ds_read_b64_tr_b16 a[94:95], v197 offset:61440
  v_mfma_f32_16x16x32_bf16 v[32:35], a[64:67], a[16:19], v[32:35]
  v_mfma_f32_16x16x32_bf16 v[40:43], a[64:67], a[20:23], v[40:43]
  v_mfma_f32_16x16x32_bf16 v[36:39], a[68:71], a[16:19], v[36:39]
  v_mfma_f32_16x16x32_bf16 v[44:47], a[68:71], a[20:23], v[44:47]
  s_waitcnt vmcnt(8)
  s_barrier
  v_mfma_f32_16x16x32_bf16 v[0:3], a[72:75], a[24:27], v[0:3]
  v_mfma_f32_16x16x32_bf16 v[8:11], a[72:75], a[28:31], v[8:11]
  ds_read_b64_tr_b16 a[96:97], v184 offset:49152
  ds_read_b64_tr_b16 a[98:99], v184 offset:53248
  s_waitcnt lgkmcnt(2)
  v_mfma_f32_16x16x32_bf16 v[4:7], a[76:79], a[24:27], v[4:7]
  ds_read_b64_tr_b16 a[100:101], v185 offset:49152
  ds_read_b64_tr_b16 a[102:103], v185 offset:53248
  v_mfma_f32_16x16x32_bf16 v[12:15], a[76:79], a[28:31], v[12:15]
  ds_read_b64_tr_b16 a[104:105], v184 offset:57344
  ds_read_b64_tr_b16 a[106:107], v184 offset:61440
  v_mfma_f32_16x16x32_bf16 v[16:19], a[80:83], a[24:27], v[16:19]
  ds_read_b64_tr_b16 a[108:109], v185 offset:57344
  ds_read_b64_tr_b16 a[110:111], v185 offset:61440
  v_mfma_f32_16x16x32_bf16 v[24:27], a[80:83], a[28:31], v[24:27]
  ds_read_b64_tr_b16 a[112:113], v200 offset:0
  ds_read_b64_tr_b16 a[114:115], v200 offset:4096
  v_mfma_f32_16x16x32_bf16 v[20:23], a[84:87], a[24:27], v[20:23]
  v_mfma_f32_16x16x32_bf16 v[28:31], a[84:87], a[28:31], v[28:31]
  ds_read_b64_tr_b16 a[116:117], v201 offset:0
  ds_read_b64_tr_b16 a[118:119], v201 offset:4096
  v_mfma_f32_16x16x32_bf16 v[32:35], a[88:91], a[24:27], v[32:35]
  v_mfma_f32_16x16x32_bf16 v[40:43], a[88:91], a[28:31], v[40:43]
  ds_read_b64_tr_b16 a[120:121], v200 offset:8192
  ds_read_b64_tr_b16 a[122:123], v200 offset:12288
  v_mfma_f32_16x16x32_bf16 v[36:39], a[92:95], a[24:27], v[36:39]
  v_mfma_f32_16x16x32_bf16 v[44:47], a[92:95], a[28:31], v[44:47]
  ds_read_b64_tr_b16 a[124:125], v201 offset:8192
  s_waitcnt lgkmcnt(5)
  ds_read_b64_tr_b16 a[126:127], v201 offset:12288
  v_mfma_f32_16x16x32_bf16 v[0:3], a[96:99], a[32:35], v[0:3]
  v_mfma_f32_16x16x32_bf16 v[8:11], a[96:99], a[36:39], v[8:11]
  ds_read_b64_tr_b16 a[64:65], v192 offset:16384
  ds_read_b64_tr_b16 a[66:67], v192 offset:20480
  v_mfma_f32_16x16x32_bf16 v[4:7], a[100:103], a[32:35], v[4:7]
  v_mfma_f32_16x16x32_bf16 v[12:15], a[100:103], a[36:39], v[12:15]
  ds_read_b64_tr_b16 a[68:69], v193 offset:16384
  ds_read_b64_tr_b16 a[70:71], v193 offset:20480
  v_mfma_f32_16x16x32_bf16 v[0:3], a[104:107], a[40:43], v[0:3]
  v_mfma_f32_16x16x32_bf16 v[8:11], a[104:107], a[44:47], v[8:11]
  ds_read_b64_tr_b16 a[72:73], v192 offset:24576
  ds_read_b64_tr_b16 a[74:75], v192 offset:28672
  v_mfma_f32_16x16x32_bf16 v[4:7], a[108:111], a[40:43], v[4:7]
  v_mfma_f32_16x16x32_bf16 v[12:15], a[108:111], a[44:47], v[12:15]
  ds_read_b64_tr_b16 a[76:77], v193 offset:24576
  ds_read_b64_tr_b16 a[78:79], v193 offset:28672
  v_mfma_f32_16x16x32_bf16 v[0:3], a[112:115], a[48:51], v[0:3]
  v_mfma_f32_16x16x32_bf16 v[8:11], a[112:115], a[52:55], v[8:11]
  ds_read_b64_tr_b16 a[80:81], v184 offset:16384
  s_waitcnt lgkmcnt(5)
  ds_read_b64_tr_b16 a[82:83], v184 offset:20480
  v_mfma_f32_16x16x32_bf16 v[4:7], a[116:119], a[48:51], v[4:7]
  v_mfma_f32_16x16x32_bf16 v[12:15], a[116:119], a[52:55], v[12:15]
  ds_read_b64_tr_b16 a[84:85], v185 offset:16384
  ds_read_b64_tr_b16 a[86:87], v185 offset:20480
  v_mfma_f32_16x16x32_bf16 v[0:3], a[120:123], a[56:59], v[0:3]
  v_mfma_f32_16x16x32_bf16 v[8:11], a[120:123], a[60:63], v[8:11]
  ds_read_b64_tr_b16 a[88:89], v184 offset:24576
  ds_read_b64_tr_b16 a[90:91], v184 offset:28672
  v_mfma_f32_16x16x32_bf16 v[4:7], a[124:127], a[56:59], v[4:7]
  v_mfma_f32_16x16x32_bf16 v[12:15], a[124:127], a[60:63], v[12:15]
  ds_read_b64_tr_b16 a[92:93], v185 offset:24576
  ds_read_b64_tr_b16 a[94:95], v185 offset:28672
  s_waitcnt vmcnt(7)
  v_mfma_f32_16x16x32_bf16 v[0:3], a[64:67], a[128:131], v[0:3]
  s_waitcnt vmcnt(6)
  v_mfma_f32_16x16x32_bf16 v[8:11], a[64:67], a[132:135], v[8:11]
  ds_read_b64_tr_b16 a[96:97], v186 offset:49152
  ds_read_b64_tr_b16 a[98:99], v186 offset:53248
  v_mfma_f32_16x16x32_bf16 v[4:7], a[68:71], a[128:131], v[4:7]
  v_mfma_f32_16x16x32_bf16 v[12:15], a[68:71], a[132:135], v[12:15]
  ds_read_b64_tr_b16 a[100:101], v187 offset:49152
  s_waitcnt lgkmcnt(5)
  ds_read_b64_tr_b16 a[102:103], v187 offset:53248
  s_waitcnt vmcnt(5)
  v_mfma_f32_16x16x32_bf16 v[0:3], a[72:75], a[136:139], v[0:3]
  s_waitcnt vmcnt(4)
  v_mfma_f32_16x16x32_bf16 v[8:11], a[72:75], a[140:143], v[8:11]
  ds_read_b64_tr_b16 a[104:105], v186 offset:57344
  ds_read_b64_tr_b16 a[106:107], v186 offset:61440
  v_mfma_f32_16x16x32_bf16 v[4:7], a[76:79], a[136:139], v[4:7]
  v_mfma_f32_16x16x32_bf16 v[12:15], a[76:79], a[140:143], v[12:15]
  ds_read_b64_tr_b16 a[108:109], v187 offset:57344
  ds_read_b64_tr_b16 a[110:111], v187 offset:61440
  s_waitcnt vmcnt(3)
  v_mfma_f32_16x16x32_bf16 v[0:3], a[80:83], a[144:147], v[0:3]
  s_waitcnt vmcnt(2)
  v_mfma_f32_16x16x32_bf16 v[8:11], a[80:83], a[148:151], v[8:11]
  ds_read_b64_tr_b16 a[112:113], v202 offset:0
  ds_read_b64_tr_b16 a[114:115], v202 offset:4096
  v_mfma_f32_16x16x32_bf16 v[4:7], a[84:87], a[144:147], v[4:7]
  v_mfma_f32_16x16x32_bf16 v[12:15], a[84:87], a[148:151], v[12:15]
  ds_read_b64_tr_b16 a[116:117], v203 offset:0
  ds_read_b64_tr_b16 a[118:119], v203 offset:4096
  s_waitcnt vmcnt(1)
  v_mfma_f32_16x16x32_bf16 v[0:3], a[88:91], a[152:155], v[0:3]
  s_waitcnt vmcnt(0)
  v_mfma_f32_16x16x32_bf16 v[8:11], a[88:91], a[156:159], v[8:11]
  ds_read_b64_tr_b16 a[120:121], v202 offset:8192
  s_waitcnt lgkmcnt(5)
  ds_read_b64_tr_b16 a[122:123], v202 offset:12288
  v_mfma_f32_16x16x32_bf16 v[4:7], a[92:95], a[152:155], v[4:7]
  v_mfma_f32_16x16x32_bf16 v[12:15], a[92:95], a[156:159], v[12:15]
  ds_read_b64_tr_b16 a[124:125], v203 offset:8192
  ds_read_b64_tr_b16 a[126:127], v203 offset:12288
  v_mfma_f32_16x16x32_bf16 v[16:19], a[96:99], a[32:35], v[16:19]
  v_mfma_f32_16x16x32_bf16 v[24:27], a[96:99], a[36:39], v[24:27]
  ds_read_b64_tr_b16 a[64:65], v194 offset:16384
  ds_read_b64_tr_b16 a[66:67], v194 offset:20480
  v_mfma_f32_16x16x32_bf16 v[20:23], a[100:103], a[32:35], v[20:23]
  v_mfma_f32_16x16x32_bf16 v[28:31], a[100:103], a[36:39], v[28:31]
  ds_read_b64_tr_b16 a[68:69], v195 offset:16384
  ds_read_b64_tr_b16 a[70:71], v195 offset:20480
  v_mfma_f32_16x16x32_bf16 v[16:19], a[104:107], a[40:43], v[16:19]
  v_mfma_f32_16x16x32_bf16 v[24:27], a[104:107], a[44:47], v[24:27]
  v_cvt_pk_bf16_f32 v64, v0, v1
  v_cvt_pk_bf16_f32 v65, v2, v3
  v_mfma_f32_16x16x32_bf16 v[20:23], a[108:111], a[40:43], v[20:23]
  ds_read_b64_tr_b16 a[72:73], v194 offset:24576
  ds_read_b64_tr_b16 a[74:75], v194 offset:28672
  v_mfma_f32_16x16x32_bf16 v[28:31], a[108:111], a[44:47], v[28:31]
  ds_read_b64_tr_b16 a[76:77], v195 offset:24576
  s_waitcnt lgkmcnt(5)
  ds_read_b64_tr_b16 a[78:79], v195 offset:28672
  v_mfma_f32_16x16x32_bf16 v[16:19], a[112:115], a[48:51], v[16:19]
  v_mfma_f32_16x16x32_bf16 v[24:27], a[112:115], a[52:55], v[24:27]
  v_cvt_pk_bf16_f32 v66, v4, v5
  v_cvt_pk_bf16_f32 v67, v6, v7
  v_min_u32 v64, -2, v64
  v_mfma_f32_16x16x32_bf16 v[20:23], a[116:119], a[48:51], v[20:23]
  ds_read_b64_tr_b16 a[80:81], v186 offset:16384
  ds_read_b64_tr_b16 a[82:83], v186 offset:20480
  v_mfma_f32_16x16x32_bf16 v[28:31], a[116:119], a[52:55], v[28:31]
  s_add_u32 s51, s72, 0
  buffer_store_dwordx4 v[64:67], v230, s[36:39], s51 offen offset:0 sc1
  v_cvt_pk_bf16_f32 v68, v8, v9
  v_cvt_pk_bf16_f32 v69, v10, v11
  v_mfma_f32_16x16x32_bf16 v[16:19], a[120:123], a[56:59], v[16:19]
  ds_read_b64_tr_b16 a[84:85], v187 offset:16384
  ds_read_b64_tr_b16 a[86:87], v187 offset:20480
  v_mfma_f32_16x16x32_bf16 v[24:27], a[120:123], a[60:63], v[24:27]
  v_cvt_pk_bf16_f32 v70, v12, v13
  v_cvt_pk_bf16_f32 v71, v14, v15
  v_min_u32 v68, -2, v68
  v_mfma_f32_16x16x32_bf16 v[20:23], a[124:127], a[56:59], v[20:23]
  buffer_store_dwordx4 v[68:71], v230, s[36:39], s51 offen offset:896 sc1
  v_mfma_f32_16x16x32_bf16 v[28:31], a[124:127], a[60:63], v[28:31]
  ds_read_b64_tr_b16 a[88:89], v186 offset:24576
  ds_read_b64_tr_b16 a[90:91], v186 offset:28672
  v_mfma_f32_16x16x32_bf16 v[16:19], a[64:67], a[128:131], v[16:19]
  ds_read_b64_tr_b16 a[92:93], v187 offset:24576
  ds_read_b64_tr_b16 a[94:95], v187 offset:28672
  v_mfma_f32_16x16x32_bf16 v[24:27], a[64:67], a[132:135], v[24:27]
  ds_read_b64_tr_b16 a[96:97], v188 offset:49152
  s_waitcnt lgkmcnt(7)
  ds_read_b64_tr_b16 a[98:99], v188 offset:53248
  v_mfma_f32_16x16x32_bf16 v[20:23], a[68:71], a[128:131], v[20:23]
  v_mfma_f32_16x16x32_bf16 v[28:31], a[68:71], a[132:135], v[28:31]
  ds_read_b64_tr_b16 a[100:101], v189 offset:49152
  ds_read_b64_tr_b16 a[102:103], v189 offset:53248
  v_mfma_f32_16x16x32_bf16 v[16:19], a[72:75], a[136:139], v[16:19]
  v_mfma_f32_16x16x32_bf16 v[24:27], a[72:75], a[140:143], v[24:27]
  ds_read_b64_tr_b16 a[104:105], v188 offset:57344
  ds_read_b64_tr_b16 a[106:107], v188 offset:61440
  v_mfma_f32_16x16x32_bf16 v[20:23], a[76:79], a[136:139], v[20:23]
  v_mfma_f32_16x16x32_bf16 v[28:31], a[76:79], a[140:143], v[28:31]
  ds_read_b64_tr_b16 a[108:109], v189 offset:57344
  ds_read_b64_tr_b16 a[110:111], v189 offset:61440
  v_mfma_f32_16x16x32_bf16 v[16:19], a[80:83], a[144:147], v[16:19]
  v_mfma_f32_16x16x32_bf16 v[24:27], a[80:83], a[148:151], v[24:27]
  ds_read_b64_tr_b16 a[112:113], v204 offset:0
  s_waitcnt lgkmcnt(5)
  ds_read_b64_tr_b16 a[114:115], v204 offset:4096
  v_mfma_f32_16x16x32_bf16 v[20:23], a[84:87], a[144:147], v[20:23]
  v_mfma_f32_16x16x32_bf16 v[28:31], a[84:87], a[148:151], v[28:31]
  ds_read_b64_tr_b16 a[116:117], v205 offset:0
  ds_read_b64_tr_b16 a[118:119], v205 offset:4096
  v_mfma_f32_16x16x32_bf16 v[16:19], a[88:91], a[152:155], v[16:19]
  v_mfma_f32_16x16x32_bf16 v[24:27], a[88:91], a[156:159], v[24:27]
  ds_read_b64_tr_b16 a[120:121], v204 offset:8192
  ds_read_b64_tr_b16 a[122:123], v204 offset:12288
  v_mfma_f32_16x16x32_bf16 v[20:23], a[92:95], a[152:155], v[20:23]
  v_mfma_f32_16x16x32_bf16 v[28:31], a[92:95], a[156:159], v[28:31]
  ds_read_b64_tr_b16 a[124:125], v205 offset:8192
  ds_read_b64_tr_b16 a[126:127], v205 offset:12288
  v_mfma_f32_16x16x32_bf16 v[32:35], a[96:99], a[32:35], v[32:35]
  v_mfma_f32_16x16x32_bf16 v[40:43], a[96:99], a[36:39], v[40:43]
  ds_read_b64_tr_b16 a[64:65], v196 offset:16384
  ds_read_b64_tr_b16 a[66:67], v196 offset:20480
  v_mfma_f32_16x16x32_bf16 v[36:39], a[100:103], a[32:35], v[36:39]
  v_mfma_f32_16x16x32_bf16 v[44:47], a[100:103], a[36:39], v[44:47]
  ds_read_b64_tr_b16 a[68:69], v197 offset:16384
  s_waitcnt lgkmcnt(5)
  ds_read_b64_tr_b16 a[70:71], v197 offset:20480
  v_mfma_f32_16x16x32_bf16 v[32:35], a[104:107], a[40:43], v[32:35]
  v_mfma_f32_16x16x32_bf16 v[40:43], a[104:107], a[44:47], v[40:43]
  v_cvt_pk_bf16_f32 v72, v16, v17
  v_cvt_pk_bf16_f32 v73, v18, v19
  v_mfma_f32_16x16x32_bf16 v[36:39], a[108:111], a[40:43], v[36:39]
  ds_read_b64_tr_b16 a[72:73], v196 offset:24576
  ds_read_b64_tr_b16 a[74:75], v196 offset:28672
  v_mfma_f32_16x16x32_bf16 v[44:47], a[108:111], a[44:47], v[44:47]
  ds_read_b64_tr_b16 a[76:77], v197 offset:24576
  ds_read_b64_tr_b16 a[78:79], v197 offset:28672
  v_mfma_f32_16x16x32_bf16 v[32:35], a[112:115], a[48:51], v[32:35]
  v_mfma_f32_16x16x32_bf16 v[40:43], a[112:115], a[52:55], v[40:43]
  v_cvt_pk_bf16_f32 v74, v20, v21
L_pg11:
  s_cbranch_execz L_pgback
  v_cvt_pk_bf16_f32 v75, v22, v23
  v_min_u32 v72, -2, v72
  v_mfma_f32_16x16x32_bf16 v[36:39], a[116:119], a[48:51], v[36:39]
  ds_read_b64_tr_b16 a[80:81], v188 offset:16384
  ds_read_b64_tr_b16 a[82:83], v188 offset:20480
  v_mfma_f32_16x16x32_bf16 v[44:47], a[116:119], a[52:55], v[44:47]
  s_add_u32 s51, s73, 0
  buffer_store_dwordx4 v[72:75], v230, s[36:39], s51 offen offset:0 sc1
  v_cvt_pk_bf16_f32 v76, v24, v25
  v_cvt_pk_bf16_f32 v77, v26, v27
  v_mfma_f32_16x16x32_bf16 v[32:35], a[120:123], a[56:59], v[32:35]
  ds_read_b64_tr_b16 a[84:85], v189 offset:16384
  ds_read_b64_tr_b16 a[86:87], v189 offset:20480
  v_mfma_f32_16x16x32_bf16 v[40:43], a[120:123], a[60:63], v[40:43]
  v_cvt_pk_bf16_f32 v78, v28, v29
  v_cvt_pk_bf16_f32 v79, v30, v31
  v_min_u32 v76, -2, v76
  s_waitcnt lgkmcnt(4)
  v_mfma_f32_16x16x32_bf16 v[36:39], a[124:127], a[56:59], v[36:39]
  buffer_store_dwordx4 v[76:79], v230, s[36:39], s51 offen offset:896 sc1
  v_mfma_f32_16x16x32_bf16 v[44:47], a[124:127], a[60:63], v[44:47]
  ds_read_b64_tr_b16 a[88:89], v188 offset:24576
  ds_read_b64_tr_b16 a[90:91], v188 offset:28672
  v_mfma_f32_16x16x32_bf16 v[32:35], a[64:67], a[128:131], v[32:35]
  ds_read_b64_tr_b16 a[92:93], v189 offset:24576
  ds_read_b64_tr_b16 a[94:95], v189 offset:28672
  v_mfma_f32_16x16x32_bf16 v[40:43], a[64:67], a[132:135], v[40:43]
  ds_read_b64_tr_b16 a[96:97], v198 offset:32768
  ds_read_b64_tr_b16 a[98:99], v198 offset:36864
  v_mfma_f32_16x16x32_bf16 v[36:39], a[68:71], a[128:131], v[36:39]
  v_mfma_f32_16x16x32_bf16 v[44:47], a[68:71], a[132:135], v[44:47]
  ds_read_b64_tr_b16 a[100:101], v199 offset:32768
  ds_read_b64_tr_b16 a[102:103], v199 offset:36864
  v_mfma_f32_16x16x32_bf16 v[32:35], a[72:75], a[136:139], v[32:35]
  v_mfma_f32_16x16x32_bf16 v[40:43], a[72:75], a[140:143], v[40:43]
  ds_read_b64_tr_b16 a[104:105], v198 offset:40960
  ds_read_b64_tr_b16 a[106:107], v198 offset:45056
  v_mfma_f32_16x16x32_bf16 v[36:39], a[76:79], a[136:139], v[36:39]
  v_mfma_f32_16x16x32_bf16 v[44:47], a[76:79], a[140:143], v[44:47]
  ds_read_b64_tr_b16 a[108:109], v199 offset:40960
  s_waitcnt lgkmcnt(5)
  ds_read_b64_tr_b16 a[110:111], v199 offset:45056
  v_mfma_f32_16x16x32_bf16 v[32:35], a[80:83], a[144:147], v[32:35]
  v_mfma_f32_16x16x32_bf16 v[40:43], a[80:83], a[148:151], v[40:43]
  ds_read_b64_tr_b16 a[112:113], v190 offset:32768
  ds_read_b64_tr_b16 a[114:115], v190 offset:36864
  v_mfma_f32_16x16x32_bf16 v[36:39], a[84:87], a[144:147], v[36:39]
  v_mfma_f32_16x16x32_bf16 v[44:47], a[84:87], a[148:151], v[44:47]
  ds_read_b64_tr_b16 a[116:117], v191 offset:32768
  ds_read_b64_tr_b16 a[118:119], v191 offset:36864
  v_mfma_f32_16x16x32_bf16 v[32:35], a[88:91], a[152:155], v[32:35]
  v_mfma_f32_16x16x32_bf16 v[40:43], a[88:91], a[156:159], v[40:43]
  ds_read_b64_tr_b16 a[120:121], v190 offset:40960
  ds_read_b64_tr_b16 a[122:123], v190 offset:45056
  v_mfma_f32_16x16x32_bf16 v[36:39], a[92:95], a[152:155], v[36:39]
  v_mfma_f32_16x16x32_bf16 v[44:47], a[92:95], a[156:159], v[44:47]
  ds_read_b64_tr_b16 a[124:125], v191 offset:40960
  ds_read_b64_tr_b16 a[126:127], v191 offset:45056
  v_mfma_f32_16x16x32_bf16 v[48:51], a[96:99], a[192:195], v[48:51]
  v_mfma_f32_16x16x32_bf16 v[56:59], a[96:99], a[196:199], v[56:59]
  ds_read_b64_tr_b16 a[64:65], v198 offset:0
  s_waitcnt lgkmcnt(5)
  ds_read_b64_tr_b16 a[66:67], v198 offset:4096
  v_mfma_f32_16x16x32_bf16 v[52:55], a[100:103], a[192:195], v[52:55]
  v_mfma_f32_16x16x32_bf16 v[60:63], a[100:103], a[196:199], v[60:63]
  ds_read_b64_tr_b16 a[68:69], v199 offset:0
  ds_read_b64_tr_b16 a[70:71], v199 offset:4096
  v_mfma_f32_16x16x32_bf16 v[48:51], a[104:107], a[200:203], v[48:51]
  v_mfma_f32_16x16x32_bf16 v[56:59], a[104:107], a[204:207], v[56:59]
  v_cvt_pk_bf16_f32 v80, v32, v33
  v_cvt_pk_bf16_f32 v81, v34, v35
  v_mfma_f32_16x16x32_bf16 v[52:55], a[108:111], a[200:203], v[52:55]
  ds_read_b64_tr_b16 a[72:73], v198 offset:8192
  ds_read_b64_tr_b16 a[74:75], v198 offset:12288
  v_mfma_f32_16x16x32_bf16 v[60:63], a[108:111], a[204:207], v[60:63]
  ds_read_b64_tr_b16 a[76:77], v199 offset:8192
  ds_read_b64_tr_b16 a[78:79], v199 offset:12288
  v_mfma_f32_16x16x32_bf16 v[48:51], a[112:115], a[208:211], v[48:51]
  v_mfma_f32_16x16x32_bf16 v[56:59], a[112:115], a[212:215], v[56:59]
  v_cvt_pk_bf16_f32 v82, v36, v37
  v_cvt_pk_bf16_f32 v83, v38, v39
  v_min_u32 v80, -2, v80
  v_mfma_f32_16x16x32_bf16 v[52:55], a[116:119], a[208:211], v[52:55]
  ds_read_b64_tr_b16 a[80:81], v190 offset:0
  ds_read_b64_tr_b16 a[82:83], v190 offset:4096
  v_mfma_f32_16x16x32_bf16 v[60:63], a[116:119], a[212:215], v[60:63]
  s_add_u32 s51, s74, 0
  buffer_store_dwordx4 v[80:83], v230, s[36:39], s51 offen offset:0 sc1
  v_cvt_pk_bf16_f32 v84, v40, v41
  v_cvt_pk_bf16_f32 v85, v42, v43
  s_waitcnt lgkmcnt(6)
  v_mfma_f32_16x16x32_bf16 v[48:51], a[120:123], a[216:219], v[48:51]
  ds_read_b64_tr_b16 a[84:85], v191 offset:0
  ds_read_b64_tr_b16 a[86:87], v191 offset:4096
  v_mfma_f32_16x16x32_bf16 v[56:59], a[120:123], a[220:223], v[56:59]
  v_cvt_pk_bf16_f32 v86, v44, v45
  v_cvt_pk_bf16_f32 v87, v46, v47
  v_min_u32 v84, -2, v84
  v_mfma_f32_16x16x32_bf16 v[52:55], a[124:127], a[216:219], v[52:55]
  buffer_store_dwordx4 v[84:87], v230, s[36:39], s51 offen offset:896 sc1
  v_mfma_f32_16x16x32_bf16 v[60:63], a[124:127], a[220:223], v[60:63]
  ds_read_b64_tr_b16 a[88:89], v190 offset:8192
  ds_read_b64_tr_b16 a[90:91], v190 offset:12288
  v_mfma_f32_16x16x32_bf16 v[48:51], a[64:67], a[224:227], v[48:51]
  ds_read_b64_tr_b16 a[92:93], v191 offset:8192
  ds_read_b64_tr_b16 a[94:95], v191 offset:12288
  v_mfma_f32_16x16x32_bf16 v[56:59], a[64:67], a[228:231], v[56:59]
  ds_read_b64_tr_b16 a[96:97], v206 offset:16384
  ds_read_b64_tr_b16 a[98:99], v206 offset:20480
  v_mfma_f32_16x16x32_bf16 v[52:55], a[68:71], a[224:227], v[52:55]
  v_mfma_f32_16x16x32_bf16 v[60:63], a[68:71], a[228:231], v[60:63]
  ds_read_b64_tr_b16 a[100:101], v207 offset:16384
  s_waitcnt lgkmcnt(7)
  ds_read_b64_tr_b16 a[102:103], v207 offset:20480
  v_mfma_f32_16x16x32_bf16 v[48:51], a[72:75], a[232:235], v[48:51]
  v_mfma_f32_16x16x32_bf16 v[56:59], a[72:75], a[236:239], v[56:59]
  ds_read_b64_tr_b16 a[104:105], v206 offset:24576
  ds_read_b64_tr_b16 a[106:107], v206 offset:28672
  v_mfma_f32_16x16x32_bf16 v[52:55], a[76:79], a[232:235], v[52:55]
  v_mfma_f32_16x16x32_bf16 v[60:63], a[76:79], a[236:239], v[60:63]
  ds_read_b64_tr_b16 a[108:109], v207 offset:24576
  ds_read_b64_tr_b16 a[110:111], v207 offset:28672
  v_mfma_f32_16x16x32_bf16 v[48:51], a[80:83], a[240:243], v[48:51]
  v_mfma_f32_16x16x32_bf16 v[56:59], a[80:83], a[244:247], v[56:59]
  ds_read_b64_tr_b16 a[112:113], v198 offset:49152
  ds_read_b64_tr_b16 a[114:115], v198 offset:53248
  v_mfma_f32_16x16x32_bf16 v[52:55], a[84:87], a[240:243], v[52:55]
  v_mfma_f32_16x16x32_bf16 v[60:63], a[84:87], a[244:247], v[60:63]
  ds_read_b64_tr_b16 a[116:117], v199 offset:49152
  s_waitcnt lgkmcnt(5)
  ds_read_b64_tr_b16 a[118:119], v199 offset:53248
  v_mfma_f32_16x16x32_bf16 v[48:51], a[88:91], a[248:251], v[48:51]
  v_mfma_f32_16x16x32_bf16 v[56:59], a[88:91], a[252:255], v[56:59]
  ds_read_b64_tr_b16 a[120:121], v198 offset:57344
  ds_read_b64_tr_b16 a[122:123], v198 offset:61440
  v_mfma_f32_16x16x32_bf16 v[52:55], a[92:95], a[248:251], v[52:55]
  v_mfma_f32_16x16x32_bf16 v[60:63], a[92:95], a[252:255], v[60:63]
  ds_read_b64_tr_b16 a[124:125], v199 offset:57344
  ds_read_b64_tr_b16 a[126:127], v199 offset:61440
  v_mfma_f32_16x16x32_bf16 v[48:51], a[96:99], a[0:3], v[48:51]
  v_mfma_f32_16x16x32_bf16 v[56:59], a[96:99], a[4:7], v[56:59]
  ds_read_b64_tr_b16 a[64:65], v190 offset:49152
  ds_read_b64_tr_b16 a[66:67], v190 offset:53248
  v_mfma_f32_16x16x32_bf16 v[52:55], a[100:103], a[0:3], v[52:55]
  v_mfma_f32_16x16x32_bf16 v[60:63], a[100:103], a[4:7], v[60:63]
  ds_read_b64_tr_b16 a[68:69], v191 offset:49152
  ds_read_b64_tr_b16 a[70:71], v191 offset:53248
  v_mfma_f32_16x16x32_bf16 v[48:51], a[104:107], a[8:11], v[48:51]
  v_mfma_f32_16x16x32_bf16 v[56:59], a[104:107], a[12:15], v[56:59]
  ds_read_b64_tr_b16 a[72:73], v190 offset:57344
  s_waitcnt lgkmcnt(5)
  ds_read_b64_tr_b16 a[74:75], v190 offset:61440
  v_mfma_f32_16x16x32_bf16 v[52:55], a[108:111], a[8:11], v[52:55]
  v_mfma_f32_16x16x32_bf16 v[60:63], a[108:111], a[12:15], v[60:63]
  ds_read_b64_tr_b16 a[76:77], v191 offset:57344
  ds_read_b64_tr_b16 a[78:79], v191 offset:61440
  v_mfma_f32_16x16x32_bf16 v[48:51], a[112:115], a[16:19], v[48:51]
  v_mfma_f32_16x16x32_bf16 v[56:59], a[112:115], a[20:23], v[56:59]
  ds_read_b64_tr_b16 a[80:81], v206 offset:0
  ds_read_b64_tr_b16 a[82:83], v206 offset:4096
  v_mfma_f32_16x16x32_bf16 v[52:55], a[116:119], a[16:19], v[52:55]
  v_mfma_f32_16x16x32_bf16 v[60:63], a[116:119], a[20:23], v[60:63]
  ds_read_b64_tr_b16 a[84:85], v207 offset:0
  ds_read_b64_tr_b16 a[86:87], v207 offset:4096
  v_mfma_f32_16x16x32_bf16 v[48:51], a[120:123], a[24:27], v[48:51]
  v_mfma_f32_16x16x32_bf16 v[56:59], a[120:123], a[28:31], v[56:59]
  ds_read_b64_tr_b16 a[88:89], v206 offset:8192
  ds_read_b64_tr_b16 a[90:91], v206 offset:12288
  v_mfma_f32_16x16x32_bf16 v[52:55], a[124:127], a[24:27], v[52:55]
  v_mfma_f32_16x16x32_bf16 v[60:63], a[124:127], a[28:31], v[60:63]
  ds_read_b64_tr_b16 a[92:93], v207 offset:8192
  s_waitcnt lgkmcnt(5)
  ds_read_b64_tr_b16 a[94:95], v207 offset:12288
  v_mfma_f32_16x16x32_bf16 v[48:51], a[64:67], a[32:35], v[48:51]
  v_mfma_f32_16x16x32_bf16 v[56:59], a[64:67], a[36:39], v[56:59]
  ds_read_b64_tr_b16 a[96:97], v198 offset:16384
  ds_read_b64_tr_b16 a[98:99], v198 offset:20480
  v_mfma_f32_16x16x32_bf16 v[52:55], a[68:71], a[32:35], v[52:55]
  v_mfma_f32_16x16x32_bf16 v[60:63], a[68:71], a[36:39], v[60:63]
  s_add_u32 s51, s75, 0
  ds_read_b64_tr_b16 a[100:101], v199 offset:16384
  v_mfma_f32_16x16x32_bf16 v[48:51], a[72:75], a[40:43], v[48:51]
  ds_read_b64_tr_b16 a[102:103], v199 offset:20480
  v_mfma_f32_16x16x32_bf16 v[56:59], a[72:75], a[44:47], v[56:59]
  ds_read_b64_tr_b16 a[104:105], v198 offset:24576
  ds_read_b64_tr_b16 a[106:107], v198 offset:28672
  v_mfma_f32_16x16x32_bf16 v[52:55], a[76:79], a[40:43], v[52:55]
  buffer_load_dwordx4 v[128:131], v230, s[36:39], s51 offen offset:0 sc1
  v_mfma_f32_16x16x32_bf16 v[60:63], a[76:79], a[44:47], v[60:63]
  ds_read_b64_tr_b16 a[108:109], v199 offset:24576
  ds_read_b64_tr_b16 a[110:111], v199 offset:28672
  v_mfma_f32_16x16x32_bf16 v[48:51], a[80:83], a[48:51], v[48:51]
  v_mfma_f32_16x16x32_bf16 v[56:59], a[80:83], a[52:55], v[56:59]
  ds_read_b64_tr_b16 a[112:113], v190 offset:16384
  s_waitcnt lgkmcnt(6)
  ds_read_b64_tr_b16 a[114:115], v190 offset:20480
  v_mfma_f32_16x16x32_bf16 v[52:55], a[84:87], a[48:51], v[52:55]
  buffer_load_dwordx4 v[132:135], v230, s[36:39], s51 offen offset:896 sc1
  v_mfma_f32_16x16x32_bf16 v[60:63], a[84:87], a[52:55], v[60:63]
  s_add_u32 s51, s76, 0
  ds_read_b64_tr_b16 a[116:117], v191 offset:16384
  v_mfma_f32_16x16x32_bf16 v[48:51], a[88:91], a[56:59], v[48:51]
  ds_read_b64_tr_b16 a[118:119], v191 offset:20480
  v_mfma_f32_16x16x32_bf16 v[56:59], a[88:91], a[60:63], v[56:59]
  ds_read_b64_tr_b16 a[120:121], v190 offset:24576
  ds_read_b64_tr_b16 a[122:123], v190 offset:28672
  v_mfma_f32_16x16x32_bf16 v[52:55], a[92:95], a[56:59], v[52:55]
  buffer_load_dwordx4 v[136:139], v230, s[36:39], s51 offen offset:0 sc1
  v_mfma_f32_16x16x32_bf16 v[60:63], a[92:95], a[60:63], v[60:63]
  ds_read_b64_tr_b16 a[124:125], v191 offset:24576
  ds_read_b64_tr_b16 a[126:127], v191 offset:28672
  v_mfma_f32_16x16x32_bf16 v[48:51], a[96:99], a[128:131], v[48:51]
  v_mfma_f32_16x16x32_bf16 v[56:59], a[96:99], a[132:135], v[56:59]
  s_waitcnt lgkmcnt(5)
  v_mfma_f32_16x16x32_bf16 v[52:55], a[100:103], a[128:131], v[52:55]
  v_mfma_f32_16x16x32_bf16 v[60:63], a[100:103], a[132:135], v[60:63]
  buffer_load_dwordx4 v[140:143], v230, s[36:39], s51 offen offset:896 sc1
  v_mfma_f32_16x16x32_bf16 v[48:51], a[104:107], a[136:139], v[48:51]
  v_mfma_f32_16x16x32_bf16 v[56:59], a[104:107], a[140:143], v[56:59]
  s_add_u32 s51, s77, 0
  v_mfma_f32_16x16x32_bf16 v[52:55], a[108:111], a[136:139], v[52:55]
  v_mfma_f32_16x16x32_bf16 v[60:63], a[108:111], a[140:143], v[60:63]
  buffer_load_dwordx4 v[144:147], v230, s[36:39], s51 offen offset:0 sc1
  v_mfma_f32_16x16x32_bf16 v[48:51], a[112:115], a[144:147], v[48:51]
  v_mfma_f32_16x16x32_bf16 v[56:59], a[112:115], a[148:151], v[56:59]
  s_waitcnt lgkmcnt(0)
  v_mfma_f32_16x16x32_bf16 v[52:55], a[116:119], a[144:147], v[52:55]
  v_mfma_f32_16x16x32_bf16 v[60:63], a[116:119], a[148:151], v[60:63]
  buffer_load_dwordx4 v[148:151], v230, s[36:39], s51 offen offset:896 sc1
  v_mfma_f32_16x16x32_bf16 v[48:51], a[120:123], a[152:155], v[48:51]
  v_mfma_f32_16x16x32_bf16 v[56:59], a[120:123], a[156:159], v[56:59]
  v_mfma_f32_16x16x32_bf16 v[52:55], a[124:127], a[152:155], v[52:55]
  v_mfma_f32_16x16x32_bf16 v[60:63], a[124:127], a[156:159], v[60:63]
  s_mov_b32 s62, 0x40000
  s_branch L_pchk
L_ppoll:
  s_add_u32 s51, s75, 0
  s_waitcnt vmcnt(5)
  buffer_load_dwordx4 v[128:131], v230, s[36:39], s51 offen offset:0 sc1
  s_waitcnt vmcnt(5)
  buffer_load_dwordx4 v[132:135], v230, s[36:39], s51 offen offset:896 sc1
  s_add_u32 s51, s76, 0
  s_waitcnt vmcnt(5)
  buffer_load_dwordx4 v[136:139], v230, s[36:39], s51 offen offset:0 sc1
  s_waitcnt vmcnt(5)
  buffer_load_dwordx4 v[140:143], v230, s[36:39], s51 offen offset:896 sc1
  s_add_u32 s51, s77, 0
  s_waitcnt vmcnt(5)
  buffer_load_dwordx4 v[144:147], v230, s[36:39], s51 offen offset:0 sc1
  s_waitcnt vmcnt(5)
  buffer_load_dwordx4 v[148:151], v230, s[36:39], s51 offen offset:896 sc1
L_pchk:
  s_sub_u32 s62, s62, 1
  s_waitcnt vmcnt(0)
  v_max3_u32 v248, v128, v132, v136
  v_max3_u32 v248, v248, v140, v144
  v_max_u32 v248, v248, v148
  v_cmp_eq_u32 vcc, -1, v248
  s_cmp_eq_u32 s62, 0
  s_cbranch_scc1 L_pdone
  s_cbranch_vccnz L_ppoll
L_pdone:
  v_lshlrev_b32 v248, 16, v128
  v_and_b32 v249, 0xffff0000, v128
  v_pk_add_f32 v[48:49], v[48:49], v[248:249]
  v_lshlrev_b32 v250, 16, v129
  v_and_b32 v251, 0xffff0000, v129
  v_pk_add_f32 v[50:51], v[50:51], v[250:251]
  v_lshlrev_b32 v248, 16, v130
  v_and_b32 v249, 0xffff0000, v130
  v_pk_add_f32 v[52:53], v[52:53], v[248:249]
  v_lshlrev_b32 v250, 16, v131
  v_and_b32 v251, 0xffff0000, v131
  v_pk_add_f32 v[54:55], v[54:55], v[250:251]
  v_lshlrev_b32 v248, 16, v132
  v_and_b32 v249, 0xffff0000, v132
  v_pk_add_f32 v[56:57], v[56:57], v[248:249]
  v_lshlrev_b32 v250, 16, v133
  v_and_b32 v251, 0xffff0000, v133
  v_pk_add_f32 v[58:59], v[58:59], v[250:251]
  v_lshlrev_b32 v248, 16, v134
  v_and_b32 v249, 0xffff0000, v134
  v_pk_add_f32 v[60:61], v[60:61], v[248:249]
  v_lshlrev_b32 v250, 16, v135
  v_and_b32 v251, 0xffff0000, v135
  v_pk_add_f32 v[62:63], v[62:63], v[250:251]
  v_lshlrev_b32 v248, 16, v136
  v_and_b32 v249, 0xffff0000, v136
  v_pk_add_f32 v[48:49], v[48:49], v[248:249]
  v_lshlrev_b32 v250, 16, v137
  v_and_b32 v251, 0xffff0000, v137
  v_pk_add_f32 v[50:51], v[50:51], v[250:251]
  v_lshlrev_b32 v248, 16, v138
  v_and_b32 v249, 0xffff0000, v138
  v_pk_add_f32 v[52:53], v[52:53], v[248:249]
  v_lshlrev_b32 v250, 16, v139
  v_and_b32 v251, 0xffff0000, v139
  v_pk_add_f32 v[54:55], v[54:55], v[250:251]
  v_lshlrev_b32 v248, 16, v140
  v_and_b32 v249, 0xffff0000, v140
  v_pk_add_f32 v[56:57], v[56:57], v[248:249]
  v_lshlrev_b32 v250, 16, v141
  v_and_b32 v251, 0xffff0000, v141
  v_pk_add_f32 v[58:59], v[58:59], v[250:251]
  v_lshlrev_b32 v248, 16, v142
  v_and_b32 v249, 0xffff0000, v142
  v_pk_add_f32 v[60:61], v[60:61], v[248:249]
  v_lshlrev_b32 v250, 16, v143
  v_and_b32 v251, 0xffff0000, v143
  v_pk_add_f32 v[62:63], v[62:63], v[250:251]
  v_lshlrev_b32 v248, 16, v144
  v_and_b32 v249, 0xffff0000, v144
  v_pk_add_f32 v[48:49], v[48:49], v[248:249]
  v_lshlrev_b32 v250, 16, v145
  v_and_b32 v251, 0xffff0000, v145
  v_pk_add_f32 v[50:51], v[50:51], v[250:251]
  v_lshlrev_b32 v248, 16, v146
  v_and_b32 v249, 0xffff0000, v146
  v_pk_add_f32 v[52:53], v[52:53], v[248:249]
  v_lshlrev_b32 v250, 16, v147
  v_and_b32 v251, 0xffff0000, v147
  v_pk_add_f32 v[54:55], v[54:55], v[250:251]
  v_lshlrev_b32 v248, 16, v148
  v_and_b32 v249, 0xffff0000, v148
  v_pk_add_f32 v[56:57], v[56:57], v[248:249]
  v_lshlrev_b32 v250, 16, v149
  v_and_b32 v251, 0xffff0000, v149
  v_pk_add_f32 v[58:59], v[58:59], v[250:251]
  v_lshlrev_b32 v248, 16, v150
  v_and_b32 v249, 0xffff0000, v150
  v_pk_add_f32 v[60:61], v[60:61], v[248:249]
  v_lshlrev_b32 v250, 16, v151
  v_and_b32 v251, 0xffff0000, v151
  v_pk_add_f32 v[62:63], v[62:63], v[250:251]
  v_cvt_pk_bf16_f32 v160, v48, v49
  v_cvt_pk_bf16_f32 v161, v50, v51
  v_cvt_pk_bf16_f32 v162, v52, v53
  v_cvt_pk_bf16_f32 v163, v54, v55
  v_cvt_pk_bf16_f32 v164, v56, v57
  v_cvt_pk_bf16_f32 v165, v58, v59
  v_cvt_pk_bf16_f32 v166, v60, v61
  v_cvt_pk_bf16_f32 v167, v62, v63
  s_add_u32 s49, s78, 14336
  v_permlane16_swap_b32 v160, v162
  v_permlane16_swap_b32 v161, v163
  v_permlane16_swap_b32 v164, v166
  v_permlane16_swap_b32 v165, v167
  buffer_store_dwordx4 v[160:163], v231, s[28:31], s78 offen
  buffer_store_dwordx4 v[164:167], v231, s[28:31], s49 offen
L_end:
  s_endpgm
L_nors_39_r:
  s_call_b64 s[60:61], L_rescale_011
  s_branch L_nors_39
L_nors_40_r:
  s_call_b64 s[60:61], L_rescale_001
  s_branch L_nors_40
L_nors_41_r:
  s_call_b64 s[60:61], L_rescale_011
  s_branch L_nors_41
L_nors_42_r:
  s_call_b64 s[60:61], L_rescale_001
  s_branch L_nors_42
L_nors_43_r:
  s_call_b64 s[60:61], L_rescale_011
  s_branch L_nors_43
L_nors_44_r:
  s_call_b64 s[60:61], L_rescale_001
  s_branch L_nors_44
L_nors_45_r:
  s_call_b64 s[60:61], L_rescale_011
  s_branch L_nors_45
L_nors_46_r:
  s_call_b64 s[60:61], L_rescale_001
  s_branch L_nors_46
L_nors_47_r:
  s_call_b64 s[60:61], L_rescale_011
  s_branch L_nors_47
L_nors_48_r:
  s_call_b64 s[60:61], L_rescale_001
  s_branch L_nors_48
L_nors_49_r:
  s_call_b64 s[60:61], L_rescale_011
  s_branch L_nors_49
L_nors_50_r:
  s_call_b64 s[60:61], L_rescale_001
  s_branch L_nors_50
L_nors_51_r:
  s_call_b64 s[60:61], L_rescale_011
  s_branch L_nors_51
L_nors_52_r:
  s_call_b64 s[60:61], L_rescale_001
  s_branch L_nors_52
L_nors_53_r:
  s_call_b64 s[60:61], L_rescale_010
  s_branch L_nors_53
L_nors_54_r:
  s_call_b64 s[60:61], L_rescale_111
  s_branch L_nors_54
L_nors_55_r:
  s_call_b64 s[60:61], L_rescale_101
  s_branch L_nors_55
L_nors_56_r:
  s_call_b64 s[60:61], L_rescale_111
  s_branch L_nors_56
L_nors_57_r:
  s_call_b64 s[60:61], L_rescale_101
  s_branch L_nors_57
L_nors_58_r:
  s_call_b64 s[60:61], L_rescale_111
  s_branch L_nors_58
L_nors_59_r:
  s_call_b64 s[60:61], L_rescale_101
  s_branch L_nors_59
L_nors_60_r:
  s_call_b64 s[60:61], L_rescale_111
  s_branch L_nors_60
L_nors_61_r:
  s_call_b64 s[60:61], L_rescale_101
  s_branch L_nors_61
L_nors_62_r:
  s_call_b64 s[60:61], L_rescale_111
  s_branch L_nors_62
L_nors_63_r:
  s_call_b64 s[60:61], L_rescale_101
  s_branch L_nors_63
L_nors_64_r:
  s_call_b64 s[60:61], L_rescale_111
  s_branch L_nors_64
L_nors_65_r:
  s_call_b64 s[60:61], L_rescale_101
  s_branch L_nors_65
L_nors_66_r:
  s_call_b64 s[60:61], L_rescale_111
  s_branch L_nors_66
L_nors_67_r:
  s_call_b64 s[60:61], L_rescale_101
  s_branch L_nors_67
L_nors_68_r:
  s_call_b64 s[60:61], L_rescale_110
  s_branch L_nors_68
L_rescale_001:
  s_nop 15
  v_max3_f32 v238, v128, v129, 0
  v_max3_f32 v238, v238, v130, v131
  v_max3_f32 v238, v238, v132, v133
  v_max3_f32 v238, v238, v134, v135
  v_max3_f32 v239, v136, v137, 0
  v_max3_f32 v239, v239, v138, v139
  v_max3_f32 v239, v239, v140, v141
  v_max3_f32 v239, v239, v142, v143
  s_nop 1
  v_mov_b32 v240, v238
  s_nop 1
  v_mov_b32 v241, v239
  s_nop 1
  v_permlane32_swap_b32 v238, v240
  s_nop 1
  v_permlane32_swap_b32 v239, v241
  s_nop 1
  v_max_f32 v238, v238, v240
  s_nop 1
  v_max_f32 v239, v239, v241
  s_nop 1
  v_mov_b32 v240, v238
  s_nop 1
  v_mov_b32 v241, v239
  s_nop 1
  v_permlane16_swap_b32 v238, v240
  s_nop 1
  v_permlane16_swap_b32 v239, v241
  s_nop 1
  v_max_f32 v238, v238, v240
  s_nop 1
  v_max_f32 v239, v239, v241
  v_exp_f32 v240, -v238
  v_exp_f32 v241, -v239
  v_sub_f32 v176, v176, v238
  v_sub_f32 v177, v177, v238
  v_sub_f32 v178, v178, v238
  v_sub_f32 v179, v179, v238
  v_sub_f32 v180, v180, v239
  v_sub_f32 v181, v181, v239
  v_sub_f32 v182, v182, v239
  v_sub_f32 v183, v183, v239
  v_sub_f32 v128, v128, v238
  v_sub_f32 v129, v129, v238
  v_sub_f32 v130, v130, v238
  v_sub_f32 v131, v131, v238
  v_sub_f32 v132, v132, v238
  v_sub_f32 v133, v133, v238
  v_sub_f32 v134, v134, v238
  v_sub_f32 v135, v135, v238
  v_sub_f32 v136, v136, v239
  v_sub_f32 v137, v137, v239
  v_sub_f32 v138, v138, v239
  v_sub_f32 v139, v139, v239
  v_sub_f32 v140, v140, v239
  v_sub_f32 v141, v141, v239
  v_sub_f32 v142, v142, v239
  v_sub_f32 v143, v143, v239
  v_sub_f32 v144, v144, v238
  v_sub_f32 v145, v145, v238
  v_sub_f32 v146, v146, v238
  v_sub_f32 v147, v147, v238
  v_sub_f32 v148, v148, v238
  v_sub_f32 v149, v149, v238
  v_sub_f32 v150, v150, v238
  v_sub_f32 v151, v151, v238
  v_sub_f32 v152, v152, v239
  v_sub_f32 v153, v153, v239
  v_sub_f32 v154, v154, v239
  v_sub_f32 v155, v155, v239
  v_sub_f32 v156, v156, v239
  v_sub_f32 v157, v157, v239
  v_sub_f32 v158, v158, v239
  v_sub_f32 v159, v159, v239
  v_mul_f32 v0, v0, v240
  v_mul_f32 v1, v1, v240
  v_mul_f32 v2, v2, v240
  v_mul_f32 v3, v3, v240
  v_mul_f32 v4, v4, v240
  v_mul_f32 v5, v5, v240
  v_mul_f32 v6, v6, v240
  v_mul_f32 v7, v7, v240
  v_mul_f32 v8, v8, v241
  v_mul_f32 v9, v9, v241
  v_mul_f32 v10, v10, v241
  v_mul_f32 v11, v11, v241
  v_mul_f32 v12, v12, v241
  v_mul_f32 v13, v13, v241
  v_mul_f32 v14, v14, v241
  v_mul_f32 v15, v15, v241
  v_mul_f32 v16, v16, v240
  v_mul_f32 v17, v17, v240
  v_mul_f32 v18, v18, v240
  v_mul_f32 v19, v19, v240
  v_mul_f32 v20, v20, v240
  v_mul_f32 v21, v21, v240
  v_mul_f32 v22, v22, v240
  v_mul_f32 v23, v23, v240
  v_mul_f32 v24, v24, v241
  v_mul_f32 v25, v25, v241
  v_mul_f32 v26, v26, v241
  v_mul_f32 v27, v27, v241
  v_mul_f32 v28, v28, v241
  v_mul_f32 v29, v29, v241
  v_mul_f32 v30, v30, v241
  v_mul_f32 v31, v31, v241
  v_mul_f32 v32, v32, v240
  v_mul_f32 v33, v33, v240
  v_mul_f32 v34, v34, v240
  v_mul_f32 v35, v35, v240
  v_mul_f32 v36, v36, v240
  v_mul_f32 v37, v37, v240
  v_mul_f32 v38, v38, v240
  v_mul_f32 v39, v39, v240
  v_mul_f32 v40, v40, v241
  v_mul_f32 v41, v41, v241
  v_mul_f32 v42, v42, v241
  v_mul_f32 v43, v43, v241
  v_mul_f32 v44, v44, v241
  v_mul_f32 v45, v45, v241
  v_mul_f32 v46, v46, v241
  v_mul_f32 v47, v47, v241
  v_mul_f32 v48, v48, v240
  v_mul_f32 v49, v49, v240
  v_mul_f32 v50, v50, v240
  v_mul_f32 v51, v51, v240
  v_mul_f32 v52, v52, v240
  v_mul_f32 v53, v53, v240
  v_mul_f32 v54, v54, v240
  v_mul_f32 v55, v55, v240
  v_mul_f32 v56, v56, v241
  v_mul_f32 v57, v57, v241
  v_mul_f32 v58, v58, v241
  v_mul_f32 v59, v59, v241
  v_mul_f32 v60, v60, v241
  v_mul_f32 v61, v61, v241
  v_mul_f32 v62, v62, v241
  v_mul_f32 v63, v63, v241
  v_mul_f32 v234, v234, v240
  v_mov_b32 v236, 0
  v_mul_f32 v235, v235, v241
  v_mov_b32 v237, 0
  v_exp_f32 v222, v128
  v_exp_f32 v223, v129
  s_nop 0
  v_cvt_pk_bf16_f32 v160, v222, v223
  v_add_f32 v236, v236, v222
  v_add_f32 v236, v236, v223
  v_exp_f32 v222, v130
  v_exp_f32 v223, v131
  s_nop 0
  v_cvt_pk_bf16_f32 v161, v222, v223
  v_add_f32 v236, v236, v222
  v_add_f32 v236, v236, v223
  v_exp_f32 v222, v132
  v_exp_f32 v223, v133
  s_nop 0
  v_cvt_pk_bf16_f32 v162, v222, v223
  v_add_f32 v236, v236, v222
  v_add_f32 v236, v236, v223
  v_exp_f32 v222, v134
  v_exp_f32 v223, v135
  s_nop 0
  v_cvt_pk_bf16_f32 v163, v222, v223
  v_add_f32 v236, v236, v222
  v_add_f32 v236, v236, v223
  v_exp_f32 v222, v136
  v_exp_f32 v223, v137
  s_nop 0
  v_cvt_pk_bf16_f32 v164, v222, v223
  v_add_f32 v237, v237, v222
  v_add_f32 v237, v237, v223
  v_exp_f32 v222, v138
  v_exp_f32 v223, v139
  s_nop 0
  v_cvt_pk_bf16_f32 v165, v222, v223
  v_add_f32 v237, v237, v222
  v_add_f32 v237, v237, v223
  v_exp_f32 v222, v140
  v_exp_f32 v223, v141
  s_nop 0
  v_cvt_pk_bf16_f32 v166, v222, v223
  v_add_f32 v237, v237, v222
  v_add_f32 v237, v237, v223
  v_exp_f32 v222, v142
  v_exp_f32 v223, v143
  s_nop 0
  v_cvt_pk_bf16_f32 v167, v222, v223
  v_add_f32 v237, v237, v222
  v_add_f32 v237, v237, v223
  s_nop 3
  s_setpc_b64 s[60:61]
L_rescale_010:
  s_nop 15
  v_max3_f32 v238, v144, v145, 0
  v_max3_f32 v238, v238, v146, v147
  v_max3_f32 v238, v238, v148, v149
  v_max3_f32 v238, v238, v150, v151
  v_max3_f32 v239, v152, v153, 0
  v_max3_f32 v239, v239, v154, v155
  v_max3_f32 v239, v239, v156, v157
  v_max3_f32 v239, v239, v158, v159
  s_nop 1
  v_mov_b32 v240, v238
  s_nop 1
  v_mov_b32 v241, v239
  s_nop 1
  v_permlane32_swap_b32 v238, v240
  s_nop 1
  v_permlane32_swap_b32 v239, v241
  s_nop 1
  v_max_f32 v238, v238, v240
  s_nop 1
  v_max_f32 v239, v239, v241
  s_nop 1
  v_mov_b32 v240, v238
  s_nop 1
  v_mov_b32 v241, v239
  s_nop 1
  v_permlane16_swap_b32 v238, v240
  s_nop 1
  v_permlane16_swap_b32 v239, v241
  s_nop 1
  v_max_f32 v238, v238, v240
  s_nop 1
  v_max_f32 v239, v239, v241
  v_exp_f32 v240, -v238
  v_exp_f32 v241, -v239
  v_sub_f32 v176, v176, v238
  v_sub_f32 v177, v177, v238
  v_sub_f32 v178, v178, v238
  v_sub_f32 v179, v179, v238
  v_sub_f32 v180, v180, v239
  v_sub_f32 v181, v181, v239
  v_sub_f32 v182, v182, v239
  v_sub_f32 v183, v183, v239
  v_sub_f32 v144, v144, v238
  v_sub_f32 v145, v145, v238
  v_sub_f32 v146, v146, v238
  v_sub_f32 v147, v147, v238
  v_sub_f32 v148, v148, v238
  v_sub_f32 v149, v149, v238
  v_sub_f32 v150, v150, v238
  v_sub_f32 v151, v151, v238
  v_sub_f32 v152, v152, v239
  v_sub_f32 v153, v153, v239
  v_sub_f32 v154, v154, v239
  v_sub_f32 v155, v155, v239
  v_sub_f32 v156, v156, v239
  v_sub_f32 v157, v157, v239
  v_sub_f32 v158, v158, v239
  v_sub_f32 v159, v159, v239
  v_mul_f32 v0, v0, v240
  v_mul_f32 v1, v1, v240
  v_mul_f32 v2, v2, v240
  v_mul_f32 v3, v3, v240
  v_mul_f32 v4, v4, v240
  v_mul_f32 v5, v5, v240
  v_mul_f32 v6, v6, v240
  v_mul_f32 v7, v7, v240
  v_mul_f32 v8, v8, v241
  v_mul_f32 v9, v9, v241
  v_mul_f32 v10, v10, v241
  v_mul_f32 v11, v11, v241
  v_mul_f32 v12, v12, v241
  v_mul_f32 v13, v13, v241
  v_mul_f32 v14, v14, v241
  v_mul_f32 v15, v15, v241
  v_mul_f32 v16, v16, v240
  v_mul_f32 v17, v17, v240
  v_mul_f32 v18, v18, v240
  v_mul_f32 v19, v19, v240
  v_mul_f32 v20, v20, v240
  v_mul_f32 v21, v21, v240
  v_mul_f32 v22, v22, v240
  v_mul_f32 v23, v23, v240
  v_mul_f32 v24, v24, v241
  v_mul_f32 v25, v25, v241
  v_mul_f32 v26, v26, v241
  v_mul_f32 v27, v27, v241
  v_mul_f32 v28, v28, v241
  v_mul_f32 v29, v29, v241
  v_mul_f32 v30, v30, v241
  v_mul_f32 v31, v31, v241
  v_mul_f32 v32, v32, v240
  v_mul_f32 v33, v33, v240
  v_mul_f32 v34, v34, v240
  v_mul_f32 v35, v35, v240
  v_mul_f32 v36, v36, v240
  v_mul_f32 v37, v37, v240
  v_mul_f32 v38, v38, v240
  v_mul_f32 v39, v39, v240
  v_mul_f32 v40, v40, v241
  v_mul_f32 v41, v41, v241
  v_mul_f32 v42, v42, v241
  v_mul_f32 v43, v43, v241
  v_mul_f32 v44, v44, v241
  v_mul_f32 v45, v45, v241
  v_mul_f32 v46, v46, v241
  v_mul_f32 v47, v47, v241
  v_mul_f32 v48, v48, v240
  v_mul_f32 v49, v49, v240
  v_mul_f32 v50, v50, v240
  v_mul_f32 v51, v51, v240
  v_mul_f32 v52, v52, v240
  v_mul_f32 v53, v53, v240
  v_mul_f32 v54, v54, v240
  v_mul_f32 v55, v55, v240
  v_mul_f32 v56, v56, v241
  v_mul_f32 v57, v57, v241
  v_mul_f32 v58, v58, v241
  v_mul_f32 v59, v59, v241
  v_mul_f32 v60, v60, v241
  v_mul_f32 v61, v61, v241
  v_mul_f32 v62, v62, v241
  v_mul_f32 v63, v63, v241
  v_mul_f32 v234, v234, v240
  v_mov_b32 v236, 0
  v_mul_f32 v235, v235, v241
  v_mov_b32 v237, 0
  v_exp_f32 v222, v144
  v_exp_f32 v223, v145
  s_nop 0
  v_cvt_pk_bf16_f32 v168, v222, v223
  v_add_f32 v236, v236, v222
  v_add_f32 v236, v236, v223
  v_exp_f32 v222, v146
  v_exp_f32 v223, v147
  s_nop 0
  v_cvt_pk_bf16_f32 v169, v222, v223
  v_add_f32 v236, v236, v222
  v_add_f32 v236, v236, v223
  v_exp_f32 v222, v148
  v_exp_f32 v223, v149
  s_nop 0
  v_cvt_pk_bf16_f32 v170, v222, v223
  v_add_f32 v236, v236, v222
  v_add_f32 v236, v236, v223
  v_exp_f32 v222, v150
  v_exp_f32 v223, v151
  s_nop 0
  v_cvt_pk_bf16_f32 v171, v222, v223
  v_add_f32 v236, v236, v222
  v_add_f32 v236, v236, v223
  v_exp_f32 v222, v152
  v_exp_f32 v223, v153
  s_nop 0
  v_cvt_pk_bf16_f32 v172, v222, v223
  v_add_f32 v237, v237, v222
  v_add_f32 v237, v237, v223
  v_exp_f32 v222, v154
  v_exp_f32 v223, v155
  s_nop 0
  v_cvt_pk_bf16_f32 v173, v222, v223
  v_add_f32 v237, v237, v222
  v_add_f32 v237, v237, v223
  v_exp_f32 v222, v156
  v_exp_f32 v223, v157
  s_nop 0
  v_cvt_pk_bf16_f32 v174, v222, v223
  v_add_f32 v237, v237, v222
  v_add_f32 v237, v237, v223
  v_exp_f32 v222, v158
  v_exp_f32 v223, v159
  s_nop 0
  v_cvt_pk_bf16_f32 v175, v222, v223
  v_add_f32 v237, v237, v222
  v_add_f32 v237, v237, v223
  s_nop 3
  s_setpc_b64 s[60:61]
L_rescale_011:
  s_nop 15
  v_max3_f32 v238, v144, v145, 0
  v_max3_f32 v238, v238, v146, v147
  v_max3_f32 v238, v238, v148, v149
  v_max3_f32 v238, v238, v150, v151
  v_max3_f32 v239, v152, v153, 0
  v_max3_f32 v239, v239, v154, v155
  v_max3_f32 v239, v239, v156, v157
  v_max3_f32 v239, v239, v158, v159
  s_nop 1
  v_mov_b32 v240, v238
  s_nop 1
  v_mov_b32 v241, v239
  s_nop 1
  v_permlane32_swap_b32 v238, v240
  s_nop 1
  v_permlane32_swap_b32 v239, v241
  s_nop 1
  v_max_f32 v238, v238, v240
  s_nop 1
  v_max_f32 v239, v239, v241
  s_nop 1
  v_mov_b32 v240, v238
  s_nop 1
  v_mov_b32 v241, v239
  s_nop 1
  v_permlane16_swap_b32 v238, v240
  s_nop 1
  v_permlane16_swap_b32 v239, v241
  s_nop 1
  v_max_f32 v238, v238, v240
  s_nop 1
  v_max_f32 v239, v239, v241
  v_exp_f32 v240, -v238
  v_exp_f32 v241, -v239
  v_sub_f32 v176, v176, v238
  v_sub_f32 v177, v177, v238
  v_sub_f32 v178, v178, v238
  v_sub_f32 v179, v179, v238
  v_sub_f32 v180, v180, v239
  v_sub_f32 v181, v181, v239
  v_sub_f32 v182, v182, v239
  v_sub_f32 v183, v183, v239
  v_sub_f32 v128, v128, v238
  v_sub_f32 v129, v129, v238
  v_sub_f32 v130, v130, v238
  v_sub_f32 v131, v131, v238
  v_sub_f32 v132, v132, v238
  v_sub_f32 v133, v133, v238
  v_sub_f32 v134, v134, v238
  v_sub_f32 v135, v135, v238
  v_sub_f32 v136, v136, v239
  v_sub_f32 v137, v137, v239
  v_sub_f32 v138, v138, v239
  v_sub_f32 v139, v139, v239
  v_sub_f32 v140, v140, v239
  v_sub_f32 v141, v141, v239
  v_sub_f32 v142, v142, v239
  v_sub_f32 v143, v143, v239
  v_sub_f32 v144, v144, v238
  v_sub_f32 v145, v145, v238
  v_sub_f32 v146, v146, v238
  v_sub_f32 v147, v147, v238
  v_sub_f32 v148, v148, v238
  v_sub_f32 v149, v149, v238
  v_sub_f32 v150, v150, v238
  v_sub_f32 v151, v151, v238
  v_sub_f32 v152, v152, v239
  v_sub_f32 v153, v153, v239
  v_sub_f32 v154, v154, v239
  v_sub_f32 v155, v155, v239
  v_sub_f32 v156, v156, v239
  v_sub_f32 v157, v157, v239
  v_sub_f32 v158, v158, v239
  v_sub_f32 v159, v159, v239
  v_mul_f32 v0, v0, v240
  v_mul_f32 v1, v1, v240
  v_mul_f32 v2, v2, v240
  v_mul_f32 v3, v3, v240
  v_mul_f32 v4, v4, v240
  v_mul_f32 v5, v5, v240
  v_mul_f32 v6, v6, v240
  v_mul_f32 v7, v7, v240
  v_mul_f32 v8, v8, v241
  v_mul_f32 v9, v9, v241
  v_mul_f32 v10, v10, v241
  v_mul_f32 v11, v11, v241
  v_mul_f32 v12, v12, v241
  v_mul_f32 v13, v13, v241
  v_mul_f32 v14, v14, v241
  v_mul_f32 v15, v15, v241
  v_mul_f32 v16, v16, v240
  v_mul_f32 v17, v17, v240
  v_mul_f32 v18, v18, v240
  v_mul_f32 v19, v19, v240
  v_mul_f32 v20, v20, v240
  v_mul_f32 v21, v21, v240
  v_mul_f32 v22, v22, v240
  v_mul_f32 v23, v23, v240
  v_mul_f32 v24, v24, v241
  v_mul_f32 v25, v25, v241
  v_mul_f32 v26, v26, v241
  v_mul_f32 v27, v27, v241
  v_mul_f32 v28, v28, v241
  v_mul_f32 v29, v29, v241
  v_mul_f32 v30, v30, v241
  v_mul_f32 v31, v31, v241
  v_mul_f32 v32, v32, v240
  v_mul_f32 v33, v33, v240
  v_mul_f32 v34, v34, v240
  v_mul_f32 v35, v35, v240
  v_mul_f32 v36, v36, v240
  v_mul_f32 v37, v37, v240
  v_mul_f32 v38, v38, v240
  v_mul_f32 v39, v39, v240
  v_mul_f32 v40, v40, v241
  v_mul_f32 v41, v41, v241
  v_mul_f32 v42, v42, v241
  v_mul_f32 v43, v43, v241
  v_mul_f32 v44, v44, v241
  v_mul_f32 v45, v45, v241
  v_mul_f32 v46, v46, v241
  v_mul_f32 v47, v47, v241
  v_mul_f32 v48, v48, v240
  v_mul_f32 v49, v49, v240
  v_mul_f32 v50, v50, v240
  v_mul_f32 v51, v51, v240
  v_mul_f32 v52, v52, v240
  v_mul_f32 v53, v53, v240
  v_mul_f32 v54, v54, v240
  v_mul_f32 v55, v55, v240
  v_mul_f32 v56, v56, v241
  v_mul_f32 v57, v57, v241
  v_mul_f32 v58, v58, v241
  v_mul_f32 v59, v59, v241
  v_mul_f32 v60, v60, v241
  v_mul_f32 v61, v61, v241
  v_mul_f32 v62, v62, v241
  v_mul_f32 v63, v63, v241
  v_mul_f32 v234, v234, v240
  v_mov_b32 v236, 0
  v_mul_f32 v235, v235, v241
  v_mov_b32 v237, 0
  v_exp_f32 v222, v144
  v_exp_f32 v223, v145
  s_nop 0
  v_cvt_pk_bf16_f32 v168, v222, v223
  v_add_f32 v236, v236, v222
  v_add_f32 v236, v236, v223
  v_exp_f32 v222, v146
  v_exp_f32 v223, v147
  s_nop 0
  v_cvt_pk_bf16_f32 v169, v222, v223
  v_add_f32 v236, v236, v222
  v_add_f32 v236, v236, v223
  v_exp_f32 v222, v148
  v_exp_f32 v223, v149
  s_nop 0
  v_cvt_pk_bf16_f32 v170, v222, v223
  v_add_f32 v236, v236, v222
  v_add_f32 v236, v236, v223
  v_exp_f32 v222, v150
  v_exp_f32 v223, v151
  s_nop 0
  v_cvt_pk_bf16_f32 v171, v222, v223
  v_add_f32 v236, v236, v222
  v_add_f32 v236, v236, v223
  v_exp_f32 v222, v152
  v_exp_f32 v223, v153
  s_nop 0
  v_cvt_pk_bf16_f32 v172, v222, v223
  v_add_f32 v237, v237, v222
  v_add_f32 v237, v237, v223
  v_exp_f32 v222, v154
  v_exp_f32 v223, v155
  s_nop 0
  v_cvt_pk_bf16_f32 v173, v222, v223
  v_add_f32 v237, v237, v222
  v_add_f32 v237, v237, v223
  v_exp_f32 v222, v156
  v_exp_f32 v223, v157
  s_nop 0
  v_cvt_pk_bf16_f32 v174, v222, v223
  v_add_f32 v237, v237, v222
  v_add_f32 v237, v237, v223
  v_exp_f32 v222, v158
  v_exp_f32 v223, v159
  s_nop 0
  v_cvt_pk_bf16_f32 v175, v222, v223
  v_add_f32 v237, v237, v222
  v_add_f32 v237, v237, v223
  s_nop 3
  s_setpc_b64 s[60:61]
L_rescale_101:
  s_nop 15
  v_max3_f32 v238, v128, v129, 0
  v_max3_f32 v238, v238, v130, v131
  v_max3_f32 v238, v238, v132, v133
  v_max3_f32 v238, v238, v134, v135
  v_max3_f32 v239, v136, v137, 0
  v_max3_f32 v239, v239, v138, v139
  v_max3_f32 v239, v239, v140, v141
  v_max3_f32 v239, v239, v142, v143
  s_nop 1
  v_mov_b32 v240, v238
  s_nop 1
  v_mov_b32 v241, v239
  s_nop 1
  v_permlane32_swap_b32 v238, v240
  s_nop 1
  v_permlane32_swap_b32 v239, v241
  s_nop 1
  v_max_f32 v238, v238, v240
  s_nop 1
  v_max_f32 v239, v239, v241
  s_nop 1
  v_mov_b32 v240, v238
  s_nop 1
  v_mov_b32 v241, v239
  s_nop 1
  v_permlane16_swap_b32 v238, v240
  s_nop 1
  v_permlane16_swap_b32 v239, v241
  s_nop 1
  v_max_f32 v238, v238, v240
  s_nop 1
  v_max_f32 v239, v239, v241
  v_exp_f32 v240, -v238
  v_exp_f32 v241, -v239
  v_sub_f32 v176, v176, v238
  v_sub_f32 v177, v177, v238
  v_sub_f32 v178, v178, v238
  v_sub_f32 v179, v179, v238
  v_sub_f32 v180, v180, v239
  v_sub_f32 v181, v181, v239
  v_sub_f32 v182, v182, v239
  v_sub_f32 v183, v183, v239
  v_sub_f32 v128, v128, v238
  v_sub_f32 v129, v129, v238
  v_sub_f32 v130, v130, v238
  v_sub_f32 v131, v131, v238
  v_sub_f32 v132, v132, v238
  v_sub_f32 v133, v133, v238
  v_sub_f32 v134, v134, v238
  v_sub_f32 v135, v135, v238
  v_sub_f32 v136, v136, v239
  v_sub_f32 v137, v137, v239
  v_sub_f32 v138, v138, v239
  v_sub_f32 v139, v139, v239
  v_sub_f32 v140, v140, v239
  v_sub_f32 v141, v141, v239
  v_sub_f32 v142, v142, v239
  v_sub_f32 v143, v143, v239
  v_sub_f32 v144, v144, v238
  v_sub_f32 v145, v145, v238
  v_sub_f32 v146, v146, v238
  v_sub_f32 v147, v147, v238
  v_sub_f32 v148, v148, v238
  v_sub_f32 v149, v149, v238
  v_sub_f32 v150, v150, v238
  v_sub_f32 v151, v151, v238
  v_sub_f32 v152, v152, v239
  v_sub_f32 v153, v153, v239
  v_sub_f32 v154, v154, v239
  v_sub_f32 v155, v155, v239
  v_sub_f32 v156, v156, v239
  v_sub_f32 v157, v157, v239
  v_sub_f32 v158, v158, v239
  v_sub_f32 v159, v159, v239
  v_mul_f32 v64, v64, v240
  v_mul_f32 v65, v65, v240
  v_mul_f32 v66, v66, v240
  v_mul_f32 v67, v67, v240
  v_mul_f32 v68, v68, v240
  v_mul_f32 v69, v69, v240
  v_mul_f32 v70, v70, v240
  v_mul_f32 v71, v71, v240
  v_mul_f32 v72, v72, v241
  v_mul_f32 v73, v73, v241
  v_mul_f32 v74, v74, v241
  v_mul_f32 v75, v75, v241
  v_mul_f32 v76, v76, v241
  v_mul_f32 v77, v77, v241
  v_mul_f32 v78, v78, v241
  v_mul_f32 v79, v79, v241
  v_mul_f32 v80, v80, v240
  v_mul_f32 v81, v81, v240
  v_mul_f32 v82, v82, v240
  v_mul_f32 v83, v83, v240
  v_mul_f32 v84, v84, v240
  v_mul_f32 v85, v85, v240
  v_mul_f32 v86, v86, v240
  v_mul_f32 v87, v87, v240
  v_mul_f32 v88, v88, v241
  v_mul_f32 v89, v89, v241
  v_mul_f32 v90, v90, v241
  v_mul_f32 v91, v91, v241
  v_mul_f32 v92, v92, v241
  v_mul_f32 v93, v93, v241
  v_mul_f32 v94, v94, v241
  v_mul_f32 v95, v95, v241
  v_mul_f32 v96, v96, v240
  v_mul_f32 v97, v97, v240
  v_mul_f32 v98, v98, v240
  v_mul_f32 v99, v99, v240
  v_mul_f32 v100, v100, v240
  v_mul_f32 v101, v101, v240
  v_mul_f32 v102, v102, v240
  v_mul_f32 v103, v103, v240
  v_mul_f32 v104, v104, v241
  v_mul_f32 v105, v105, v241
  v_mul_f32 v106, v106, v241
  v_mul_f32 v107, v107, v241
  v_mul_f32 v108, v108, v241
  v_mul_f32 v109, v109, v241
  v_mul_f32 v110, v110, v241
  v_mul_f32 v111, v111, v241
  v_mul_f32 v112, v112, v240
  v_mul_f32 v113, v113, v240
  v_mul_f32 v114, v114, v240
  v_mul_f32 v115, v115, v240
  v_mul_f32 v116, v116, v240
  v_mul_f32 v117, v117, v240
  v_mul_f32 v118, v118, v240
  v_mul_f32 v119, v119, v240
  v_mul_f32 v120, v120, v241
  v_mul_f32 v121, v121, v241
  v_mul_f32 v122, v122, v241
  v_mul_f32 v123, v123, v241
  v_mul_f32 v124, v124, v241
  v_mul_f32 v125, v125, v241
  v_mul_f32 v126, v126, v241
  v_mul_f32 v127, v127, v241
  v_mul_f32 v234, v234, v240
  v_mov_b32 v236, 0
  v_mul_f32 v235, v235, v241
  v_mov_b32 v237, 0
  v_exp_f32 v222, v128
  v_exp_f32 v223, v129
  s_nop 0
  v_cvt_pk_bf16_f32 v160, v222, v223
  v_add_f32 v236, v236, v222
  v_add_f32 v236, v236, v223
  v_exp_f32 v222, v130
  v_exp_f32 v223, v131
  s_nop 0
  v_cvt_pk_bf16_f32 v161, v222, v223
  v_add_f32 v236, v236, v222
  v_add_f32 v236, v236, v223
  v_exp_f32 v222, v132
  v_exp_f32 v223, v133
  s_nop 0
  v_cvt_pk_bf16_f32 v162, v222, v223
  v_add_f32 v236, v236, v222
  v_add_f32 v236, v236, v223
  v_exp_f32 v222, v134
  v_exp_f32 v223, v135
  s_nop 0
  v_cvt_pk_bf16_f32 v163, v222, v223
  v_add_f32 v236, v236, v222
  v_add_f32 v236, v236, v223
  v_exp_f32 v222, v136
  v_exp_f32 v223, v137
  s_nop 0
  v_cvt_pk_bf16_f32 v164, v222, v223
  v_add_f32 v237, v237, v222
  v_add_f32 v237, v237, v223
  v_exp_f32 v222, v138
  v_exp_f32 v223, v139
  s_nop 0
  v_cvt_pk_bf16_f32 v165, v222, v223
  v_add_f32 v237, v237, v222
  v_add_f32 v237, v237, v223
  v_exp_f32 v222, v140
  v_exp_f32 v223, v141
  s_nop 0
  v_cvt_pk_bf16_f32 v166, v222, v223
  v_add_f32 v237, v237, v222
  v_add_f32 v237, v237, v223
  v_exp_f32 v222, v142
  v_exp_f32 v223, v143
  s_nop 0
  v_cvt_pk_bf16_f32 v167, v222, v223
  v_add_f32 v237, v237, v222
  v_add_f32 v237, v237, v223
  s_nop 3
  s_setpc_b64 s[60:61]
L_rescale_110:
  s_nop 15
  v_max3_f32 v238, v144, v145, 0
  v_max3_f32 v238, v238, v146, v147
  v_max3_f32 v238, v238, v148, v149
  v_max3_f32 v238, v238, v150, v151
  v_max3_f32 v239, v152, v153, 0
  v_max3_f32 v239, v239, v154, v155
  v_max3_f32 v239, v239, v156, v157
  v_max3_f32 v239, v239, v158, v159
  s_nop 1
  v_mov_b32 v240, v238
  s_nop 1
  v_mov_b32 v241, v239
  s_nop 1
  v_permlane32_swap_b32 v238, v240
  s_nop 1
  v_permlane32_swap_b32 v239, v241
  s_nop 1
  v_max_f32 v238, v238, v240
  s_nop 1
  v_max_f32 v239, v239, v241
  s_nop 1
  v_mov_b32 v240, v238
  s_nop 1
  v_mov_b32 v241, v239
  s_nop 1
  v_permlane16_swap_b32 v238, v240
  s_nop 1
  v_permlane16_swap_b32 v239, v241
  s_nop 1
  v_max_f32 v238, v238, v240
  s_nop 1
  v_max_f32 v239, v239, v241
  v_exp_f32 v240, -v238
  v_exp_f32 v241, -v239
  v_sub_f32 v176, v176, v238
  v_sub_f32 v177, v177, v238
  v_sub_f32 v178, v178, v238
  v_sub_f32 v179, v179, v238
  v_sub_f32 v180, v180, v239
  v_sub_f32 v181, v181, v239
  v_sub_f32 v182, v182, v239
  v_sub_f32 v183, v183, v239
  v_sub_f32 v144, v144, v238
  v_sub_f32 v145, v145, v238
  v_sub_f32 v146, v146, v238
  v_sub_f32 v147, v147, v238
  v_sub_f32 v148, v148, v238
  v_sub_f32 v149, v149, v238
  v_sub_f32 v150, v150, v238
  v_sub_f32 v151, v151, v238
  v_sub_f32 v152, v152, v239
  v_sub_f32 v153, v153, v239
  v_sub_f32 v154, v154, v239
  v_sub_f32 v155, v155, v239
  v_sub_f32 v156, v156, v239
  v_sub_f32 v157, v157, v239
  v_sub_f32 v158, v158, v239
  v_sub_f32 v159, v159, v239
  v_mul_f32 v64, v64, v240
  v_mul_f32 v65, v65, v240
  v_mul_f32 v66, v66, v240
  v_mul_f32 v67, v67, v240
  v_mul_f32 v68, v68, v240
  v_mul_f32 v69, v69, v240
  v_mul_f32 v70, v70, v240
  v_mul_f32 v71, v71, v240
  v_mul_f32 v72, v72, v241
  v_mul_f32 v73, v73, v241
  v_mul_f32 v74, v74, v241
  v_mul_f32 v75, v75, v241
  v_mul_f32 v76, v76, v241
  v_mul_f32 v77, v77, v241
  v_mul_f32 v78, v78, v241
  v_mul_f32 v79, v79, v241
  v_mul_f32 v80, v80, v240
  v_mul_f32 v81, v81, v240
  v_mul_f32 v82, v82, v240
  v_mul_f32 v83, v83, v240
  v_mul_f32 v84, v84, v240
  v_mul_f32 v85, v85, v240
  v_mul_f32 v86, v86, v240
  v_mul_f32 v87, v87, v240
  v_mul_f32 v88, v88, v241
  v_mul_f32 v89, v89, v241
  v_mul_f32 v90, v90, v241
  v_mul_f32 v91, v91, v241
  v_mul_f32 v92, v92, v241
  v_mul_f32 v93, v93, v241
  v_mul_f32 v94, v94, v241
  v_mul_f32 v95, v95, v241
  v_mul_f32 v96, v96, v240
  v_mul_f32 v97, v97, v240
  v_mul_f32 v98, v98, v240
  v_mul_f32 v99, v99, v240
  v_mul_f32 v100, v100, v240
  v_mul_f32 v101, v101, v240
  v_mul_f32 v102, v102, v240
  v_mul_f32 v103, v103, v240
  v_mul_f32 v104, v104, v241
  v_mul_f32 v105, v105, v241
  v_mul_f32 v106, v106, v241
  v_mul_f32 v107, v107, v241
  v_mul_f32 v108, v108, v241
  v_mul_f32 v109, v109, v241
  v_mul_f32 v110, v110, v241
  v_mul_f32 v111, v111, v241
  v_mul_f32 v112, v112, v240
  v_mul_f32 v113, v113, v240
  v_mul_f32 v114, v114, v240
  v_mul_f32 v115, v115, v240
  v_mul_f32 v116, v116, v240
  v_mul_f32 v117, v117, v240
  v_mul_f32 v118, v118, v240
  v_mul_f32 v119, v119, v240
  v_mul_f32 v120, v120, v241
  v_mul_f32 v121, v121, v241
  v_mul_f32 v122, v122, v241
  v_mul_f32 v123, v123, v241
  v_mul_f32 v124, v124, v241
  v_mul_f32 v125, v125, v241
  v_mul_f32 v126, v126, v241
  v_mul_f32 v127, v127, v241
  v_mul_f32 v234, v234, v240
  v_mov_b32 v236, 0
  v_mul_f32 v235, v235, v241
  v_mov_b32 v237, 0
  v_exp_f32 v222, v144
  v_exp_f32 v223, v145
  s_nop 0
  v_cvt_pk_bf16_f32 v168, v222, v223
  v_add_f32 v236, v236, v222
  v_add_f32 v236, v236, v223
  v_exp_f32 v222, v146
  v_exp_f32 v223, v147
  s_nop 0
  v_cvt_pk_bf16_f32 v169, v222, v223
  v_add_f32 v236, v236, v222
  v_add_f32 v236, v236, v223
  v_exp_f32 v222, v148
  v_exp_f32 v223, v149
  s_nop 0
  v_cvt_pk_bf16_f32 v170, v222, v223
  v_add_f32 v236, v236, v222
  v_add_f32 v236, v236, v223
  v_exp_f32 v222, v150
  v_exp_f32 v223, v151
  s_nop 0
  v_cvt_pk_bf16_f32 v171, v222, v223
  v_add_f32 v236, v236, v222
  v_add_f32 v236, v236, v223
  v_exp_f32 v222, v152
  v_exp_f32 v223, v153
  s_nop 0
  v_cvt_pk_bf16_f32 v172, v222, v223
  v_add_f32 v237, v237, v222
  v_add_f32 v237, v237, v223
  v_exp_f32 v222, v154
  v_exp_f32 v223, v155
  s_nop 0
  v_cvt_pk_bf16_f32 v173, v222, v223
  v_add_f32 v237, v237, v222
  v_add_f32 v237, v237, v223
  v_exp_f32 v222, v156
  v_exp_f32 v223, v157
  s_nop 0
  v_cvt_pk_bf16_f32 v174, v222, v223
  v_add_f32 v237, v237, v222
  v_add_f32 v237, v237, v223
  v_exp_f32 v222, v158
  v_exp_f32 v223, v159
  s_nop 0
  v_cvt_pk_bf16_f32 v175, v222, v223
  v_add_f32 v237, v237, v222
  v_add_f32 v237, v237, v223
  s_nop 3
  s_setpc_b64 s[60:61]
L_rescale_111:
  s_nop 15
  v_max3_f32 v238, v144, v145, 0
  v_max3_f32 v238, v238, v146, v147
  v_max3_f32 v238, v238, v148, v149
  v_max3_f32 v238, v238, v150, v151
  v_max3_f32 v239, v152, v153, 0
  v_max3_f32 v239, v239, v154, v155
  v_max3_f32 v239, v239, v156, v157
  v_max3_f32 v239, v239, v158, v159
  s_nop 1
  v_mov_b32 v240, v238
  s_nop 1
  v_mov_b32 v241, v239
  s_nop 1
  v_permlane32_swap_b32 v238, v240
  s_nop 1
  v_permlane32_swap_b32 v239, v241
  s_nop 1
  v_max_f32 v238, v238, v240
  s_nop 1
  v_max_f32 v239, v239, v241
  s_nop 1
  v_mov_b32 v240, v238
  s_nop 1
  v_mov_b32 v241, v239
  s_nop 1
  v_permlane16_swap_b32 v238, v240
  s_nop 1
  v_permlane16_swap_b32 v239, v241
  s_nop 1
  v_max_f32 v238, v238, v240
  s_nop 1
  v_max_f32 v239, v239, v241
  v_exp_f32 v240, -v238
  v_exp_f32 v241, -v239
  v_sub_f32 v176, v176, v238
  v_sub_f32 v177, v177, v238
  v_sub_f32 v178, v178, v238
  v_sub_f32 v179, v179, v238
  v_sub_f32 v180, v180, v239
  v_sub_f32 v181, v181, v239
  v_sub_f32 v182, v182, v239
  v_sub_f32 v183, v183, v239
  v_sub_f32 v128, v128, v238
  v_sub_f32 v129, v129, v238
  v_sub_f32 v130, v130, v238
  v_sub_f32 v131, v131, v238
  v_sub_f32 v132, v132, v238
  v_sub_f32 v133, v133, v238
  v_sub_f32 v134, v134, v238
  v_sub_f32 v135, v135, v238
  v_sub_f32 v136, v136, v239
  v_sub_f32 v137, v137, v239
  v_sub_f32 v138, v138, v239
  v_sub_f32 v139, v139, v239
  v_sub_f32 v140, v140, v239
  v_sub_f32 v141, v141, v239
  v_sub_f32 v142, v142, v239
  v_sub_f32 v143, v143, v239
  v_sub_f32 v144, v144, v238
  v_sub_f32 v145, v145, v238
  v_sub_f32 v146, v146, v238
  v_sub_f32 v147, v147, v238
  v_sub_f32 v148, v148, v238
  v_sub_f32 v149, v149, v238
  v_sub_f32 v150, v150, v238
  v_sub_f32 v151, v151, v238
  v_sub_f32 v152, v152, v239
  v_sub_f32 v153, v153, v239
  v_sub_f32 v154, v154, v239
  v_sub_f32 v155, v155, v239
  v_sub_f32 v156, v156, v239
  v_sub_f32 v157, v157, v239
  v_sub_f32 v158, v158, v239
  v_sub_f32 v159, v159, v239
  v_mul_f32 v64, v64, v240
  v_mul_f32 v65, v65, v240
  v_mul_f32 v66, v66, v240
  v_mul_f32 v67, v67, v240
  v_mul_f32 v68, v68, v240
  v_mul_f32 v69, v69, v240
  v_mul_f32 v70, v70, v240
  v_mul_f32 v71, v71, v240
  v_mul_f32 v72, v72, v241
  v_mul_f32 v73, v73, v241
  v_mul_f32 v74, v74, v241
  v_mul_f32 v75, v75, v241
  v_mul_f32 v76, v76, v241
  v_mul_f32 v77, v77, v241
  v_mul_f32 v78, v78, v241
  v_mul_f32 v79, v79, v241
  v_mul_f32 v80, v80, v240
  v_mul_f32 v81, v81, v240
  v_mul_f32 v82, v82, v240
  v_mul_f32 v83, v83, v240
  v_mul_f32 v84, v84, v240
  v_mul_f32 v85, v85, v240
  v_mul_f32 v86, v86, v240
  v_mul_f32 v87, v87, v240
  v_mul_f32 v88, v88, v241
  v_mul_f32 v89, v89, v241
  v_mul_f32 v90, v90, v241
  v_mul_f32 v91, v91, v241
  v_mul_f32 v92, v92, v241
  v_mul_f32 v93, v93, v241
  v_mul_f32 v94, v94, v241
  v_mul_f32 v95, v95, v241
  v_mul_f32 v96, v96, v240
  v_mul_f32 v97, v97, v240
  v_mul_f32 v98, v98, v240
  v_mul_f32 v99, v99, v240
  v_mul_f32 v100, v100, v240
  v_mul_f32 v101, v101, v240
  v_mul_f32 v102, v102, v240
  v_mul_f32 v103, v103, v240
  v_mul_f32 v104, v104, v241
  v_mul_f32 v105, v105, v241
  v_mul_f32 v106, v106, v241
  v_mul_f32 v107, v107, v241
  v_mul_f32 v108, v108, v241
  v_mul_f32 v109, v109, v241
  v_mul_f32 v110, v110, v241
  v_mul_f32 v111, v111, v241
  v_mul_f32 v112, v112, v240
  v_mul_f32 v113, v113, v240
  v_mul_f32 v114, v114, v240
  v_mul_f32 v115, v115, v240
  v_mul_f32 v116, v116, v240
  v_mul_f32 v117, v117, v240
  v_mul_f32 v118, v118, v240
  v_mul_f32 v119, v119, v240
  v_mul_f32 v120, v120, v241
  v_mul_f32 v121, v121, v241
  v_mul_f32 v122, v122, v241
  v_mul_f32 v123, v123, v241
  v_mul_f32 v124, v124, v241
  v_mul_f32 v125, v125, v241
  v_mul_f32 v126, v126, v241
  v_mul_f32 v127, v127, v241
  v_mul_f32 v234, v234, v240
  v_mov_b32 v236, 0
  v_mul_f32 v235, v235, v241
  v_mov_b32 v237, 0
  v_exp_f32 v222, v144
  v_exp_f32 v223, v145
  s_nop 0
  v_cvt_pk_bf16_f32 v168, v222, v223
  v_add_f32 v236, v236, v222
  v_add_f32 v236, v236, v223
  v_exp_f32 v222, v146
  v_exp_f32 v223, v147
  s_nop 0
  v_cvt_pk_bf16_f32 v169, v222, v223
  v_add_f32 v236, v236, v222
  v_add_f32 v236, v236, v223
  v_exp_f32 v222, v148
  v_exp_f32 v223, v149
  s_nop 0
  v_cvt_pk_bf16_f32 v170, v222, v223
  v_add_f32 v236, v236, v222
  v_add_f32 v236, v236, v223
  v_exp_f32 v222, v150
  v_exp_f32 v223, v151
  s_nop 0
  v_cvt_pk_bf16_f32 v171, v222, v223
  v_add_f32 v236, v236, v222
  v_add_f32 v236, v236, v223
  v_exp_f32 v222, v152
  v_exp_f32 v223, v153
  s_nop 0
  v_cvt_pk_bf16_f32 v172, v222, v223
  v_add_f32 v237, v237, v222
  v_add_f32 v237, v237, v223
  v_exp_f32 v222, v154
  v_exp_f32 v223, v155
  s_nop 0
  v_cvt_pk_bf16_f32 v173, v222, v223
  v_add_f32 v237, v237, v222
  v_add_f32 v237, v237, v223
  v_exp_f32 v222, v156
  v_exp_f32 v223, v157
  s_nop 0
  v_cvt_pk_bf16_f32 v174, v222, v223
  v_add_f32 v237, v237, v222
  v_add_f32 v237, v237, v223
  v_exp_f32 v222, v158
  v_exp_f32 v223, v159
  s_nop 0
  v_cvt_pk_bf16_f32 v175, v222, v223
  v_add_f32 v237, v237, v222
  v_add_f32 v237, v237, v223
  s_nop 3
  s_setpc_b64 s[60:61]
L_codeend:
.section .rodata,"a"
.p2align 6
.amdhsa_kernel standalone__mha_block_cached__near_ridge_kernel
  .amdhsa_next_free_vgpr 512
  .amdhsa_next_free_sgpr 102
  .amdhsa_accum_offset 256
  .amdhsa_group_segment_fixed_size 0
  .amdhsa_kernarg_size 64
  .amdhsa_user_sgpr_count 2
  .amdhsa_user_sgpr_kernarg_segment_ptr 1
  .amdhsa_system_sgpr_workgroup_id_x 1
  .amdhsa_float_denorm_mode_32 3
.end_amdhsa_kernel
```
